```python
import torch

def _softmax(x, axis=-1):
    return torch.softmax(x, dim=axis)
def _gelu(x):
    return torch.nn.functional.gelu(x, approximate="tanh")
def _silu(x):
    return torch.nn.functional.silu(x)
def _sigmoid(x):
    return torch.sigmoid(x)
def _layernorm(x, axis=-1, eps=1e-5):
    m = x.mean(dim=axis, keepdim=True)
    v = x.var(dim=axis, keepdim=True, unbiased=False)
    return (x - m) / torch.sqrt(v + eps)
def _scatter_add(tgt, idx, src, axis=0):
    return tgt.clone().index_add_(axis, idx, src)
def _segment_sum(src, seg, n):
    out = torch.zeros((n,) + src.shape[1:], dtype=src.dtype)
    return out.index_add_(0, seg, src)
def _pad(x, pw):
    flat = tuple(v for pair in reversed(pw) for v in pair)
    return torch.nn.functional.pad(x, flat)

kernel_name = 'concat_heads__gqa_block_cached__mha_block_cached__near_ridge'

def setup_inputs():

    _w = (lambda a: (lambda t: t.to(torch.bfloat16) if t.is_floating_point() else t)(torch.as_tensor(a)))
    def _A_setup():
        B, Sq, D = 16, 80, 576
        Hq, Hkv, Sk, Dh = 32, 16, 512, 128
        assert Hq % Hkv == 0, (Hq, Hkv)
        return {
            "x": _w((lambda *s: torch.randn(*s, dtype=torch.bfloat16) * 0.8)(B, Sq, D)),
            "k_cache": _w((lambda *s: torch.randn(*s, dtype=torch.bfloat16) * 0.8)(B, Hkv, Sk, Dh)),
            "v_cache": _w((lambda *s: torch.randn(*s, dtype=torch.bfloat16) * 0.05)(B, Hkv, Sk, Dh)),
            "wq": _w((lambda *s: torch.randn(*s, dtype=torch.bfloat16) * 0.8)(D, Hq * Dh) * (D ** -0.5)),
            "wo": _w((lambda *s: torch.randn(*s, dtype=torch.bfloat16) * 0.05)(Hq * Dh, D) * ((Hq * Dh) ** -0.5)),
        }
    _A_in = _A_setup()

    def _B_setup():
        B, Sq, D = 16, 80, 576
        H, Sk, Dh = 32, 512, 128
        return {
            "x": _w((lambda *s: torch.randn(*s, dtype=torch.bfloat16) * 0.8)(B, Sq, D)),
            "k_cache": _w((lambda *s: torch.randn(*s, dtype=torch.bfloat16) * 0.8)(B, H, Sk, Dh)),
            "v_cache": _w((lambda *s: torch.randn(*s, dtype=torch.bfloat16) * 0.05)(B, H, Sk, Dh)),
            "wq": _w((lambda *s: torch.randn(*s, dtype=torch.bfloat16) * 0.8)(D, H * Dh) * (D ** -0.5)),
            "wo": _w((lambda *s: torch.randn(*s, dtype=torch.bfloat16) * 0.05)(H * Dh, D) * ((H * Dh) ** -0.5)),
        }
    _B_in = _B_setup()

    return {
        "A_x": _A_in["x"],
        "A_k_cache": _A_in["k_cache"],
        "A_v_cache": _A_in["v_cache"],
        "A_wq": _A_in["wq"],
        "A_wo": _A_in["wo"],
        "B_x": _B_in["x"],
        "B_k_cache": _B_in["k_cache"],
        "B_v_cache": _B_in["v_cache"],
        "B_wq": _B_in["wq"],
        "B_wo": _B_in["wo"],
    }

def reference(A_x, A_k_cache, A_v_cache, A_wq, A_wo, B_x, B_k_cache, B_v_cache, B_wq, B_wo):
    def _A_ref(x, k_cache, v_cache, wq, wo):
        B, Sq, D = x.shape
        Hq, Dh = 32, 128
        Hkv = k_cache.shape[1]
        rep = Hq // Hkv
        q = (lambda x, *d: x.permute(*d))((x @ wq).reshape(B, Sq, Hq, Dh), 0, 2, 1, 3)
        k = (lambda x, n, axis: torch.repeat_interleave(x, n, dim=axis))(k_cache, rep, axis=1)
        v = (lambda x, n, axis: torch.repeat_interleave(x, n, dim=axis))(v_cache, rep, axis=1)
        scores = torch.einsum("bhqd,bhkd->bhqk", q, k) * (Dh ** -0.5)
        p = _softmax(scores, axis=-1)
        o = torch.einsum("bhqk,bhkd->bhqd", p, v)
        return (lambda x, *d: x.permute(*d))(o, 0, 2, 1, 3).reshape(B, Sq, Hq * Dh) @ wo

    def _B_ref(x, k_cache, v_cache, wq, wo):
        B, Sq, D = x.shape
        H, Dh = 32, 128
        q = (lambda x, *d: x.permute(*d))((x @ wq).reshape(B, Sq, H, Dh), 0, 2, 1, 3)
        scores = torch.einsum("bhqd,bhkd->bhqk", q, k_cache) * (Dh ** -0.5)
        p = _softmax(scores, axis=-1)
        o = torch.einsum("bhqk,bhkd->bhqd", p, v_cache)
        return (lambda x, *d: x.permute(*d))(o, 0, 2, 1, 3).reshape(B, Sq, H * Dh) @ wo

    a = _A_ref(A_x, A_k_cache, A_v_cache, A_wq, A_wo)
    b = _B_ref(B_x, B_k_cache, B_v_cache, B_wq, B_wo)
    return torch.concatenate([a, b], axis=-1)
```

```asm
; @launch kernel=attn_kernel grid=(256,1,1) block=(256,1,1) lds=163840
.amdgcn_target "amdgcn-amd-amdhsa--gfx950"
.text
.globl attn_kernel
.p2align 8
.type attn_kernel,@function
attn_kernel:
    s_cmp_ge_u32 s2, 256
    s_cbranch_scc1 L_k1_done
    s_and_b32 s41, s2, 7
    s_lshr_b32 s42, s2, 3
    s_and_b32 s25, s42, 1
    s_lshr_b32 s42, s42, 1
    s_mul_i32 s45, s25, 40
    s_add_u32 s46, s0, s45
    s_addc_u32 s47, s1, 0
    s_load_dwordx8 s[64:71], s[46:47], 0
    s_load_dwordx2 s[72:73], s[0:1], 96
    v_lshrrev_b32 v1, 6, v0
    v_and_b32 v0, 63, v0
    v_readfirstlane_b32 s24, v1
    s_and_b32 s43, s42, 3
    s_lshr_b32 s44, s42, 2
    s_add_u32 s48, s43, s44
    s_and_b32 s63, s48, 3
    s_and_b32 s49, s41, 3
    s_lshl_b32 s49, s49, 2
    s_add_u32 s43, s43, s49
    s_lshr_b32 s49, s41, 2
    s_lshl_b32 s49, s49, 2
    s_add_u32 s44, s44, s49
    s_and_b32 s63, s2, 7
    s_lshr_b32 s49, s24, 1
    s_lshl_b32 s26, s44, 1
    s_add_u32 s26, s26, s49
    s_and_b32 s50, s24, 1
    s_lshl_b32 s27, s43, 1
    s_add_u32 s27, s27, s50
    s_mul_i32 s28, s24, 40960
    s_cmp_eq_u32 s25, 0
    s_cselect_b32 s51, s43, s27
    s_add_u32 s52, s25, 4
    s_lshl_b32 s52, s26, s52
    s_add_u32 s51, s51, s52
    s_lshl_b32 s29, s51, 17
    s_mov_b32 s3, s29
    s_lshr_b32 s52, s29, 17
    s_mul_i32 s52, s52, 5
    s_and_b32 s52, s52, 15
    s_lshl_b32 s52, s52, 13
    s_add_u32 s29, s29, s52
    s_mov_b32 s30, s29
    s_lshl_b32 s53, s44, 1
    s_add_u32 s53, s53, s49
    s_mul_i32 s31, s53, 92160
    s_mul_i32 s54, s50, 46080
    s_add_u32 s31, s31, s54
    s_add_u32 s52, s49, 2
    s_mul_i32 s52, s52, 40960
    s_mul_i32 s54, s50, 5120
    s_add_u32 s34, s52, s54
    s_add_u32 s34, s34, 16384
    s_lshl_b32 s37, s49, 17
    s_lshl_b32 s51, s27, 8
    s_add_u32 s37, s37, s51
    s_mul_i32 s38, s50, 40960
    s_lshl_b32 s51, s49, 12
    s_add_u32 s38, s38, s51
    s_add_u32 s38, s38, 16384
    s_lshl_b32 s60, s25, 7
    s_lshl_b32 s51, s27, 2
    s_add_u32 s60, s60, s51
    s_mul_i32 s60, s60, 80
    s_mul_i32 s51, s26, 5
    s_add_u32 s60, s60, s51
    s_lshl_b32 s60, s60, 10
    s_mov_b32 s61, 0x3e0293ee
    s_mov_b32 s62, 0x40004000
    v_lshrrev_b32 v23, 3, v0
    v_lshrrev_b32 v24, 4, v0
    v_and_b32 v26, 7, v0
    v_xor_b32 v26, v26, v24
    v_lshlrev_b32 v26, 4, v26
    v_mul_u32_u24 v10, 1152, v23
    v_add_u32 v10, v10, v26
    v_and_b32 v27, 15, v0
    v_lshrrev_b32 v28, 2, v27
    v_lshrrev_b32 v25, 1, v27
    v_xor_b32 v25, v25, v24
    v_lshlrev_b32 v25, 4, v25
    v_lshlrev_b32 v1, 7, v27
    v_add_u32 v1, v1, v25
    s_add_u32 s51, s49, 2
    s_mul_i32 s51, s51, 40960
    s_add_u32 s51, s51, 16384
    v_add_u32 v1, s51, v1
    v_xor_b32 v233, 64, v1
    v_lshlrev_b32 v25, 1, v24
    v_xor_b32 v25, v25, v27
    v_lshlrev_b32 v25, 4, v25
    v_lshlrev_b32 v11, 13, v24
    v_add_u32 v11, v11, v25
    v_xor_b32 v12, 0x80, v11
    v_and_b32 v29, 3, v0
    v_lshlrev_b32 v29, 3, v29
    v_lshlrev_b32 v25, 3, v24
    v_add_u32 v25, v25, v28
    v_lshlrev_b32 v25, 8, v25
    v_and_b32 v26, 1, v24
    v_lshlrev_b32 v26, 2, v26
    v_or_b32 v26, v26, v28
    v_lshlrev_b32 v30, 5, v26
    v_add_u32 v25, v25, v30
    v_add_u32 v25, v25, v29
    s_mul_i32 s51, s50, 40960
    s_add_u32 s51, s51, 16384
    v_add_u32 v2, s51, v25
    v_xor_b32 v3, 32, v2
    v_xor_b32 v4, 64, v2
    v_xor_b32 v5, 96, v2
    v_xor_b32 v6, 128, v2
    v_xor_b32 v7, 160, v2
    v_xor_b32 v8, 192, v2
    v_xor_b32 v9, 224, v2
    v_xor_b32 v25, v27, v24
    v_lshlrev_b32 v25, 4, v25
    v_lshlrev_b32 v26, 8, v24
    v_add_u32 v17, v26, v25
    v_xor_b32 v18, 64, v17
    v_xor_b32 v19, 128, v17
    v_xor_b32 v20, 192, v17
    v_lshlrev_b32 v30, 8, v27
    v_add_u32 v30, v30, v25
    v_add_u32 v13, s28, v30
    v_xor_b32 v14, 64, v13
    v_xor_b32 v15, 128, v13
    v_xor_b32 v16, 192, v13
    v_lshlrev_b32 v25, 1, v24
    v_xor_b32 v25, v25, v27
    v_lshlrev_b32 v25, 4, v25
    v_add_u32 v21, v26, v25
    v_xor_b32 v22, 0x80, v21
    v_lshlrev_b32 v25, 2, v24
    v_add_u32 v25, v25, v28
    v_and_b32 v26, 7, v25
    v_lshlrev_b32 v25, 8, v25
    v_lshlrev_b32 v26, 5, v26
    v_add_u32 v25, v25, v26
    v_add_u32 v25, v25, v29
    v_add_u32 v31, s28, v25
    s_add_u32 s51, s37, 0
    v_add_u32 v224, s51, v11
    s_add_u32 s51, s37, 32768
    v_add_u32 v225, s51, v11
    s_add_u32 s51, s37, 65536
    v_add_u32 v226, s51, v12
    s_add_u32 s51, s37, 98304
    v_add_u32 v227, s51, v12
    s_add_u32 s51, s50, 0
    s_and_b32 s51, s51, 1
    s_lshl_b32 s51, s51, 6
    v_xor_b32 v228, s51, v10
    s_add_u32 s51, s31, 0
    v_add_u32 v228, s51, v228
    s_add_u32 s51, s50, 1
    s_and_b32 s51, s51, 1
    s_lshl_b32 s51, s51, 6
    v_xor_b32 v229, s51, v10
    s_add_u32 s51, s31, 9216
    v_add_u32 v229, s51, v229
    s_add_u32 s51, s50, 2
    s_and_b32 s51, s51, 1
    s_lshl_b32 s51, s51, 6
    v_xor_b32 v230, s51, v10
    s_add_u32 s51, s31, 18432
    v_add_u32 v230, s51, v230
    s_add_u32 s51, s50, 3
    s_and_b32 s51, s51, 1
    s_lshl_b32 s51, s51, 6
    v_xor_b32 v231, s51, v10
    s_add_u32 s51, s31, 27648
    v_add_u32 v231, s51, v231
    s_add_u32 s51, s50, 4
    s_and_b32 s51, s51, 1
    s_lshl_b32 s51, s51, 6
    v_xor_b32 v232, s51, v10
    s_add_u32 s51, s31, 36864
    v_add_u32 v232, s51, v232
    s_waitcnt lgkmcnt(0)
    s_mov_b32 s4, s64
    s_mov_b32 s5, s65
    s_mov_b32 s6, 1474560
    s_mov_b32 s7, 0x20000
    s_mov_b32 s8, s70
    s_mov_b32 s9, s71
    s_mov_b32 s10, 4718592
    s_mov_b32 s11, 0x20000
    s_add_u32 s51, s25, 25
    s_lshl_b32 s51, 1, s51
    s_mov_b32 s12, s66
    s_mov_b32 s13, s67
    s_mov_b32 s14, s51
    s_mov_b32 s15, 0x20000
    s_mov_b32 s16, s68
    s_mov_b32 s17, s69
    s_mov_b32 s18, s51
    s_mov_b32 s19, 0x20000
    s_mov_b32 s20, s72
    s_mov_b32 s21, s73
    s_mov_b32 s22, 20971520
    s_mov_b32 s23, 0x20000
    s_cmp_lg_u32 s2, 0
    s_cbranch_scc1 L_k1_nononce
    s_cmp_lg_u32 s24, 0
    s_cbranch_scc1 L_k1_nononce
    s_load_dwordx2 s[74:75], s[0:1], 88
    s_memrealtime s[76:77]
    s_waitcnt lgkmcnt(0)
    s_or_b32 s76, s76, 1
    v_mov_b32 v234, s76
    v_mov_b32 v235, 0
    s_mov_b32 s76, s74
    s_mov_b32 s77, s75
    s_mov_b32 s78, 256
    s_mov_b32 s79, 0x20000
    v_cmp_eq_u32 vcc, 0, v0
    s_nop 3
    s_and_saveexec_b64 s[74:75], vcc
    buffer_store_dword v234, v235, s[76:79], 0 offen sc1
    s_waitcnt vmcnt(0)
    s_mov_b64 exec, s[74:75]
L_k1_nononce:
    s_add_u32 s39, s63, 0
    s_cmp_ge_u32 s39, 9
    s_cselect_b32 s55, 9, 0
    s_sub_u32 s39, s39, s55
    s_lshl_b32 s39, s39, 7
    s_add_u32 m0, s34, 10240
    s_nop 0
    buffer_load_dwordx4 v228, s[4:7], s39 offen lds
    s_add_u32 m0, s34, 11264
    s_nop 0
    buffer_load_dwordx4 v229, s[4:7], s39 offen lds
    s_add_u32 m0, s34, 12288
    s_nop 0
    buffer_load_dwordx4 v230, s[4:7], s39 offen lds
    s_add_u32 m0, s34, 13312
    s_nop 0
    buffer_load_dwordx4 v231, s[4:7], s39 offen lds
    s_add_u32 m0, s34, 14336
    s_nop 0
    buffer_load_dwordx4 v232, s[4:7], s39 offen lds
    s_add_u32 s40, s63, 0
    s_cmp_ge_u32 s40, 9
    s_cselect_b32 s55, 9, 0
    s_sub_u32 s40, s40, s55
    s_lshl_b32 s40, s40, 19
    s_add_u32 m0, s38, 0
    s_nop 0
    buffer_load_dwordx4 v224, s[8:11], s40 offen lds
    s_add_u32 m0, s38, 1024
    s_nop 0
    buffer_load_dwordx4 v225, s[8:11], s40 offen lds
    s_add_u32 m0, s38, 2048
    s_nop 0
    buffer_load_dwordx4 v226, s[8:11], s40 offen lds
    s_add_u32 m0, s38, 3072
    s_nop 0
    buffer_load_dwordx4 v227, s[8:11], s40 offen lds
    s_add_u32 s40, s40, 0x40000
    s_add_u32 m0, s38, 8192
    s_nop 0
    buffer_load_dwordx4 v224, s[8:11], s40 offen lds
    s_add_u32 m0, s38, 9216
    s_nop 0
    buffer_load_dwordx4 v225, s[8:11], s40 offen lds
    s_add_u32 m0, s38, 10240
    s_nop 0
    buffer_load_dwordx4 v226, s[8:11], s40 offen lds
    s_add_u32 m0, s38, 11264
    s_nop 0
    buffer_load_dwordx4 v227, s[8:11], s40 offen lds
    s_add_u32 s39, s63, 1
    s_cmp_ge_u32 s39, 9
    s_cselect_b32 s55, 9, 0
    s_sub_u32 s39, s39, s55
    s_lshl_b32 s39, s39, 7
    s_add_u32 m0, s34, 0
    s_nop 0
    buffer_load_dwordx4 v228, s[4:7], s39 offen lds
    s_add_u32 m0, s34, 1024
    s_nop 0
    buffer_load_dwordx4 v229, s[4:7], s39 offen lds
    s_add_u32 m0, s34, 2048
    s_nop 0
    buffer_load_dwordx4 v230, s[4:7], s39 offen lds
    s_add_u32 m0, s34, 3072
    s_nop 0
    buffer_load_dwordx4 v231, s[4:7], s39 offen lds
    s_add_u32 m0, s34, 4096
    s_nop 0
    buffer_load_dwordx4 v232, s[4:7], s39 offen lds
    s_waitcnt vmcnt(9)
    s_barrier
    ds_read_b128 a[0:3], v1 offset:10240
    ds_read_b64_tr_b16 a[20:21], v2 offset:0
    ds_read_b64_tr_b16 a[22:23], v2 offset:1024
    ds_read_b128 a[4:7], v1 offset:12288
    ds_read_b128 a[8:11], v1 offset:14336
    ds_read_b128 a[12:15], v1 offset:16384
    ds_read_b128 a[16:19], v1 offset:18432
    ds_read_b64_tr_b16 a[24:25], v3 offset:0
    ds_read_b64_tr_b16 a[26:27], v3 offset:1024
    ds_read_b64_tr_b16 a[28:29], v4 offset:0
    ds_read_b64_tr_b16 a[30:31], v4 offset:1024
    ds_read_b64_tr_b16 a[32:33], v5 offset:0
    ds_read_b64_tr_b16 a[34:35], v5 offset:1024
    ds_read_b64_tr_b16 a[36:37], v6 offset:0
    ds_read_b64_tr_b16 a[38:39], v6 offset:1024
    ds_read_b64_tr_b16 a[40:41], v7 offset:0
    ds_read_b64_tr_b16 a[42:43], v7 offset:1024
    ds_read_b64_tr_b16 a[44:45], v8 offset:0
    ds_read_b64_tr_b16 a[46:47], v8 offset:1024
    ds_read_b64_tr_b16 a[48:49], v9 offset:0
    ds_read_b64_tr_b16 a[50:51], v9 offset:1024
    s_waitcnt lgkmcnt(0)
    v_mfma_f32_16x16x32_bf16 v[64:67], a[20:23], a[0:3], 0
    v_mfma_f32_16x16x32_bf16 v[68:71], a[20:23], a[4:7], 0
    v_mfma_f32_16x16x32_bf16 v[72:75], a[20:23], a[8:11], 0
    v_mfma_f32_16x16x32_bf16 v[76:79], a[20:23], a[12:15], 0
    v_mfma_f32_16x16x32_bf16 v[80:83], a[20:23], a[16:19], 0
    v_mfma_f32_16x16x32_bf16 v[84:87], a[24:27], a[0:3], 0
    s_waitcnt vmcnt(5)
    s_barrier
    v_mfma_f32_16x16x32_bf16 v[88:91], a[24:27], a[4:7], 0
    ds_read_b128 a[52:55], v233 offset:10240
    v_mfma_f32_16x16x32_bf16 v[92:95], a[24:27], a[8:11], 0
    ds_read_b64_tr_b16 a[72:73], v2 offset:8192
    v_mfma_f32_16x16x32_bf16 v[96:99], a[24:27], a[12:15], 0
    s_add_u32 s40, s63, 1
    s_cmp_ge_u32 s40, 9
    s_cselect_b32 s55, 9, 0
    s_sub_u32 s40, s40, s55
    v_mfma_f32_16x16x32_bf16 v[100:103], a[24:27], a[16:19], 0
    ds_read_b64_tr_b16 a[74:75], v2 offset:9216
    v_mfma_f32_16x16x32_bf16 v[104:107], a[28:31], a[0:3], 0
    ds_read_b128 a[56:59], v233 offset:12288
    v_mfma_f32_16x16x32_bf16 v[108:111], a[28:31], a[4:7], 0
    s_lshl_b32 s40, s40, 19
    ds_read_b128 a[60:63], v233 offset:14336
    v_mfma_f32_16x16x32_bf16 v[112:115], a[28:31], a[8:11], 0
    ds_read_b128 a[64:67], v233 offset:16384
    v_mfma_f32_16x16x32_bf16 v[116:119], a[28:31], a[12:15], 0
    s_add_u32 m0, s38, 16384
    v_mfma_f32_16x16x32_bf16 v[120:123], a[28:31], a[16:19], 0
    ds_read_b128 a[68:71], v233 offset:18432
    v_mfma_f32_16x16x32_bf16 v[124:127], a[32:35], a[0:3], 0
    ds_read_b64_tr_b16 a[76:77], v3 offset:8192
    v_mfma_f32_16x16x32_bf16 v[128:131], a[32:35], a[4:7], 0
    buffer_load_dwordx4 v224, s[8:11], s40 offen lds
    v_mfma_f32_16x16x32_bf16 v[132:135], a[32:35], a[8:11], 0
    ds_read_b64_tr_b16 a[78:79], v3 offset:9216
    ds_read_b64_tr_b16 a[80:81], v4 offset:8192
    v_mfma_f32_16x16x32_bf16 v[136:139], a[32:35], a[12:15], 0
    s_add_u32 m0, s38, 17408
    v_mfma_f32_16x16x32_bf16 v[140:143], a[32:35], a[16:19], 0
    ds_read_b64_tr_b16 a[82:83], v4 offset:9216
    v_mfma_f32_16x16x32_bf16 v[144:147], a[36:39], a[0:3], 0
    ds_read_b64_tr_b16 a[84:85], v5 offset:8192
    v_mfma_f32_16x16x32_bf16 v[148:151], a[36:39], a[4:7], 0
    buffer_load_dwordx4 v225, s[8:11], s40 offen lds
    v_mfma_f32_16x16x32_bf16 v[152:155], a[36:39], a[8:11], 0
    ds_read_b64_tr_b16 a[86:87], v5 offset:9216
    ds_read_b64_tr_b16 a[88:89], v6 offset:8192
    v_mfma_f32_16x16x32_bf16 v[156:159], a[36:39], a[12:15], 0
    s_add_u32 m0, s38, 18432
    v_mfma_f32_16x16x32_bf16 v[160:163], a[36:39], a[16:19], 0
    ds_read_b64_tr_b16 a[90:91], v6 offset:9216
    v_mfma_f32_16x16x32_bf16 v[164:167], a[40:43], a[0:3], 0
    ds_read_b64_tr_b16 a[92:93], v7 offset:8192
    v_mfma_f32_16x16x32_bf16 v[168:171], a[40:43], a[4:7], 0
    buffer_load_dwordx4 v226, s[8:11], s40 offen lds
    v_mfma_f32_16x16x32_bf16 v[172:175], a[40:43], a[8:11], 0
    ds_read_b64_tr_b16 a[94:95], v7 offset:9216
    v_mfma_f32_16x16x32_bf16 v[176:179], a[40:43], a[12:15], 0
    ds_read_b64_tr_b16 a[96:97], v8 offset:8192
    s_add_u32 m0, s38, 19456
    v_mfma_f32_16x16x32_bf16 v[180:183], a[40:43], a[16:19], 0
    ds_read_b64_tr_b16 a[98:99], v8 offset:9216
    v_mfma_f32_16x16x32_bf16 v[184:187], a[44:47], a[0:3], 0
    ds_read_b64_tr_b16 a[100:101], v9 offset:8192
    v_mfma_f32_16x16x32_bf16 v[188:191], a[44:47], a[4:7], 0
    buffer_load_dwordx4 v227, s[8:11], s40 offen lds
    v_mfma_f32_16x16x32_bf16 v[192:195], a[44:47], a[8:11], 0
    ds_read_b64_tr_b16 a[102:103], v9 offset:9216
    v_mfma_f32_16x16x32_bf16 v[196:199], a[44:47], a[12:15], 0
    s_add_u32 s40, s40, 0x40000
    v_mfma_f32_16x16x32_bf16 v[200:203], a[44:47], a[16:19], 0
    s_add_u32 m0, s38, 0
    s_nop 0
    buffer_load_dwordx4 v224, s[8:11], s40 offen lds
    v_mfma_f32_16x16x32_bf16 v[204:207], a[48:51], a[0:3], 0
    s_add_u32 m0, s38, 1024
    v_mfma_f32_16x16x32_bf16 v[208:211], a[48:51], a[4:7], 0
    buffer_load_dwordx4 v225, s[8:11], s40 offen lds
    v_mfma_f32_16x16x32_bf16 v[212:215], a[48:51], a[8:11], 0
    s_add_u32 m0, s38, 2048
    v_mfma_f32_16x16x32_bf16 v[216:219], a[48:51], a[12:15], 0
    buffer_load_dwordx4 v226, s[8:11], s40 offen lds
    v_mfma_f32_16x16x32_bf16 v[220:223], a[48:51], a[16:19], 0
    s_add_u32 m0, s38, 3072
    s_nop 0
    buffer_load_dwordx4 v227, s[8:11], s40 offen lds
    s_waitcnt lgkmcnt(0)
    v_mfma_f32_16x16x32_bf16 v[64:67], a[72:75], a[52:55], v[64:67]
    v_mfma_f32_16x16x32_bf16 v[68:71], a[72:75], a[56:59], v[68:71]
    v_mfma_f32_16x16x32_bf16 v[72:75], a[72:75], a[60:63], v[72:75]
    v_mfma_f32_16x16x32_bf16 v[76:79], a[72:75], a[64:67], v[76:79]
    v_mfma_f32_16x16x32_bf16 v[80:83], a[72:75], a[68:71], v[80:83]
    v_mfma_f32_16x16x32_bf16 v[84:87], a[76:79], a[52:55], v[84:87]
    s_waitcnt vmcnt(4)
    s_barrier
    v_mfma_f32_16x16x32_bf16 v[88:91], a[76:79], a[56:59], v[88:91]
    ds_read_b128 a[0:3], v1 offset:0
    v_mfma_f32_16x16x32_bf16 v[92:95], a[76:79], a[60:63], v[92:95]
    ds_read_b64_tr_b16 a[20:21], v2 offset:16384
    v_mfma_f32_16x16x32_bf16 v[96:99], a[76:79], a[64:67], v[96:99]
    s_add_u32 s40, s63, 2
    s_cmp_ge_u32 s40, 9
    s_cselect_b32 s55, 9, 0
    s_sub_u32 s40, s40, s55
    v_mfma_f32_16x16x32_bf16 v[100:103], a[76:79], a[68:71], v[100:103]
    ds_read_b64_tr_b16 a[22:23], v2 offset:17408
    ds_read_b128 a[4:7], v1 offset:2048
    v_mfma_f32_16x16x32_bf16 v[104:107], a[80:83], a[52:55], v[104:107]
    s_lshl_b32 s40, s40, 19
    v_mfma_f32_16x16x32_bf16 v[108:111], a[80:83], a[56:59], v[108:111]
    ds_read_b128 a[8:11], v1 offset:4096
    v_mfma_f32_16x16x32_bf16 v[112:115], a[80:83], a[60:63], v[112:115]
    ds_read_b128 a[12:15], v1 offset:6144
    v_mfma_f32_16x16x32_bf16 v[116:119], a[80:83], a[64:67], v[116:119]
    s_add_u32 m0, s38, 8192
    ds_read_b128 a[16:19], v1 offset:8192
    v_mfma_f32_16x16x32_bf16 v[120:123], a[80:83], a[68:71], v[120:123]
    ds_read_b64_tr_b16 a[24:25], v3 offset:16384
    v_mfma_f32_16x16x32_bf16 v[124:127], a[84:87], a[52:55], v[124:127]
    buffer_load_dwordx4 v224, s[8:11], s40 offen lds
    v_mfma_f32_16x16x32_bf16 v[128:131], a[84:87], a[56:59], v[128:131]
    ds_read_b64_tr_b16 a[26:27], v3 offset:17408
    v_mfma_f32_16x16x32_bf16 v[132:135], a[84:87], a[60:63], v[132:135]
    ds_read_b64_tr_b16 a[28:29], v4 offset:16384
    s_add_u32 m0, s38, 9216
    v_mfma_f32_16x16x32_bf16 v[136:139], a[84:87], a[64:67], v[136:139]
    ds_read_b64_tr_b16 a[30:31], v4 offset:17408
    v_mfma_f32_16x16x32_bf16 v[140:143], a[84:87], a[68:71], v[140:143]
    ds_read_b64_tr_b16 a[32:33], v5 offset:16384
    v_mfma_f32_16x16x32_bf16 v[144:147], a[88:91], a[52:55], v[144:147]
    buffer_load_dwordx4 v225, s[8:11], s40 offen lds
    v_mfma_f32_16x16x32_bf16 v[148:151], a[88:91], a[56:59], v[148:151]
    ds_read_b64_tr_b16 a[34:35], v5 offset:17408
    ds_read_b64_tr_b16 a[36:37], v6 offset:16384
    v_mfma_f32_16x16x32_bf16 v[152:155], a[88:91], a[60:63], v[152:155]
    s_add_u32 m0, s38, 10240
    v_mfma_f32_16x16x32_bf16 v[156:159], a[88:91], a[64:67], v[156:159]
    ds_read_b64_tr_b16 a[38:39], v6 offset:17408
    v_mfma_f32_16x16x32_bf16 v[160:163], a[88:91], a[68:71], v[160:163]
    ds_read_b64_tr_b16 a[40:41], v7 offset:16384
    buffer_load_dwordx4 v226, s[8:11], s40 offen lds
    v_mfma_f32_16x16x32_bf16 v[164:167], a[92:95], a[52:55], v[164:167]
    ds_read_b64_tr_b16 a[42:43], v7 offset:17408
    v_mfma_f32_16x16x32_bf16 v[168:171], a[92:95], a[56:59], v[168:171]
    ds_read_b64_tr_b16 a[44:45], v8 offset:16384
    v_mfma_f32_16x16x32_bf16 v[172:175], a[92:95], a[60:63], v[172:175]
    s_add_u32 m0, s38, 11264
    v_mfma_f32_16x16x32_bf16 v[176:179], a[92:95], a[64:67], v[176:179]
    ds_read_b64_tr_b16 a[46:47], v8 offset:17408
    ds_read_b64_tr_b16 a[48:49], v9 offset:16384
    v_mfma_f32_16x16x32_bf16 v[180:183], a[92:95], a[68:71], v[180:183]
    buffer_load_dwordx4 v227, s[8:11], s40 offen lds
    v_mfma_f32_16x16x32_bf16 v[184:187], a[96:99], a[52:55], v[184:187]
    ds_read_b64_tr_b16 a[50:51], v9 offset:17408
    v_mfma_f32_16x16x32_bf16 v[188:191], a[96:99], a[56:59], v[188:191]
    s_add_u32 s39, s63, 2
    s_cmp_ge_u32 s39, 9
    s_cselect_b32 s55, 9, 0
    s_sub_u32 s39, s39, s55
    v_mfma_f32_16x16x32_bf16 v[192:195], a[96:99], a[60:63], v[192:195]
    s_lshl_b32 s39, s39, 7
    s_add_u32 m0, s34, 10240
    v_mfma_f32_16x16x32_bf16 v[196:199], a[96:99], a[64:67], v[196:199]
    buffer_load_dwordx4 v228, s[4:7], s39 offen lds
    v_mfma_f32_16x16x32_bf16 v[200:203], a[96:99], a[68:71], v[200:203]
    s_add_u32 m0, s34, 11264
    v_mfma_f32_16x16x32_bf16 v[204:207], a[100:103], a[52:55], v[204:207]
    buffer_load_dwordx4 v229, s[4:7], s39 offen lds
    v_mfma_f32_16x16x32_bf16 v[208:211], a[100:103], a[56:59], v[208:211]
    s_add_u32 m0, s34, 12288
    s_nop 0
    buffer_load_dwordx4 v230, s[4:7], s39 offen lds
    v_mfma_f32_16x16x32_bf16 v[212:215], a[100:103], a[60:63], v[212:215]
    s_add_u32 m0, s34, 13312
    v_mfma_f32_16x16x32_bf16 v[216:219], a[100:103], a[64:67], v[216:219]
    buffer_load_dwordx4 v231, s[4:7], s39 offen lds
    v_mfma_f32_16x16x32_bf16 v[220:223], a[100:103], a[68:71], v[220:223]
    s_add_u32 m0, s34, 14336
    s_nop 0
    buffer_load_dwordx4 v232, s[4:7], s39 offen lds
    s_waitcnt lgkmcnt(0)
    v_mfma_f32_16x16x32_bf16 v[64:67], a[20:23], a[0:3], v[64:67]
    v_mfma_f32_16x16x32_bf16 v[68:71], a[20:23], a[4:7], v[68:71]
    v_mfma_f32_16x16x32_bf16 v[72:75], a[20:23], a[8:11], v[72:75]
    v_mfma_f32_16x16x32_bf16 v[76:79], a[20:23], a[12:15], v[76:79]
    v_mfma_f32_16x16x32_bf16 v[80:83], a[20:23], a[16:19], v[80:83]
    v_mfma_f32_16x16x32_bf16 v[84:87], a[24:27], a[0:3], v[84:87]
    s_waitcnt vmcnt(9)
    s_barrier
    v_mfma_f32_16x16x32_bf16 v[88:91], a[24:27], a[4:7], v[88:91]
    v_mfma_f32_16x16x32_bf16 v[92:95], a[24:27], a[8:11], v[92:95]
    ds_read_b128 a[52:55], v233 offset:0
    v_mfma_f32_16x16x32_bf16 v[96:99], a[24:27], a[12:15], v[96:99]
    ds_read_b64_tr_b16 a[72:73], v2 offset:0
    v_mfma_f32_16x16x32_bf16 v[100:103], a[24:27], a[16:19], v[100:103]
    s_add_u32 s40, s40, 0x40000
    v_mfma_f32_16x16x32_bf16 v[104:107], a[28:31], a[0:3], v[104:107]
    ds_read_b64_tr_b16 a[74:75], v2 offset:1024
    v_mfma_f32_16x16x32_bf16 v[108:111], a[28:31], a[4:7], v[108:111]
    ds_read_b128 a[56:59], v233 offset:2048
    v_mfma_f32_16x16x32_bf16 v[112:115], a[28:31], a[8:11], v[112:115]
    s_add_u32 m0, s38, 16384
    v_mfma_f32_16x16x32_bf16 v[116:119], a[28:31], a[12:15], v[116:119]
    ds_read_b128 a[60:63], v233 offset:4096
    v_mfma_f32_16x16x32_bf16 v[120:123], a[28:31], a[16:19], v[120:123]
    v_mfma_f32_16x16x32_bf16 v[124:127], a[32:35], a[0:3], v[124:127]
    ds_read_b128 a[64:67], v233 offset:6144
    v_mfma_f32_16x16x32_bf16 v[128:131], a[32:35], a[4:7], v[128:131]
    buffer_load_dwordx4 v224, s[8:11], s40 offen lds
    v_mfma_f32_16x16x32_bf16 v[132:135], a[32:35], a[8:11], v[132:135]
    ds_read_b128 a[68:71], v233 offset:8192
    v_mfma_f32_16x16x32_bf16 v[136:139], a[32:35], a[12:15], v[136:139]
    ds_read_b64_tr_b16 a[76:77], v3 offset:0
    v_mfma_f32_16x16x32_bf16 v[140:143], a[32:35], a[16:19], v[140:143]
    s_add_u32 m0, s38, 17408
    v_mfma_f32_16x16x32_bf16 v[144:147], a[36:39], a[0:3], v[144:147]
    ds_read_b64_tr_b16 a[78:79], v3 offset:1024
    v_mfma_f32_16x16x32_bf16 v[148:151], a[36:39], a[4:7], v[148:151]
    ds_read_b64_tr_b16 a[80:81], v4 offset:0
    v_mfma_f32_16x16x32_bf16 v[152:155], a[36:39], a[8:11], v[152:155]
    buffer_load_dwordx4 v225, s[8:11], s40 offen lds
    v_mfma_f32_16x16x32_bf16 v[156:159], a[36:39], a[12:15], v[156:159]
    v_mfma_f32_16x16x32_bf16 v[160:163], a[36:39], a[16:19], v[160:163]
    ds_read_b64_tr_b16 a[82:83], v4 offset:1024
    v_mfma_f32_16x16x32_bf16 v[164:167], a[40:43], a[0:3], v[164:167]
    ds_read_b64_tr_b16 a[84:85], v5 offset:0
    v_mfma_f32_16x16x32_bf16 v[168:171], a[40:43], a[4:7], v[168:171]
    s_add_u32 m0, s38, 18432
    v_mfma_f32_16x16x32_bf16 v[172:175], a[40:43], a[8:11], v[172:175]
    ds_read_b64_tr_b16 a[86:87], v5 offset:1024
    v_mfma_f32_16x16x32_bf16 v[176:179], a[40:43], a[12:15], v[176:179]
    ds_read_b64_tr_b16 a[88:89], v6 offset:0
    v_mfma_f32_16x16x32_bf16 v[180:183], a[40:43], a[16:19], v[180:183]
    buffer_load_dwordx4 v226, s[8:11], s40 offen lds
    v_mfma_f32_16x16x32_bf16 v[184:187], a[44:47], a[0:3], v[184:187]
    ds_read_b64_tr_b16 a[90:91], v6 offset:1024
    v_mfma_f32_16x16x32_bf16 v[188:191], a[44:47], a[4:7], v[188:191]
    v_mfma_f32_16x16x32_bf16 v[192:195], a[44:47], a[8:11], v[192:195]
    ds_read_b64_tr_b16 a[92:93], v7 offset:0
    v_mfma_f32_16x16x32_bf16 v[196:199], a[44:47], a[12:15], v[196:199]
    s_add_u32 m0, s38, 19456
    v_mfma_f32_16x16x32_bf16 v[200:203], a[44:47], a[16:19], v[200:203]
    ds_read_b64_tr_b16 a[94:95], v7 offset:1024
    v_mfma_f32_16x16x32_bf16 v[204:207], a[48:51], a[0:3], v[204:207]
    ds_read_b64_tr_b16 a[96:97], v8 offset:0
    v_mfma_f32_16x16x32_bf16 v[208:211], a[48:51], a[4:7], v[208:211]
    buffer_load_dwordx4 v227, s[8:11], s40 offen lds
    v_mfma_f32_16x16x32_bf16 v[212:215], a[48:51], a[8:11], v[212:215]
    ds_read_b64_tr_b16 a[98:99], v8 offset:1024
    v_mfma_f32_16x16x32_bf16 v[216:219], a[48:51], a[12:15], v[216:219]
    ds_read_b64_tr_b16 a[100:101], v9 offset:0
    v_mfma_f32_16x16x32_bf16 v[220:223], a[48:51], a[16:19], v[220:223]
    ds_read_b64_tr_b16 a[102:103], v9 offset:1024
    s_waitcnt lgkmcnt(0)
    v_mfma_f32_16x16x32_bf16 v[64:67], a[72:75], a[52:55], v[64:67]
    v_mfma_f32_16x16x32_bf16 v[68:71], a[72:75], a[56:59], v[68:71]
    v_mfma_f32_16x16x32_bf16 v[72:75], a[72:75], a[60:63], v[72:75]
    v_mfma_f32_16x16x32_bf16 v[76:79], a[72:75], a[64:67], v[76:79]
    v_mfma_f32_16x16x32_bf16 v[80:83], a[72:75], a[68:71], v[80:83]
    v_mfma_f32_16x16x32_bf16 v[84:87], a[76:79], a[52:55], v[84:87]
    s_waitcnt vmcnt(4)
    s_barrier
    v_mfma_f32_16x16x32_bf16 v[88:91], a[76:79], a[56:59], v[88:91]
    ds_read_b128 a[0:3], v1 offset:10240
    v_mfma_f32_16x16x32_bf16 v[92:95], a[76:79], a[60:63], v[92:95]
    ds_read_b64_tr_b16 a[20:21], v2 offset:8192
    v_mfma_f32_16x16x32_bf16 v[96:99], a[76:79], a[64:67], v[96:99]
    s_add_u32 s40, s63, 3
    s_cmp_ge_u32 s40, 9
    s_cselect_b32 s55, 9, 0
    s_sub_u32 s40, s40, s55
    v_mfma_f32_16x16x32_bf16 v[100:103], a[76:79], a[68:71], v[100:103]
    ds_read_b64_tr_b16 a[22:23], v2 offset:9216
    ds_read_b128 a[4:7], v1 offset:12288
    v_mfma_f32_16x16x32_bf16 v[104:107], a[80:83], a[52:55], v[104:107]
    s_lshl_b32 s40, s40, 19
    v_mfma_f32_16x16x32_bf16 v[108:111], a[80:83], a[56:59], v[108:111]
    ds_read_b128 a[8:11], v1 offset:14336
    v_mfma_f32_16x16x32_bf16 v[112:115], a[80:83], a[60:63], v[112:115]
    ds_read_b128 a[12:15], v1 offset:16384
    v_mfma_f32_16x16x32_bf16 v[116:119], a[80:83], a[64:67], v[116:119]
    s_add_u32 m0, s38, 0
    ds_read_b128 a[16:19], v1 offset:18432
    v_mfma_f32_16x16x32_bf16 v[120:123], a[80:83], a[68:71], v[120:123]
    ds_read_b64_tr_b16 a[24:25], v3 offset:8192
    v_mfma_f32_16x16x32_bf16 v[124:127], a[84:87], a[52:55], v[124:127]
    buffer_load_dwordx4 v224, s[8:11], s40 offen lds
    v_mfma_f32_16x16x32_bf16 v[128:131], a[84:87], a[56:59], v[128:131]
    ds_read_b64_tr_b16 a[26:27], v3 offset:9216
    v_mfma_f32_16x16x32_bf16 v[132:135], a[84:87], a[60:63], v[132:135]
    ds_read_b64_tr_b16 a[28:29], v4 offset:8192
    s_add_u32 m0, s38, 1024
    v_mfma_f32_16x16x32_bf16 v[136:139], a[84:87], a[64:67], v[136:139]
    ds_read_b64_tr_b16 a[30:31], v4 offset:9216
    v_mfma_f32_16x16x32_bf16 v[140:143], a[84:87], a[68:71], v[140:143]
    ds_read_b64_tr_b16 a[32:33], v5 offset:8192
    v_mfma_f32_16x16x32_bf16 v[144:147], a[88:91], a[52:55], v[144:147]
    buffer_load_dwordx4 v225, s[8:11], s40 offen lds
    v_mfma_f32_16x16x32_bf16 v[148:151], a[88:91], a[56:59], v[148:151]
    ds_read_b64_tr_b16 a[34:35], v5 offset:9216
    ds_read_b64_tr_b16 a[36:37], v6 offset:8192
    v_mfma_f32_16x16x32_bf16 v[152:155], a[88:91], a[60:63], v[152:155]
    s_add_u32 m0, s38, 2048
    v_mfma_f32_16x16x32_bf16 v[156:159], a[88:91], a[64:67], v[156:159]
    ds_read_b64_tr_b16 a[38:39], v6 offset:9216
    v_mfma_f32_16x16x32_bf16 v[160:163], a[88:91], a[68:71], v[160:163]
    ds_read_b64_tr_b16 a[40:41], v7 offset:8192
    buffer_load_dwordx4 v226, s[8:11], s40 offen lds
    v_mfma_f32_16x16x32_bf16 v[164:167], a[92:95], a[52:55], v[164:167]
    ds_read_b64_tr_b16 a[42:43], v7 offset:9216
    v_mfma_f32_16x16x32_bf16 v[168:171], a[92:95], a[56:59], v[168:171]
    ds_read_b64_tr_b16 a[44:45], v8 offset:8192
    v_mfma_f32_16x16x32_bf16 v[172:175], a[92:95], a[60:63], v[172:175]
    s_add_u32 m0, s38, 3072
    v_mfma_f32_16x16x32_bf16 v[176:179], a[92:95], a[64:67], v[176:179]
    ds_read_b64_tr_b16 a[46:47], v8 offset:9216
    ds_read_b64_tr_b16 a[48:49], v9 offset:8192
    v_mfma_f32_16x16x32_bf16 v[180:183], a[92:95], a[68:71], v[180:183]
    buffer_load_dwordx4 v227, s[8:11], s40 offen lds
    v_mfma_f32_16x16x32_bf16 v[184:187], a[96:99], a[52:55], v[184:187]
    ds_read_b64_tr_b16 a[50:51], v9 offset:9216
    v_mfma_f32_16x16x32_bf16 v[188:191], a[96:99], a[56:59], v[188:191]
    s_add_u32 s39, s63, 3
    s_cmp_ge_u32 s39, 9
    s_cselect_b32 s55, 9, 0
    s_sub_u32 s39, s39, s55
    v_mfma_f32_16x16x32_bf16 v[192:195], a[96:99], a[60:63], v[192:195]
    s_lshl_b32 s39, s39, 7
    s_add_u32 m0, s34, 0
    v_mfma_f32_16x16x32_bf16 v[196:199], a[96:99], a[64:67], v[196:199]
    buffer_load_dwordx4 v228, s[4:7], s39 offen lds
    v_mfma_f32_16x16x32_bf16 v[200:203], a[96:99], a[68:71], v[200:203]
    s_add_u32 m0, s34, 1024
    v_mfma_f32_16x16x32_bf16 v[204:207], a[100:103], a[52:55], v[204:207]
    buffer_load_dwordx4 v229, s[4:7], s39 offen lds
    v_mfma_f32_16x16x32_bf16 v[208:211], a[100:103], a[56:59], v[208:211]
    s_add_u32 m0, s34, 2048
    s_nop 0
    buffer_load_dwordx4 v230, s[4:7], s39 offen lds
    v_mfma_f32_16x16x32_bf16 v[212:215], a[100:103], a[60:63], v[212:215]
    s_add_u32 m0, s34, 3072
    v_mfma_f32_16x16x32_bf16 v[216:219], a[100:103], a[64:67], v[216:219]
    buffer_load_dwordx4 v231, s[4:7], s39 offen lds
    v_mfma_f32_16x16x32_bf16 v[220:223], a[100:103], a[68:71], v[220:223]
    s_add_u32 m0, s34, 4096
    s_nop 0
    buffer_load_dwordx4 v232, s[4:7], s39 offen lds
    s_waitcnt lgkmcnt(0)
    v_mfma_f32_16x16x32_bf16 v[64:67], a[20:23], a[0:3], v[64:67]
    v_mfma_f32_16x16x32_bf16 v[68:71], a[20:23], a[4:7], v[68:71]
    v_mfma_f32_16x16x32_bf16 v[72:75], a[20:23], a[8:11], v[72:75]
    v_mfma_f32_16x16x32_bf16 v[76:79], a[20:23], a[12:15], v[76:79]
    v_mfma_f32_16x16x32_bf16 v[80:83], a[20:23], a[16:19], v[80:83]
    v_mfma_f32_16x16x32_bf16 v[84:87], a[24:27], a[0:3], v[84:87]
    s_waitcnt vmcnt(9)
    s_barrier
    v_mfma_f32_16x16x32_bf16 v[88:91], a[24:27], a[4:7], v[88:91]
    v_mfma_f32_16x16x32_bf16 v[92:95], a[24:27], a[8:11], v[92:95]
    ds_read_b128 a[52:55], v233 offset:10240
    v_mfma_f32_16x16x32_bf16 v[96:99], a[24:27], a[12:15], v[96:99]
    ds_read_b64_tr_b16 a[72:73], v2 offset:16384
    v_mfma_f32_16x16x32_bf16 v[100:103], a[24:27], a[16:19], v[100:103]
    s_add_u32 s40, s40, 0x40000
    v_mfma_f32_16x16x32_bf16 v[104:107], a[28:31], a[0:3], v[104:107]
    ds_read_b64_tr_b16 a[74:75], v2 offset:17408
    v_mfma_f32_16x16x32_bf16 v[108:111], a[28:31], a[4:7], v[108:111]
    ds_read_b128 a[56:59], v233 offset:12288
    v_mfma_f32_16x16x32_bf16 v[112:115], a[28:31], a[8:11], v[112:115]
    s_add_u32 m0, s38, 8192
    v_mfma_f32_16x16x32_bf16 v[116:119], a[28:31], a[12:15], v[116:119]
    ds_read_b128 a[60:63], v233 offset:14336
    v_mfma_f32_16x16x32_bf16 v[120:123], a[28:31], a[16:19], v[120:123]
    v_mfma_f32_16x16x32_bf16 v[124:127], a[32:35], a[0:3], v[124:127]
    ds_read_b128 a[64:67], v233 offset:16384
    v_mfma_f32_16x16x32_bf16 v[128:131], a[32:35], a[4:7], v[128:131]
    buffer_load_dwordx4 v224, s[8:11], s40 offen lds
    v_mfma_f32_16x16x32_bf16 v[132:135], a[32:35], a[8:11], v[132:135]
    ds_read_b128 a[68:71], v233 offset:18432
    v_mfma_f32_16x16x32_bf16 v[136:139], a[32:35], a[12:15], v[136:139]
    ds_read_b64_tr_b16 a[76:77], v3 offset:16384
    v_mfma_f32_16x16x32_bf16 v[140:143], a[32:35], a[16:19], v[140:143]
    s_add_u32 m0, s38, 9216
    v_mfma_f32_16x16x32_bf16 v[144:147], a[36:39], a[0:3], v[144:147]
    ds_read_b64_tr_b16 a[78:79], v3 offset:17408
    v_mfma_f32_16x16x32_bf16 v[148:151], a[36:39], a[4:7], v[148:151]
    ds_read_b64_tr_b16 a[80:81], v4 offset:16384
    v_mfma_f32_16x16x32_bf16 v[152:155], a[36:39], a[8:11], v[152:155]
    buffer_load_dwordx4 v225, s[8:11], s40 offen lds
    v_mfma_f32_16x16x32_bf16 v[156:159], a[36:39], a[12:15], v[156:159]
    v_mfma_f32_16x16x32_bf16 v[160:163], a[36:39], a[16:19], v[160:163]
    ds_read_b64_tr_b16 a[82:83], v4 offset:17408
    v_mfma_f32_16x16x32_bf16 v[164:167], a[40:43], a[0:3], v[164:167]
    ds_read_b64_tr_b16 a[84:85], v5 offset:16384
    v_mfma_f32_16x16x32_bf16 v[168:171], a[40:43], a[4:7], v[168:171]
    s_add_u32 m0, s38, 10240
    v_mfma_f32_16x16x32_bf16 v[172:175], a[40:43], a[8:11], v[172:175]
    ds_read_b64_tr_b16 a[86:87], v5 offset:17408
    v_mfma_f32_16x16x32_bf16 v[176:179], a[40:43], a[12:15], v[176:179]
    ds_read_b64_tr_b16 a[88:89], v6 offset:16384
    v_mfma_f32_16x16x32_bf16 v[180:183], a[40:43], a[16:19], v[180:183]
    buffer_load_dwordx4 v226, s[8:11], s40 offen lds
    v_mfma_f32_16x16x32_bf16 v[184:187], a[44:47], a[0:3], v[184:187]
    ds_read_b64_tr_b16 a[90:91], v6 offset:17408
    v_mfma_f32_16x16x32_bf16 v[188:191], a[44:47], a[4:7], v[188:191]
    v_mfma_f32_16x16x32_bf16 v[192:195], a[44:47], a[8:11], v[192:195]
    ds_read_b64_tr_b16 a[92:93], v7 offset:16384
    v_mfma_f32_16x16x32_bf16 v[196:199], a[44:47], a[12:15], v[196:199]
    s_add_u32 m0, s38, 11264
    v_mfma_f32_16x16x32_bf16 v[200:203], a[44:47], a[16:19], v[200:203]
    ds_read_b64_tr_b16 a[94:95], v7 offset:17408
    v_mfma_f32_16x16x32_bf16 v[204:207], a[48:51], a[0:3], v[204:207]
    ds_read_b64_tr_b16 a[96:97], v8 offset:16384
    v_mfma_f32_16x16x32_bf16 v[208:211], a[48:51], a[4:7], v[208:211]
    buffer_load_dwordx4 v227, s[8:11], s40 offen lds
    v_mfma_f32_16x16x32_bf16 v[212:215], a[48:51], a[8:11], v[212:215]
    ds_read_b64_tr_b16 a[98:99], v8 offset:17408
    v_mfma_f32_16x16x32_bf16 v[216:219], a[48:51], a[12:15], v[216:219]
    ds_read_b64_tr_b16 a[100:101], v9 offset:16384
    v_mfma_f32_16x16x32_bf16 v[220:223], a[48:51], a[16:19], v[220:223]
    ds_read_b64_tr_b16 a[102:103], v9 offset:17408
    s_waitcnt lgkmcnt(0)
    v_mfma_f32_16x16x32_bf16 v[64:67], a[72:75], a[52:55], v[64:67]
    v_mfma_f32_16x16x32_bf16 v[68:71], a[72:75], a[56:59], v[68:71]
    v_mfma_f32_16x16x32_bf16 v[72:75], a[72:75], a[60:63], v[72:75]
    v_mfma_f32_16x16x32_bf16 v[76:79], a[72:75], a[64:67], v[76:79]
    v_mfma_f32_16x16x32_bf16 v[80:83], a[72:75], a[68:71], v[80:83]
    v_mfma_f32_16x16x32_bf16 v[84:87], a[76:79], a[52:55], v[84:87]
    s_waitcnt vmcnt(4)
    s_barrier
    v_mfma_f32_16x16x32_bf16 v[88:91], a[76:79], a[56:59], v[88:91]
    ds_read_b128 a[0:3], v1 offset:0
    v_mfma_f32_16x16x32_bf16 v[92:95], a[76:79], a[60:63], v[92:95]
    ds_read_b64_tr_b16 a[20:21], v2 offset:0
    v_mfma_f32_16x16x32_bf16 v[96:99], a[76:79], a[64:67], v[96:99]
    s_add_u32 s40, s63, 4
    s_cmp_ge_u32 s40, 9
    s_cselect_b32 s55, 9, 0
    s_sub_u32 s40, s40, s55
    v_mfma_f32_16x16x32_bf16 v[100:103], a[76:79], a[68:71], v[100:103]
    ds_read_b64_tr_b16 a[22:23], v2 offset:1024
    ds_read_b128 a[4:7], v1 offset:2048
    v_mfma_f32_16x16x32_bf16 v[104:107], a[80:83], a[52:55], v[104:107]
    s_lshl_b32 s40, s40, 19
    v_mfma_f32_16x16x32_bf16 v[108:111], a[80:83], a[56:59], v[108:111]
    ds_read_b128 a[8:11], v1 offset:4096
    v_mfma_f32_16x16x32_bf16 v[112:115], a[80:83], a[60:63], v[112:115]
    ds_read_b128 a[12:15], v1 offset:6144
    v_mfma_f32_16x16x32_bf16 v[116:119], a[80:83], a[64:67], v[116:119]
    s_add_u32 m0, s38, 16384
    ds_read_b128 a[16:19], v1 offset:8192
    v_mfma_f32_16x16x32_bf16 v[120:123], a[80:83], a[68:71], v[120:123]
    ds_read_b64_tr_b16 a[24:25], v3 offset:0
    v_mfma_f32_16x16x32_bf16 v[124:127], a[84:87], a[52:55], v[124:127]
    buffer_load_dwordx4 v224, s[8:11], s40 offen lds
    v_mfma_f32_16x16x32_bf16 v[128:131], a[84:87], a[56:59], v[128:131]
    ds_read_b64_tr_b16 a[26:27], v3 offset:1024
    v_mfma_f32_16x16x32_bf16 v[132:135], a[84:87], a[60:63], v[132:135]
    ds_read_b64_tr_b16 a[28:29], v4 offset:0
    s_add_u32 m0, s38, 17408
    v_mfma_f32_16x16x32_bf16 v[136:139], a[84:87], a[64:67], v[136:139]
    ds_read_b64_tr_b16 a[30:31], v4 offset:1024
    v_mfma_f32_16x16x32_bf16 v[140:143], a[84:87], a[68:71], v[140:143]
    ds_read_b64_tr_b16 a[32:33], v5 offset:0
    v_mfma_f32_16x16x32_bf16 v[144:147], a[88:91], a[52:55], v[144:147]
    buffer_load_dwordx4 v225, s[8:11], s40 offen lds
    v_mfma_f32_16x16x32_bf16 v[148:151], a[88:91], a[56:59], v[148:151]
    ds_read_b64_tr_b16 a[34:35], v5 offset:1024
    ds_read_b64_tr_b16 a[36:37], v6 offset:0
    v_mfma_f32_16x16x32_bf16 v[152:155], a[88:91], a[60:63], v[152:155]
    s_add_u32 m0, s38, 18432
    v_mfma_f32_16x16x32_bf16 v[156:159], a[88:91], a[64:67], v[156:159]
    ds_read_b64_tr_b16 a[38:39], v6 offset:1024
    v_mfma_f32_16x16x32_bf16 v[160:163], a[88:91], a[68:71], v[160:163]
    ds_read_b64_tr_b16 a[40:41], v7 offset:0
    buffer_load_dwordx4 v226, s[8:11], s40 offen lds
    v_mfma_f32_16x16x32_bf16 v[164:167], a[92:95], a[52:55], v[164:167]
    ds_read_b64_tr_b16 a[42:43], v7 offset:1024
    v_mfma_f32_16x16x32_bf16 v[168:171], a[92:95], a[56:59], v[168:171]
    ds_read_b64_tr_b16 a[44:45], v8 offset:0
    v_mfma_f32_16x16x32_bf16 v[172:175], a[92:95], a[60:63], v[172:175]
    s_add_u32 m0, s38, 19456
    v_mfma_f32_16x16x32_bf16 v[176:179], a[92:95], a[64:67], v[176:179]
    ds_read_b64_tr_b16 a[46:47], v8 offset:1024
    ds_read_b64_tr_b16 a[48:49], v9 offset:0
    v_mfma_f32_16x16x32_bf16 v[180:183], a[92:95], a[68:71], v[180:183]
    buffer_load_dwordx4 v227, s[8:11], s40 offen lds
    v_mfma_f32_16x16x32_bf16 v[184:187], a[96:99], a[52:55], v[184:187]
    ds_read_b64_tr_b16 a[50:51], v9 offset:1024
    v_mfma_f32_16x16x32_bf16 v[188:191], a[96:99], a[56:59], v[188:191]
    s_add_u32 s39, s63, 4
    s_cmp_ge_u32 s39, 9
    s_cselect_b32 s55, 9, 0
    s_sub_u32 s39, s39, s55
    v_mfma_f32_16x16x32_bf16 v[192:195], a[96:99], a[60:63], v[192:195]
    s_lshl_b32 s39, s39, 7
    s_add_u32 m0, s34, 10240
    v_mfma_f32_16x16x32_bf16 v[196:199], a[96:99], a[64:67], v[196:199]
    buffer_load_dwordx4 v228, s[4:7], s39 offen lds
    v_mfma_f32_16x16x32_bf16 v[200:203], a[96:99], a[68:71], v[200:203]
    s_add_u32 m0, s34, 11264
    v_mfma_f32_16x16x32_bf16 v[204:207], a[100:103], a[52:55], v[204:207]
    buffer_load_dwordx4 v229, s[4:7], s39 offen lds
    v_mfma_f32_16x16x32_bf16 v[208:211], a[100:103], a[56:59], v[208:211]
    s_add_u32 m0, s34, 12288
    s_nop 0
    buffer_load_dwordx4 v230, s[4:7], s39 offen lds
    v_mfma_f32_16x16x32_bf16 v[212:215], a[100:103], a[60:63], v[212:215]
    s_add_u32 m0, s34, 13312
    v_mfma_f32_16x16x32_bf16 v[216:219], a[100:103], a[64:67], v[216:219]
    buffer_load_dwordx4 v231, s[4:7], s39 offen lds
    v_mfma_f32_16x16x32_bf16 v[220:223], a[100:103], a[68:71], v[220:223]
    s_add_u32 m0, s34, 14336
    s_nop 0
    buffer_load_dwordx4 v232, s[4:7], s39 offen lds
    s_waitcnt lgkmcnt(0)
    v_mfma_f32_16x16x32_bf16 v[64:67], a[20:23], a[0:3], v[64:67]
    v_mfma_f32_16x16x32_bf16 v[68:71], a[20:23], a[4:7], v[68:71]
    v_mfma_f32_16x16x32_bf16 v[72:75], a[20:23], a[8:11], v[72:75]
    v_mfma_f32_16x16x32_bf16 v[76:79], a[20:23], a[12:15], v[76:79]
    v_mfma_f32_16x16x32_bf16 v[80:83], a[20:23], a[16:19], v[80:83]
    v_mfma_f32_16x16x32_bf16 v[84:87], a[24:27], a[0:3], v[84:87]
    s_waitcnt vmcnt(9)
    s_barrier
    v_mfma_f32_16x16x32_bf16 v[88:91], a[24:27], a[4:7], v[88:91]
    v_mfma_f32_16x16x32_bf16 v[92:95], a[24:27], a[8:11], v[92:95]
    ds_read_b128 a[52:55], v233 offset:0
    v_mfma_f32_16x16x32_bf16 v[96:99], a[24:27], a[12:15], v[96:99]
    ds_read_b64_tr_b16 a[72:73], v2 offset:8192
    v_mfma_f32_16x16x32_bf16 v[100:103], a[24:27], a[16:19], v[100:103]
    s_add_u32 s40, s40, 0x40000
    v_mfma_f32_16x16x32_bf16 v[104:107], a[28:31], a[0:3], v[104:107]
    ds_read_b64_tr_b16 a[74:75], v2 offset:9216
    v_mfma_f32_16x16x32_bf16 v[108:111], a[28:31], a[4:7], v[108:111]
    ds_read_b128 a[56:59], v233 offset:2048
    v_mfma_f32_16x16x32_bf16 v[112:115], a[28:31], a[8:11], v[112:115]
    s_add_u32 m0, s38, 0
    v_mfma_f32_16x16x32_bf16 v[116:119], a[28:31], a[12:15], v[116:119]
    ds_read_b128 a[60:63], v233 offset:4096
    v_mfma_f32_16x16x32_bf16 v[120:123], a[28:31], a[16:19], v[120:123]
    v_mfma_f32_16x16x32_bf16 v[124:127], a[32:35], a[0:3], v[124:127]
    ds_read_b128 a[64:67], v233 offset:6144
    v_mfma_f32_16x16x32_bf16 v[128:131], a[32:35], a[4:7], v[128:131]
    buffer_load_dwordx4 v224, s[8:11], s40 offen lds
    v_mfma_f32_16x16x32_bf16 v[132:135], a[32:35], a[8:11], v[132:135]
    ds_read_b128 a[68:71], v233 offset:8192
    v_mfma_f32_16x16x32_bf16 v[136:139], a[32:35], a[12:15], v[136:139]
    ds_read_b64_tr_b16 a[76:77], v3 offset:8192
    v_mfma_f32_16x16x32_bf16 v[140:143], a[32:35], a[16:19], v[140:143]
    s_add_u32 m0, s38, 1024
    v_mfma_f32_16x16x32_bf16 v[144:147], a[36:39], a[0:3], v[144:147]
    ds_read_b64_tr_b16 a[78:79], v3 offset:9216
    v_mfma_f32_16x16x32_bf16 v[148:151], a[36:39], a[4:7], v[148:151]
    ds_read_b64_tr_b16 a[80:81], v4 offset:8192
    v_mfma_f32_16x16x32_bf16 v[152:155], a[36:39], a[8:11], v[152:155]
    buffer_load_dwordx4 v225, s[8:11], s40 offen lds
    v_mfma_f32_16x16x32_bf16 v[156:159], a[36:39], a[12:15], v[156:159]
    v_mfma_f32_16x16x32_bf16 v[160:163], a[36:39], a[16:19], v[160:163]
    ds_read_b64_tr_b16 a[82:83], v4 offset:9216
    v_mfma_f32_16x16x32_bf16 v[164:167], a[40:43], a[0:3], v[164:167]
    ds_read_b64_tr_b16 a[84:85], v5 offset:8192
    v_mfma_f32_16x16x32_bf16 v[168:171], a[40:43], a[4:7], v[168:171]
    s_add_u32 m0, s38, 2048
    v_mfma_f32_16x16x32_bf16 v[172:175], a[40:43], a[8:11], v[172:175]
    ds_read_b64_tr_b16 a[86:87], v5 offset:9216
    v_mfma_f32_16x16x32_bf16 v[176:179], a[40:43], a[12:15], v[176:179]
    ds_read_b64_tr_b16 a[88:89], v6 offset:8192
    v_mfma_f32_16x16x32_bf16 v[180:183], a[40:43], a[16:19], v[180:183]
    buffer_load_dwordx4 v226, s[8:11], s40 offen lds
    v_mfma_f32_16x16x32_bf16 v[184:187], a[44:47], a[0:3], v[184:187]
    ds_read_b64_tr_b16 a[90:91], v6 offset:9216
    v_mfma_f32_16x16x32_bf16 v[188:191], a[44:47], a[4:7], v[188:191]
    v_mfma_f32_16x16x32_bf16 v[192:195], a[44:47], a[8:11], v[192:195]
    ds_read_b64_tr_b16 a[92:93], v7 offset:8192
    v_mfma_f32_16x16x32_bf16 v[196:199], a[44:47], a[12:15], v[196:199]
    s_add_u32 m0, s38, 3072
    v_mfma_f32_16x16x32_bf16 v[200:203], a[44:47], a[16:19], v[200:203]
    ds_read_b64_tr_b16 a[94:95], v7 offset:9216
    v_mfma_f32_16x16x32_bf16 v[204:207], a[48:51], a[0:3], v[204:207]
    ds_read_b64_tr_b16 a[96:97], v8 offset:8192
    v_mfma_f32_16x16x32_bf16 v[208:211], a[48:51], a[4:7], v[208:211]
    buffer_load_dwordx4 v227, s[8:11], s40 offen lds
    v_mfma_f32_16x16x32_bf16 v[212:215], a[48:51], a[8:11], v[212:215]
    ds_read_b64_tr_b16 a[98:99], v8 offset:9216
    v_mfma_f32_16x16x32_bf16 v[216:219], a[48:51], a[12:15], v[216:219]
    ds_read_b64_tr_b16 a[100:101], v9 offset:8192
    v_mfma_f32_16x16x32_bf16 v[220:223], a[48:51], a[16:19], v[220:223]
    ds_read_b64_tr_b16 a[102:103], v9 offset:9216
    s_waitcnt lgkmcnt(0)
    v_mfma_f32_16x16x32_bf16 v[64:67], a[72:75], a[52:55], v[64:67]
    v_mfma_f32_16x16x32_bf16 v[68:71], a[72:75], a[56:59], v[68:71]
    v_mfma_f32_16x16x32_bf16 v[72:75], a[72:75], a[60:63], v[72:75]
    v_mfma_f32_16x16x32_bf16 v[76:79], a[72:75], a[64:67], v[76:79]
    v_mfma_f32_16x16x32_bf16 v[80:83], a[72:75], a[68:71], v[80:83]
    v_mfma_f32_16x16x32_bf16 v[84:87], a[76:79], a[52:55], v[84:87]
    s_waitcnt vmcnt(4)
    s_barrier
    v_mfma_f32_16x16x32_bf16 v[88:91], a[76:79], a[56:59], v[88:91]
    ds_read_b128 a[0:3], v1 offset:10240
    v_mfma_f32_16x16x32_bf16 v[92:95], a[76:79], a[60:63], v[92:95]
    ds_read_b64_tr_b16 a[20:21], v2 offset:16384
    v_mfma_f32_16x16x32_bf16 v[96:99], a[76:79], a[64:67], v[96:99]
    s_add_u32 s40, s63, 5
    s_cmp_ge_u32 s40, 9
    s_cselect_b32 s55, 9, 0
    s_sub_u32 s40, s40, s55
    v_mfma_f32_16x16x32_bf16 v[100:103], a[76:79], a[68:71], v[100:103]
    ds_read_b64_tr_b16 a[22:23], v2 offset:17408
    ds_read_b128 a[4:7], v1 offset:12288
    v_mfma_f32_16x16x32_bf16 v[104:107], a[80:83], a[52:55], v[104:107]
    s_lshl_b32 s40, s40, 19
    v_mfma_f32_16x16x32_bf16 v[108:111], a[80:83], a[56:59], v[108:111]
    ds_read_b128 a[8:11], v1 offset:14336
    v_mfma_f32_16x16x32_bf16 v[112:115], a[80:83], a[60:63], v[112:115]
    ds_read_b128 a[12:15], v1 offset:16384
    v_mfma_f32_16x16x32_bf16 v[116:119], a[80:83], a[64:67], v[116:119]
    s_add_u32 m0, s38, 8192
    ds_read_b128 a[16:19], v1 offset:18432
    v_mfma_f32_16x16x32_bf16 v[120:123], a[80:83], a[68:71], v[120:123]
    ds_read_b64_tr_b16 a[24:25], v3 offset:16384
    v_mfma_f32_16x16x32_bf16 v[124:127], a[84:87], a[52:55], v[124:127]
    buffer_load_dwordx4 v224, s[8:11], s40 offen lds
    v_mfma_f32_16x16x32_bf16 v[128:131], a[84:87], a[56:59], v[128:131]
    ds_read_b64_tr_b16 a[26:27], v3 offset:17408
    v_mfma_f32_16x16x32_bf16 v[132:135], a[84:87], a[60:63], v[132:135]
    ds_read_b64_tr_b16 a[28:29], v4 offset:16384
    s_add_u32 m0, s38, 9216
    v_mfma_f32_16x16x32_bf16 v[136:139], a[84:87], a[64:67], v[136:139]
    ds_read_b64_tr_b16 a[30:31], v4 offset:17408
    v_mfma_f32_16x16x32_bf16 v[140:143], a[84:87], a[68:71], v[140:143]
    ds_read_b64_tr_b16 a[32:33], v5 offset:16384
    v_mfma_f32_16x16x32_bf16 v[144:147], a[88:91], a[52:55], v[144:147]
    buffer_load_dwordx4 v225, s[8:11], s40 offen lds
    v_mfma_f32_16x16x32_bf16 v[148:151], a[88:91], a[56:59], v[148:151]
    ds_read_b64_tr_b16 a[34:35], v5 offset:17408
    ds_read_b64_tr_b16 a[36:37], v6 offset:16384
    v_mfma_f32_16x16x32_bf16 v[152:155], a[88:91], a[60:63], v[152:155]
    s_add_u32 m0, s38, 10240
    v_mfma_f32_16x16x32_bf16 v[156:159], a[88:91], a[64:67], v[156:159]
    ds_read_b64_tr_b16 a[38:39], v6 offset:17408
    v_mfma_f32_16x16x32_bf16 v[160:163], a[88:91], a[68:71], v[160:163]
    ds_read_b64_tr_b16 a[40:41], v7 offset:16384
    buffer_load_dwordx4 v226, s[8:11], s40 offen lds
    v_mfma_f32_16x16x32_bf16 v[164:167], a[92:95], a[52:55], v[164:167]
    ds_read_b64_tr_b16 a[42:43], v7 offset:17408
    v_mfma_f32_16x16x32_bf16 v[168:171], a[92:95], a[56:59], v[168:171]
    ds_read_b64_tr_b16 a[44:45], v8 offset:16384
    v_mfma_f32_16x16x32_bf16 v[172:175], a[92:95], a[60:63], v[172:175]
    s_add_u32 m0, s38, 11264
    v_mfma_f32_16x16x32_bf16 v[176:179], a[92:95], a[64:67], v[176:179]
    ds_read_b64_tr_b16 a[46:47], v8 offset:17408
    ds_read_b64_tr_b16 a[48:49], v9 offset:16384
    v_mfma_f32_16x16x32_bf16 v[180:183], a[92:95], a[68:71], v[180:183]
    buffer_load_dwordx4 v227, s[8:11], s40 offen lds
    v_mfma_f32_16x16x32_bf16 v[184:187], a[96:99], a[52:55], v[184:187]
    ds_read_b64_tr_b16 a[50:51], v9 offset:17408
    v_mfma_f32_16x16x32_bf16 v[188:191], a[96:99], a[56:59], v[188:191]
    s_add_u32 s39, s63, 5
    s_cmp_ge_u32 s39, 9
    s_cselect_b32 s55, 9, 0
    s_sub_u32 s39, s39, s55
    v_mfma_f32_16x16x32_bf16 v[192:195], a[96:99], a[60:63], v[192:195]
    s_lshl_b32 s39, s39, 7
    s_add_u32 m0, s34, 0
    v_mfma_f32_16x16x32_bf16 v[196:199], a[96:99], a[64:67], v[196:199]
    buffer_load_dwordx4 v228, s[4:7], s39 offen lds
    v_mfma_f32_16x16x32_bf16 v[200:203], a[96:99], a[68:71], v[200:203]
    s_add_u32 m0, s34, 1024
    v_mfma_f32_16x16x32_bf16 v[204:207], a[100:103], a[52:55], v[204:207]
    buffer_load_dwordx4 v229, s[4:7], s39 offen lds
    v_mfma_f32_16x16x32_bf16 v[208:211], a[100:103], a[56:59], v[208:211]
    s_add_u32 m0, s34, 2048
    s_nop 0
    buffer_load_dwordx4 v230, s[4:7], s39 offen lds
    v_mfma_f32_16x16x32_bf16 v[212:215], a[100:103], a[60:63], v[212:215]
    s_add_u32 m0, s34, 3072
    v_mfma_f32_16x16x32_bf16 v[216:219], a[100:103], a[64:67], v[216:219]
    buffer_load_dwordx4 v231, s[4:7], s39 offen lds
    v_mfma_f32_16x16x32_bf16 v[220:223], a[100:103], a[68:71], v[220:223]
    s_add_u32 m0, s34, 4096
    s_nop 0
    buffer_load_dwordx4 v232, s[4:7], s39 offen lds
    s_waitcnt lgkmcnt(0)
    v_mfma_f32_16x16x32_bf16 v[64:67], a[20:23], a[0:3], v[64:67]
    v_mfma_f32_16x16x32_bf16 v[68:71], a[20:23], a[4:7], v[68:71]
    v_mfma_f32_16x16x32_bf16 v[72:75], a[20:23], a[8:11], v[72:75]
    v_mfma_f32_16x16x32_bf16 v[76:79], a[20:23], a[12:15], v[76:79]
    v_mfma_f32_16x16x32_bf16 v[80:83], a[20:23], a[16:19], v[80:83]
    v_mfma_f32_16x16x32_bf16 v[84:87], a[24:27], a[0:3], v[84:87]
    s_waitcnt vmcnt(9)
    s_barrier
    v_mfma_f32_16x16x32_bf16 v[88:91], a[24:27], a[4:7], v[88:91]
    v_mfma_f32_16x16x32_bf16 v[92:95], a[24:27], a[8:11], v[92:95]
    ds_read_b128 a[52:55], v233 offset:10240
    v_mfma_f32_16x16x32_bf16 v[96:99], a[24:27], a[12:15], v[96:99]
    ds_read_b64_tr_b16 a[72:73], v2 offset:0
    v_mfma_f32_16x16x32_bf16 v[100:103], a[24:27], a[16:19], v[100:103]
    s_add_u32 s40, s40, 0x40000
    v_mfma_f32_16x16x32_bf16 v[104:107], a[28:31], a[0:3], v[104:107]
    ds_read_b64_tr_b16 a[74:75], v2 offset:1024
    v_mfma_f32_16x16x32_bf16 v[108:111], a[28:31], a[4:7], v[108:111]
    ds_read_b128 a[56:59], v233 offset:12288
    v_mfma_f32_16x16x32_bf16 v[112:115], a[28:31], a[8:11], v[112:115]
    s_add_u32 m0, s38, 16384
    v_mfma_f32_16x16x32_bf16 v[116:119], a[28:31], a[12:15], v[116:119]
    ds_read_b128 a[60:63], v233 offset:14336
    v_mfma_f32_16x16x32_bf16 v[120:123], a[28:31], a[16:19], v[120:123]
    v_mfma_f32_16x16x32_bf16 v[124:127], a[32:35], a[0:3], v[124:127]
    ds_read_b128 a[64:67], v233 offset:16384
    v_mfma_f32_16x16x32_bf16 v[128:131], a[32:35], a[4:7], v[128:131]
    buffer_load_dwordx4 v224, s[8:11], s40 offen lds
    v_mfma_f32_16x16x32_bf16 v[132:135], a[32:35], a[8:11], v[132:135]
    ds_read_b128 a[68:71], v233 offset:18432
    v_mfma_f32_16x16x32_bf16 v[136:139], a[32:35], a[12:15], v[136:139]
    ds_read_b64_tr_b16 a[76:77], v3 offset:0
    v_mfma_f32_16x16x32_bf16 v[140:143], a[32:35], a[16:19], v[140:143]
    s_add_u32 m0, s38, 17408
    v_mfma_f32_16x16x32_bf16 v[144:147], a[36:39], a[0:3], v[144:147]
    ds_read_b64_tr_b16 a[78:79], v3 offset:1024
    v_mfma_f32_16x16x32_bf16 v[148:151], a[36:39], a[4:7], v[148:151]
    ds_read_b64_tr_b16 a[80:81], v4 offset:0
    v_mfma_f32_16x16x32_bf16 v[152:155], a[36:39], a[8:11], v[152:155]
    buffer_load_dwordx4 v225, s[8:11], s40 offen lds
    v_mfma_f32_16x16x32_bf16 v[156:159], a[36:39], a[12:15], v[156:159]
    v_mfma_f32_16x16x32_bf16 v[160:163], a[36:39], a[16:19], v[160:163]
    ds_read_b64_tr_b16 a[82:83], v4 offset:1024
    v_mfma_f32_16x16x32_bf16 v[164:167], a[40:43], a[0:3], v[164:167]
    ds_read_b64_tr_b16 a[84:85], v5 offset:0
    v_mfma_f32_16x16x32_bf16 v[168:171], a[40:43], a[4:7], v[168:171]
    s_add_u32 m0, s38, 18432
    v_mfma_f32_16x16x32_bf16 v[172:175], a[40:43], a[8:11], v[172:175]
    ds_read_b64_tr_b16 a[86:87], v5 offset:1024
    v_mfma_f32_16x16x32_bf16 v[176:179], a[40:43], a[12:15], v[176:179]
    ds_read_b64_tr_b16 a[88:89], v6 offset:0
    v_mfma_f32_16x16x32_bf16 v[180:183], a[40:43], a[16:19], v[180:183]
    buffer_load_dwordx4 v226, s[8:11], s40 offen lds
    v_mfma_f32_16x16x32_bf16 v[184:187], a[44:47], a[0:3], v[184:187]
    ds_read_b64_tr_b16 a[90:91], v6 offset:1024
    v_mfma_f32_16x16x32_bf16 v[188:191], a[44:47], a[4:7], v[188:191]
    v_mfma_f32_16x16x32_bf16 v[192:195], a[44:47], a[8:11], v[192:195]
    ds_read_b64_tr_b16 a[92:93], v7 offset:0
    v_mfma_f32_16x16x32_bf16 v[196:199], a[44:47], a[12:15], v[196:199]
    s_add_u32 m0, s38, 19456
    v_mfma_f32_16x16x32_bf16 v[200:203], a[44:47], a[16:19], v[200:203]
    ds_read_b64_tr_b16 a[94:95], v7 offset:1024
    v_mfma_f32_16x16x32_bf16 v[204:207], a[48:51], a[0:3], v[204:207]
    ds_read_b64_tr_b16 a[96:97], v8 offset:0
    v_mfma_f32_16x16x32_bf16 v[208:211], a[48:51], a[4:7], v[208:211]
    buffer_load_dwordx4 v227, s[8:11], s40 offen lds
    v_mfma_f32_16x16x32_bf16 v[212:215], a[48:51], a[8:11], v[212:215]
    ds_read_b64_tr_b16 a[98:99], v8 offset:1024
    v_mfma_f32_16x16x32_bf16 v[216:219], a[48:51], a[12:15], v[216:219]
    ds_read_b64_tr_b16 a[100:101], v9 offset:0
    v_mfma_f32_16x16x32_bf16 v[220:223], a[48:51], a[16:19], v[220:223]
    ds_read_b64_tr_b16 a[102:103], v9 offset:1024
    s_waitcnt lgkmcnt(0)
    v_mfma_f32_16x16x32_bf16 v[64:67], a[72:75], a[52:55], v[64:67]
    v_mfma_f32_16x16x32_bf16 v[68:71], a[72:75], a[56:59], v[68:71]
    v_mfma_f32_16x16x32_bf16 v[72:75], a[72:75], a[60:63], v[72:75]
    v_mfma_f32_16x16x32_bf16 v[76:79], a[72:75], a[64:67], v[76:79]
    v_mfma_f32_16x16x32_bf16 v[80:83], a[72:75], a[68:71], v[80:83]
    v_mfma_f32_16x16x32_bf16 v[84:87], a[76:79], a[52:55], v[84:87]
    s_waitcnt vmcnt(4)
    s_barrier
    v_mfma_f32_16x16x32_bf16 v[88:91], a[76:79], a[56:59], v[88:91]
    ds_read_b128 a[0:3], v1 offset:0
    v_mfma_f32_16x16x32_bf16 v[92:95], a[76:79], a[60:63], v[92:95]
    ds_read_b64_tr_b16 a[20:21], v2 offset:8192
    v_mfma_f32_16x16x32_bf16 v[96:99], a[76:79], a[64:67], v[96:99]
    s_add_u32 s40, s63, 6
    s_cmp_ge_u32 s40, 9
    s_cselect_b32 s55, 9, 0
    s_sub_u32 s40, s40, s55
    ds_read_b64_tr_b16 a[22:23], v2 offset:9216
    v_mfma_f32_16x16x32_bf16 v[100:103], a[76:79], a[68:71], v[100:103]
    ds_read_b128 a[4:7], v1 offset:2048
    v_mfma_f32_16x16x32_bf16 v[104:107], a[80:83], a[52:55], v[104:107]
    s_lshl_b32 s40, s40, 19
    ds_read_b128 a[8:11], v1 offset:4096
    v_mfma_f32_16x16x32_bf16 v[108:111], a[80:83], a[56:59], v[108:111]
    ds_read_b128 a[12:15], v1 offset:6144
    v_mfma_f32_16x16x32_bf16 v[112:115], a[80:83], a[60:63], v[112:115]
    s_add_u32 m0, s38, 0
    v_mfma_f32_16x16x32_bf16 v[116:119], a[80:83], a[64:67], v[116:119]
    ds_read_b128 a[16:19], v1 offset:8192
    ds_read_b64_tr_b16 a[24:25], v3 offset:8192
    v_mfma_f32_16x16x32_bf16 v[120:123], a[80:83], a[68:71], v[120:123]
    buffer_load_dwordx4 v224, s[8:11], s40 offen lds
    v_mfma_f32_16x16x32_bf16 v[124:127], a[84:87], a[52:55], v[124:127]
    ds_read_b64_tr_b16 a[26:27], v3 offset:9216
    ds_read_b64_tr_b16 a[28:29], v4 offset:8192
    v_mfma_f32_16x16x32_bf16 v[128:131], a[84:87], a[56:59], v[128:131]
    s_add_u32 m0, s38, 1024
    v_mfma_f32_16x16x32_bf16 v[132:135], a[84:87], a[60:63], v[132:135]
    ds_read_b64_tr_b16 a[30:31], v4 offset:9216
    v_mfma_f32_16x16x32_bf16 v[136:139], a[84:87], a[64:67], v[136:139]
    ds_read_b64_tr_b16 a[32:33], v5 offset:8192
    buffer_load_dwordx4 v225, s[8:11], s40 offen lds
    v_mfma_f32_16x16x32_bf16 v[140:143], a[84:87], a[68:71], v[140:143]
    ds_read_b64_tr_b16 a[34:35], v5 offset:9216
    v_mfma_f32_16x16x32_bf16 v[144:147], a[88:91], a[52:55], v[144:147]
    ds_read_b64_tr_b16 a[36:37], v6 offset:8192
    s_add_u32 m0, s38, 2048
    v_mfma_f32_16x16x32_bf16 v[148:151], a[88:91], a[56:59], v[148:151]
    ds_read_b64_tr_b16 a[38:39], v6 offset:9216
    v_mfma_f32_16x16x32_bf16 v[152:155], a[88:91], a[60:63], v[152:155]
    ds_read_b64_tr_b16 a[40:41], v7 offset:8192
    buffer_load_dwordx4 v226, s[8:11], s40 offen lds
    v_mfma_f32_16x16x32_bf16 v[156:159], a[88:91], a[64:67], v[156:159]
    ds_read_b64_tr_b16 a[42:43], v7 offset:9216
    v_mfma_f32_16x16x32_bf16 v[160:163], a[88:91], a[68:71], v[160:163]
    ds_read_b64_tr_b16 a[44:45], v8 offset:8192
    v_mfma_f32_16x16x32_bf16 v[164:167], a[92:95], a[52:55], v[164:167]
    s_add_u32 m0, s38, 3072
    ds_read_b64_tr_b16 a[46:47], v8 offset:9216
    v_mfma_f32_16x16x32_bf16 v[168:171], a[92:95], a[56:59], v[168:171]
    ds_read_b64_tr_b16 a[48:49], v9 offset:8192
    v_mfma_f32_16x16x32_bf16 v[172:175], a[92:95], a[60:63], v[172:175]
    buffer_load_dwordx4 v227, s[8:11], s40 offen lds
    ds_read_b64_tr_b16 a[50:51], v9 offset:9216
    v_mfma_f32_16x16x32_bf16 v[176:179], a[92:95], a[64:67], v[176:179]
    s_add_u32 s39, s63, 6
    s_cmp_ge_u32 s39, 9
    s_cselect_b32 s55, 9, 0
    s_sub_u32 s39, s39, s55
    v_mfma_f32_16x16x32_bf16 v[180:183], a[92:95], a[68:71], v[180:183]
    s_lshl_b32 s39, s39, 7
    v_mfma_f32_16x16x32_bf16 v[184:187], a[96:99], a[52:55], v[184:187]
    s_add_u32 m0, s34, 10240
    s_nop 0
    buffer_load_dwordx4 v228, s[4:7], s39 offen lds
    v_mfma_f32_16x16x32_bf16 v[188:191], a[96:99], a[56:59], v[188:191]
    s_add_u32 m0, s34, 11264
    v_mfma_f32_16x16x32_bf16 v[192:195], a[96:99], a[60:63], v[192:195]
    buffer_load_dwordx4 v229, s[4:7], s39 offen lds
    s_add_u32 m0, s34, 12288
    v_mfma_f32_16x16x32_bf16 v[196:199], a[96:99], a[64:67], v[196:199]
    buffer_load_dwordx4 v230, s[4:7], s39 offen lds
    v_mfma_f32_16x16x32_bf16 v[200:203], a[96:99], a[68:71], v[200:203]
    s_add_u32 m0, s34, 13312
    v_mfma_f32_16x16x32_bf16 v[204:207], a[100:103], a[52:55], v[204:207]
    buffer_load_dwordx4 v231, s[4:7], s39 offen lds
    s_add_u32 m0, s34, 14336
    v_mfma_f32_16x16x32_bf16 v[208:211], a[100:103], a[56:59], v[208:211]
    buffer_load_dwordx4 v232, s[4:7], s39 offen lds
    v_mfma_f32_16x16x32_bf16 v[212:215], a[100:103], a[60:63], v[212:215]
    s_add_u32 m0, s28, 0
    s_nop 0
    buffer_load_dwordx4 v17, s[12:15], s29 offen nt lds
    v_mfma_f32_16x16x32_bf16 v[216:219], a[100:103], a[64:67], v[216:219]
    buffer_load_dwordx4 v18, s[12:15], s29 offen offset:1024 nt lds
    v_mfma_f32_16x16x32_bf16 v[220:223], a[100:103], a[68:71], v[220:223]
    buffer_load_dwordx4 v19, s[12:15], s29 offen offset:2048 nt lds
    buffer_load_dwordx4 v20, s[12:15], s29 offen offset:3072 nt lds
    s_waitcnt lgkmcnt(0)
    v_mfma_f32_16x16x32_bf16 v[64:67], a[20:23], a[0:3], v[64:67]
    v_mfma_f32_16x16x32_bf16 v[68:71], a[20:23], a[4:7], v[68:71]
    v_mfma_f32_16x16x32_bf16 v[72:75], a[20:23], a[8:11], v[72:75]
    v_mfma_f32_16x16x32_bf16 v[76:79], a[20:23], a[12:15], v[76:79]
    v_mfma_f32_16x16x32_bf16 v[80:83], a[20:23], a[16:19], v[80:83]
    v_mfma_f32_16x16x32_bf16 v[84:87], a[24:27], a[0:3], v[84:87]
    s_waitcnt vmcnt(13)
    s_barrier
    v_mfma_f32_16x16x32_bf16 v[88:91], a[24:27], a[4:7], v[88:91]
    ds_read_b128 a[52:55], v233 offset:0
    v_mfma_f32_16x16x32_bf16 v[92:95], a[24:27], a[8:11], v[92:95]
    ds_read_b64_tr_b16 a[72:73], v2 offset:16384
    v_mfma_f32_16x16x32_bf16 v[96:99], a[24:27], a[12:15], v[96:99]
    s_add_u32 s40, s40, 0x40000
    v_mfma_f32_16x16x32_bf16 v[100:103], a[24:27], a[16:19], v[100:103]
    ds_read_b64_tr_b16 a[74:75], v2 offset:17408
    v_mfma_f32_16x16x32_bf16 v[104:107], a[28:31], a[0:3], v[104:107]
    ds_read_b128 a[56:59], v233 offset:2048
    v_mfma_f32_16x16x32_bf16 v[108:111], a[28:31], a[4:7], v[108:111]
    s_add_u32 m0, s38, 8192
    v_mfma_f32_16x16x32_bf16 v[112:115], a[28:31], a[8:11], v[112:115]
    ds_read_b128 a[60:63], v233 offset:4096
    v_mfma_f32_16x16x32_bf16 v[116:119], a[28:31], a[12:15], v[116:119]
    ds_read_b128 a[64:67], v233 offset:6144
    v_mfma_f32_16x16x32_bf16 v[120:123], a[28:31], a[16:19], v[120:123]
    buffer_load_dwordx4 v224, s[8:11], s40 offen lds
    ds_read_b128 a[68:71], v233 offset:8192
    v_mfma_f32_16x16x32_bf16 v[124:127], a[32:35], a[0:3], v[124:127]
    ds_read_b64_tr_b16 a[76:77], v3 offset:16384
    v_mfma_f32_16x16x32_bf16 v[128:131], a[32:35], a[4:7], v[128:131]
    s_add_u32 m0, s38, 9216
    v_mfma_f32_16x16x32_bf16 v[132:135], a[32:35], a[8:11], v[132:135]
    ds_read_b64_tr_b16 a[78:79], v3 offset:17408
    v_mfma_f32_16x16x32_bf16 v[136:139], a[32:35], a[12:15], v[136:139]
    ds_read_b64_tr_b16 a[80:81], v4 offset:16384
    v_mfma_f32_16x16x32_bf16 v[140:143], a[32:35], a[16:19], v[140:143]
    buffer_load_dwordx4 v225, s[8:11], s40 offen lds
    v_mfma_f32_16x16x32_bf16 v[144:147], a[36:39], a[0:3], v[144:147]
    ds_read_b64_tr_b16 a[82:83], v4 offset:17408
    v_mfma_f32_16x16x32_bf16 v[148:151], a[36:39], a[4:7], v[148:151]
    ds_read_b64_tr_b16 a[84:85], v5 offset:16384
    v_mfma_f32_16x16x32_bf16 v[152:155], a[36:39], a[8:11], v[152:155]
    s_add_u32 m0, s38, 10240
    ds_read_b64_tr_b16 a[86:87], v5 offset:17408
    v_mfma_f32_16x16x32_bf16 v[156:159], a[36:39], a[12:15], v[156:159]
    ds_read_b64_tr_b16 a[88:89], v6 offset:16384
    v_mfma_f32_16x16x32_bf16 v[160:163], a[36:39], a[16:19], v[160:163]
    buffer_load_dwordx4 v226, s[8:11], s40 offen lds
    v_mfma_f32_16x16x32_bf16 v[164:167], a[40:43], a[0:3], v[164:167]
    ds_read_b64_tr_b16 a[90:91], v6 offset:17408
    v_mfma_f32_16x16x32_bf16 v[168:171], a[40:43], a[4:7], v[168:171]
    ds_read_b64_tr_b16 a[92:93], v7 offset:16384
    v_mfma_f32_16x16x32_bf16 v[172:175], a[40:43], a[8:11], v[172:175]
    s_add_u32 m0, s38, 11264
    v_mfma_f32_16x16x32_bf16 v[176:179], a[40:43], a[12:15], v[176:179]
    ds_read_b64_tr_b16 a[94:95], v7 offset:17408
    v_mfma_f32_16x16x32_bf16 v[180:183], a[40:43], a[16:19], v[180:183]
    ds_read_b64_tr_b16 a[96:97], v8 offset:16384
    v_mfma_f32_16x16x32_bf16 v[184:187], a[44:47], a[0:3], v[184:187]
    buffer_load_dwordx4 v227, s[8:11], s40 offen lds
    v_mfma_f32_16x16x32_bf16 v[188:191], a[44:47], a[4:7], v[188:191]
    ds_read_b64_tr_b16 a[98:99], v8 offset:17408
    ds_read_b64_tr_b16 a[100:101], v9 offset:16384
    v_mfma_f32_16x16x32_bf16 v[192:195], a[44:47], a[8:11], v[192:195]
    s_add_u32 s29, s29, 4096
    v_mfma_f32_16x16x32_bf16 v[196:199], a[44:47], a[12:15], v[196:199]
    ds_read_b64_tr_b16 a[102:103], v9 offset:17408
    v_mfma_f32_16x16x32_bf16 v[200:203], a[44:47], a[16:19], v[200:203]
    s_add_u32 m0, s28, 4096
    v_mfma_f32_16x16x32_bf16 v[204:207], a[48:51], a[0:3], v[204:207]
    buffer_load_dwordx4 v17, s[12:15], s29 offen nt lds
    v_mfma_f32_16x16x32_bf16 v[208:211], a[48:51], a[4:7], v[208:211]
    buffer_load_dwordx4 v18, s[12:15], s29 offen offset:1024 nt lds
    v_mfma_f32_16x16x32_bf16 v[212:215], a[48:51], a[8:11], v[212:215]
    buffer_load_dwordx4 v19, s[12:15], s29 offen offset:2048 nt lds
    v_mfma_f32_16x16x32_bf16 v[216:219], a[48:51], a[12:15], v[216:219]
    buffer_load_dwordx4 v20, s[12:15], s29 offen offset:3072 nt lds
    v_mfma_f32_16x16x32_bf16 v[220:223], a[48:51], a[16:19], v[220:223]
    s_add_u32 s29, s29, 4096
    s_and_b32 s29, s29, 0x1ffff
    s_or_b32 s29, s29, s3
    s_waitcnt lgkmcnt(0)
    v_mfma_f32_16x16x32_bf16 v[64:67], a[72:75], a[52:55], v[64:67]
    v_mfma_f32_16x16x32_bf16 v[68:71], a[72:75], a[56:59], v[68:71]
    v_mfma_f32_16x16x32_bf16 v[72:75], a[72:75], a[60:63], v[72:75]
    v_mfma_f32_16x16x32_bf16 v[76:79], a[72:75], a[64:67], v[76:79]
    v_mfma_f32_16x16x32_bf16 v[80:83], a[72:75], a[68:71], v[80:83]
    v_mfma_f32_16x16x32_bf16 v[84:87], a[76:79], a[52:55], v[84:87]
    s_waitcnt vmcnt(12)
    s_barrier
    v_mfma_f32_16x16x32_bf16 v[88:91], a[76:79], a[56:59], v[88:91]
    ds_read_b128 a[0:3], v1 offset:10240
    v_mfma_f32_16x16x32_bf16 v[92:95], a[76:79], a[60:63], v[92:95]
    ds_read_b64_tr_b16 a[20:21], v2 offset:0
    v_mfma_f32_16x16x32_bf16 v[96:99], a[76:79], a[64:67], v[96:99]
    s_add_u32 s40, s63, 7
    s_cmp_ge_u32 s40, 9
    s_cselect_b32 s55, 9, 0
    s_sub_u32 s40, s40, s55
    v_mfma_f32_16x16x32_bf16 v[100:103], a[76:79], a[68:71], v[100:103]
    ds_read_b64_tr_b16 a[22:23], v2 offset:1024
    ds_read_b128 a[4:7], v1 offset:12288
    v_mfma_f32_16x16x32_bf16 v[104:107], a[80:83], a[52:55], v[104:107]
    s_lshl_b32 s40, s40, 19
    v_mfma_f32_16x16x32_bf16 v[108:111], a[80:83], a[56:59], v[108:111]
    ds_read_b128 a[8:11], v1 offset:14336
    v_mfma_f32_16x16x32_bf16 v[112:115], a[80:83], a[60:63], v[112:115]
    ds_read_b128 a[12:15], v1 offset:16384
    v_mfma_f32_16x16x32_bf16 v[116:119], a[80:83], a[64:67], v[116:119]
    s_add_u32 m0, s38, 16384
    ds_read_b128 a[16:19], v1 offset:18432
    v_mfma_f32_16x16x32_bf16 v[120:123], a[80:83], a[68:71], v[120:123]
    ds_read_b64_tr_b16 a[24:25], v3 offset:0
    v_mfma_f32_16x16x32_bf16 v[124:127], a[84:87], a[52:55], v[124:127]
    buffer_load_dwordx4 v224, s[8:11], s40 offen lds
    v_mfma_f32_16x16x32_bf16 v[128:131], a[84:87], a[56:59], v[128:131]
    ds_read_b64_tr_b16 a[26:27], v3 offset:1024
    v_mfma_f32_16x16x32_bf16 v[132:135], a[84:87], a[60:63], v[132:135]
    ds_read_b64_tr_b16 a[28:29], v4 offset:0
    s_add_u32 m0, s38, 17408
    v_mfma_f32_16x16x32_bf16 v[136:139], a[84:87], a[64:67], v[136:139]
    ds_read_b64_tr_b16 a[30:31], v4 offset:1024
    v_mfma_f32_16x16x32_bf16 v[140:143], a[84:87], a[68:71], v[140:143]
    ds_read_b64_tr_b16 a[32:33], v5 offset:0
    v_mfma_f32_16x16x32_bf16 v[144:147], a[88:91], a[52:55], v[144:147]
    buffer_load_dwordx4 v225, s[8:11], s40 offen lds
    v_mfma_f32_16x16x32_bf16 v[148:151], a[88:91], a[56:59], v[148:151]
    ds_read_b64_tr_b16 a[34:35], v5 offset:1024
    ds_read_b64_tr_b16 a[36:37], v6 offset:0
    v_mfma_f32_16x16x32_bf16 v[152:155], a[88:91], a[60:63], v[152:155]
    s_add_u32 m0, s38, 18432
    v_mfma_f32_16x16x32_bf16 v[156:159], a[88:91], a[64:67], v[156:159]
    ds_read_b64_tr_b16 a[38:39], v6 offset:1024
    v_mfma_f32_16x16x32_bf16 v[160:163], a[88:91], a[68:71], v[160:163]
    ds_read_b64_tr_b16 a[40:41], v7 offset:0
    buffer_load_dwordx4 v226, s[8:11], s40 offen lds
    v_mfma_f32_16x16x32_bf16 v[164:167], a[92:95], a[52:55], v[164:167]
    ds_read_b64_tr_b16 a[42:43], v7 offset:1024
    v_mfma_f32_16x16x32_bf16 v[168:171], a[92:95], a[56:59], v[168:171]
    ds_read_b64_tr_b16 a[44:45], v8 offset:0
    v_mfma_f32_16x16x32_bf16 v[172:175], a[92:95], a[60:63], v[172:175]
    s_add_u32 m0, s38, 19456
    v_mfma_f32_16x16x32_bf16 v[176:179], a[92:95], a[64:67], v[176:179]
    ds_read_b64_tr_b16 a[46:47], v8 offset:1024
    ds_read_b64_tr_b16 a[48:49], v9 offset:0
    v_mfma_f32_16x16x32_bf16 v[180:183], a[92:95], a[68:71], v[180:183]
    buffer_load_dwordx4 v227, s[8:11], s40 offen lds
    v_mfma_f32_16x16x32_bf16 v[184:187], a[96:99], a[52:55], v[184:187]
    ds_read_b64_tr_b16 a[50:51], v9 offset:1024
    v_mfma_f32_16x16x32_bf16 v[188:191], a[96:99], a[56:59], v[188:191]
    s_add_u32 s39, s63, 7
    s_cmp_ge_u32 s39, 9
    s_cselect_b32 s55, 9, 0
    s_sub_u32 s39, s39, s55
    v_mfma_f32_16x16x32_bf16 v[192:195], a[96:99], a[60:63], v[192:195]
    s_lshl_b32 s39, s39, 7
    s_add_u32 m0, s34, 0
    v_mfma_f32_16x16x32_bf16 v[196:199], a[96:99], a[64:67], v[196:199]
    buffer_load_dwordx4 v228, s[4:7], s39 offen lds
    v_mfma_f32_16x16x32_bf16 v[200:203], a[96:99], a[68:71], v[200:203]
    s_add_u32 m0, s34, 1024
    v_mfma_f32_16x16x32_bf16 v[204:207], a[100:103], a[52:55], v[204:207]
    buffer_load_dwordx4 v229, s[4:7], s39 offen lds
    v_mfma_f32_16x16x32_bf16 v[208:211], a[100:103], a[56:59], v[208:211]
    s_add_u32 m0, s34, 2048
    s_nop 0
    buffer_load_dwordx4 v230, s[4:7], s39 offen lds
    v_mfma_f32_16x16x32_bf16 v[212:215], a[100:103], a[60:63], v[212:215]
    s_add_u32 m0, s34, 3072
    v_mfma_f32_16x16x32_bf16 v[216:219], a[100:103], a[64:67], v[216:219]
    buffer_load_dwordx4 v231, s[4:7], s39 offen lds
    v_mfma_f32_16x16x32_bf16 v[220:223], a[100:103], a[68:71], v[220:223]
    s_add_u32 m0, s34, 4096
    s_nop 0
    buffer_load_dwordx4 v232, s[4:7], s39 offen lds
    s_waitcnt lgkmcnt(0)
    v_mfma_f32_16x16x32_bf16 v[64:67], a[20:23], a[0:3], v[64:67]
    v_mfma_f32_16x16x32_bf16 v[68:71], a[20:23], a[4:7], v[68:71]
    v_mfma_f32_16x16x32_bf16 v[72:75], a[20:23], a[8:11], v[72:75]
    v_mfma_f32_16x16x32_bf16 v[76:79], a[20:23], a[12:15], v[76:79]
    v_mfma_f32_16x16x32_bf16 v[80:83], a[20:23], a[16:19], v[80:83]
    v_mfma_f32_16x16x32_bf16 v[84:87], a[24:27], a[0:3], v[84:87]
    s_waitcnt vmcnt(13)
    s_barrier
    v_mfma_f32_16x16x32_bf16 v[88:91], a[24:27], a[4:7], v[88:91]
    ds_read_b128 a[52:55], v233 offset:10240
    v_mfma_f32_16x16x32_bf16 v[92:95], a[24:27], a[8:11], v[92:95]
    ds_read_b64_tr_b16 a[72:73], v2 offset:8192
    v_mfma_f32_16x16x32_bf16 v[96:99], a[24:27], a[12:15], v[96:99]
    s_add_u32 s40, s40, 0x40000
    v_mfma_f32_16x16x32_bf16 v[100:103], a[24:27], a[16:19], v[100:103]
    ds_read_b64_tr_b16 a[74:75], v2 offset:9216
    v_mfma_f32_16x16x32_bf16 v[104:107], a[28:31], a[0:3], v[104:107]
    ds_read_b128 a[56:59], v233 offset:12288
    v_mfma_f32_16x16x32_bf16 v[108:111], a[28:31], a[4:7], v[108:111]
    s_add_u32 m0, s38, 0
    v_mfma_f32_16x16x32_bf16 v[112:115], a[28:31], a[8:11], v[112:115]
    ds_read_b128 a[60:63], v233 offset:14336
    v_mfma_f32_16x16x32_bf16 v[116:119], a[28:31], a[12:15], v[116:119]
    ds_read_b128 a[64:67], v233 offset:16384
    v_mfma_f32_16x16x32_bf16 v[120:123], a[28:31], a[16:19], v[120:123]
    buffer_load_dwordx4 v224, s[8:11], s40 offen lds
    v_mfma_f32_16x16x32_bf16 v[124:127], a[32:35], a[0:3], v[124:127]
    ds_read_b128 a[68:71], v233 offset:18432
    v_mfma_f32_16x16x32_bf16 v[128:131], a[32:35], a[4:7], v[128:131]
    ds_read_b64_tr_b16 a[76:77], v3 offset:8192
    v_mfma_f32_16x16x32_bf16 v[132:135], a[32:35], a[8:11], v[132:135]
    s_add_u32 m0, s38, 1024
    v_mfma_f32_16x16x32_bf16 v[136:139], a[32:35], a[12:15], v[136:139]
    ds_read_b64_tr_b16 a[78:79], v3 offset:9216
    v_mfma_f32_16x16x32_bf16 v[140:143], a[32:35], a[16:19], v[140:143]
    ds_read_b64_tr_b16 a[80:81], v4 offset:8192
    v_mfma_f32_16x16x32_bf16 v[144:147], a[36:39], a[0:3], v[144:147]
    buffer_load_dwordx4 v225, s[8:11], s40 offen lds
    v_mfma_f32_16x16x32_bf16 v[148:151], a[36:39], a[4:7], v[148:151]
    ds_read_b64_tr_b16 a[82:83], v4 offset:9216
    v_mfma_f32_16x16x32_bf16 v[152:155], a[36:39], a[8:11], v[152:155]
    ds_read_b64_tr_b16 a[84:85], v5 offset:8192
    v_mfma_f32_16x16x32_bf16 v[156:159], a[36:39], a[12:15], v[156:159]
    s_add_u32 m0, s38, 2048
    v_mfma_f32_16x16x32_bf16 v[160:163], a[36:39], a[16:19], v[160:163]
    ds_read_b64_tr_b16 a[86:87], v5 offset:9216
    v_mfma_f32_16x16x32_bf16 v[164:167], a[40:43], a[0:3], v[164:167]
    ds_read_b64_tr_b16 a[88:89], v6 offset:8192
    v_mfma_f32_16x16x32_bf16 v[168:171], a[40:43], a[4:7], v[168:171]
    buffer_load_dwordx4 v226, s[8:11], s40 offen lds
    v_mfma_f32_16x16x32_bf16 v[172:175], a[40:43], a[8:11], v[172:175]
    ds_read_b64_tr_b16 a[90:91], v6 offset:9216
    v_mfma_f32_16x16x32_bf16 v[176:179], a[40:43], a[12:15], v[176:179]
    ds_read_b64_tr_b16 a[92:93], v7 offset:8192
    v_mfma_f32_16x16x32_bf16 v[180:183], a[40:43], a[16:19], v[180:183]
    s_add_u32 m0, s38, 3072
    v_mfma_f32_16x16x32_bf16 v[184:187], a[44:47], a[0:3], v[184:187]
    ds_read_b64_tr_b16 a[94:95], v7 offset:9216
    v_mfma_f32_16x16x32_bf16 v[188:191], a[44:47], a[4:7], v[188:191]
    ds_read_b64_tr_b16 a[96:97], v8 offset:8192
    v_mfma_f32_16x16x32_bf16 v[192:195], a[44:47], a[8:11], v[192:195]
    buffer_load_dwordx4 v227, s[8:11], s40 offen lds
    v_mfma_f32_16x16x32_bf16 v[196:199], a[44:47], a[12:15], v[196:199]
    ds_read_b64_tr_b16 a[98:99], v8 offset:9216
    v_mfma_f32_16x16x32_bf16 v[200:203], a[44:47], a[16:19], v[200:203]
    ds_read_b64_tr_b16 a[100:101], v9 offset:8192
    v_mfma_f32_16x16x32_bf16 v[204:207], a[48:51], a[0:3], v[204:207]
    s_add_u32 m0, s28, 8192
    v_mfma_f32_16x16x32_bf16 v[208:211], a[48:51], a[4:7], v[208:211]
    ds_read_b64_tr_b16 a[102:103], v9 offset:9216
    v_mfma_f32_16x16x32_bf16 v[212:215], a[48:51], a[8:11], v[212:215]
    buffer_load_dwordx4 v21, s[16:19], s30 offen nt lds
    v_mfma_f32_16x16x32_bf16 v[216:219], a[48:51], a[12:15], v[216:219]
    buffer_load_dwordx4 v22, s[16:19], s30 offen offset:1024 nt lds
    v_mfma_f32_16x16x32_bf16 v[220:223], a[48:51], a[16:19], v[220:223]
    buffer_load_dwordx4 v21, s[16:19], s30 offen offset:2048 nt lds
    buffer_load_dwordx4 v22, s[16:19], s30 offen offset:3072 nt lds
    s_waitcnt lgkmcnt(0)
    v_mfma_f32_16x16x32_bf16 v[64:67], a[72:75], a[52:55], v[64:67]
    v_mfma_f32_16x16x32_bf16 v[68:71], a[72:75], a[56:59], v[68:71]
    v_mfma_f32_16x16x32_bf16 v[72:75], a[72:75], a[60:63], v[72:75]
    v_mfma_f32_16x16x32_bf16 v[76:79], a[72:75], a[64:67], v[76:79]
    v_mfma_f32_16x16x32_bf16 v[80:83], a[72:75], a[68:71], v[80:83]
    v_mfma_f32_16x16x32_bf16 v[84:87], a[76:79], a[52:55], v[84:87]
    s_waitcnt vmcnt(8)
    s_barrier
    v_mfma_f32_16x16x32_bf16 v[88:91], a[76:79], a[56:59], v[88:91]
    ds_read_b128 a[0:3], v1 offset:0
    v_mfma_f32_16x16x32_bf16 v[92:95], a[76:79], a[60:63], v[92:95]
    ds_read_b64_tr_b16 a[20:21], v2 offset:16384
    s_add_u32 s40, s63, 8
    s_cmp_ge_u32 s40, 9
    s_cselect_b32 s55, 9, 0
    s_sub_u32 s40, s40, s55
    v_mfma_f32_16x16x32_bf16 v[96:99], a[76:79], a[64:67], v[96:99]
    ds_read_b64_tr_b16 a[22:23], v2 offset:17408
    v_mfma_f32_16x16x32_bf16 v[100:103], a[76:79], a[68:71], v[100:103]
    ds_read_b128 a[4:7], v1 offset:2048
    s_lshl_b32 s40, s40, 19
    v_mfma_f32_16x16x32_bf16 v[104:107], a[80:83], a[52:55], v[104:107]
    ds_read_b128 a[8:11], v1 offset:4096
    v_mfma_f32_16x16x32_bf16 v[108:111], a[80:83], a[56:59], v[108:111]
    ds_read_b128 a[12:15], v1 offset:6144
    s_add_u32 m0, s38, 8192
    v_mfma_f32_16x16x32_bf16 v[112:115], a[80:83], a[60:63], v[112:115]
    ds_read_b128 a[16:19], v1 offset:8192
    v_mfma_f32_16x16x32_bf16 v[116:119], a[80:83], a[64:67], v[116:119]
    ds_read_b64_tr_b16 a[24:25], v3 offset:16384
    buffer_load_dwordx4 v224, s[8:11], s40 offen lds
    v_mfma_f32_16x16x32_bf16 v[120:123], a[80:83], a[68:71], v[120:123]
    ds_read_b64_tr_b16 a[26:27], v3 offset:17408
    v_mfma_f32_16x16x32_bf16 v[124:127], a[84:87], a[52:55], v[124:127]
    ds_read_b64_tr_b16 a[28:29], v4 offset:16384
    s_add_u32 m0, s38, 9216
    v_mfma_f32_16x16x32_bf16 v[128:131], a[84:87], a[56:59], v[128:131]
    ds_read_b64_tr_b16 a[30:31], v4 offset:17408
    v_mfma_f32_16x16x32_bf16 v[132:135], a[84:87], a[60:63], v[132:135]
    ds_read_b64_tr_b16 a[32:33], v5 offset:16384
    buffer_load_dwordx4 v225, s[8:11], s40 offen lds
    v_mfma_f32_16x16x32_bf16 v[136:139], a[84:87], a[64:67], v[136:139]
    ds_read_b64_tr_b16 a[34:35], v5 offset:17408
    v_mfma_f32_16x16x32_bf16 v[140:143], a[84:87], a[68:71], v[140:143]
    ds_read_b64_tr_b16 a[36:37], v6 offset:16384
    s_add_u32 m0, s38, 10240
    v_mfma_f32_16x16x32_bf16 v[144:147], a[88:91], a[52:55], v[144:147]
    ds_read_b64_tr_b16 a[38:39], v6 offset:17408
    v_mfma_f32_16x16x32_bf16 v[148:151], a[88:91], a[56:59], v[148:151]
    ds_read_b64_tr_b16 a[40:41], v7 offset:16384
    buffer_load_dwordx4 v226, s[8:11], s40 offen lds
    v_mfma_f32_16x16x32_bf16 v[152:155], a[88:91], a[60:63], v[152:155]
    ds_read_b64_tr_b16 a[42:43], v7 offset:17408
    v_mfma_f32_16x16x32_bf16 v[156:159], a[88:91], a[64:67], v[156:159]
    ds_read_b64_tr_b16 a[44:45], v8 offset:16384
    s_add_u32 m0, s38, 11264
    v_mfma_f32_16x16x32_bf16 v[160:163], a[88:91], a[68:71], v[160:163]
    ds_read_b64_tr_b16 a[46:47], v8 offset:17408
    v_mfma_f32_16x16x32_bf16 v[164:167], a[92:95], a[52:55], v[164:167]
    ds_read_b64_tr_b16 a[48:49], v9 offset:16384
    buffer_load_dwordx4 v227, s[8:11], s40 offen lds
    v_mfma_f32_16x16x32_bf16 v[168:171], a[92:95], a[56:59], v[168:171]
    ds_read_b64_tr_b16 a[50:51], v9 offset:17408
    v_mfma_f32_16x16x32_bf16 v[172:175], a[92:95], a[60:63], v[172:175]
    s_add_u32 s39, s63, 8
    s_cmp_ge_u32 s39, 9
    s_cselect_b32 s55, 9, 0
    s_sub_u32 s39, s39, s55
    s_lshl_b32 s39, s39, 7
    v_mfma_f32_16x16x32_bf16 v[176:179], a[92:95], a[64:67], v[176:179]
    s_add_u32 m0, s34, 10240
    v_mfma_f32_16x16x32_bf16 v[180:183], a[92:95], a[68:71], v[180:183]
    buffer_load_dwordx4 v228, s[4:7], s39 offen lds
    s_add_u32 m0, s34, 11264
    v_mfma_f32_16x16x32_bf16 v[184:187], a[96:99], a[52:55], v[184:187]
    buffer_load_dwordx4 v229, s[4:7], s39 offen lds
    v_mfma_f32_16x16x32_bf16 v[188:191], a[96:99], a[56:59], v[188:191]
    s_add_u32 m0, s34, 12288
    s_nop 0
    buffer_load_dwordx4 v230, s[4:7], s39 offen lds
    v_mfma_f32_16x16x32_bf16 v[192:195], a[96:99], a[60:63], v[192:195]
    s_add_u32 m0, s34, 13312
    v_mfma_f32_16x16x32_bf16 v[196:199], a[96:99], a[64:67], v[196:199]
    buffer_load_dwordx4 v231, s[4:7], s39 offen lds
    s_add_u32 m0, s34, 14336
    v_mfma_f32_16x16x32_bf16 v[200:203], a[96:99], a[68:71], v[200:203]
    buffer_load_dwordx4 v232, s[4:7], s39 offen lds
    v_mfma_f32_16x16x32_bf16 v[204:207], a[100:103], a[52:55], v[204:207]
    s_add_u32 s30, s30, 4096
    s_add_u32 m0, s28, 12288
    v_mfma_f32_16x16x32_bf16 v[208:211], a[100:103], a[56:59], v[208:211]
    buffer_load_dwordx4 v21, s[16:19], s30 offen nt lds
    v_mfma_f32_16x16x32_bf16 v[212:215], a[100:103], a[60:63], v[212:215]
    buffer_load_dwordx4 v22, s[16:19], s30 offen offset:1024 nt lds
    buffer_load_dwordx4 v21, s[16:19], s30 offen offset:2048 nt lds
    v_mfma_f32_16x16x32_bf16 v[216:219], a[100:103], a[64:67], v[216:219]
    buffer_load_dwordx4 v22, s[16:19], s30 offen offset:3072 nt lds
    v_mfma_f32_16x16x32_bf16 v[220:223], a[100:103], a[68:71], v[220:223]
    s_add_u32 s30, s30, 4096
    s_and_b32 s30, s30, 0x1ffff
    s_or_b32 s30, s30, s3
    s_waitcnt lgkmcnt(0)
    v_mfma_f32_16x16x32_bf16 v[64:67], a[20:23], a[0:3], v[64:67]
    v_mfma_f32_16x16x32_bf16 v[68:71], a[20:23], a[4:7], v[68:71]
    v_mfma_f32_16x16x32_bf16 v[72:75], a[20:23], a[8:11], v[72:75]
    v_mfma_f32_16x16x32_bf16 v[76:79], a[20:23], a[12:15], v[76:79]
    v_mfma_f32_16x16x32_bf16 v[80:83], a[20:23], a[16:19], v[80:83]
    v_mfma_f32_16x16x32_bf16 v[84:87], a[24:27], a[0:3], v[84:87]
    s_waitcnt vmcnt(17)
    s_barrier
    v_mfma_f32_16x16x32_bf16 v[88:91], a[24:27], a[4:7], v[88:91]
    v_mfma_f32_16x16x32_bf16 v[92:95], a[24:27], a[8:11], v[92:95]
    ds_read_b128 a[52:55], v233 offset:0
    v_mfma_f32_16x16x32_bf16 v[96:99], a[24:27], a[12:15], v[96:99]
    ds_read_b64_tr_b16 a[72:73], v2 offset:0
    v_mfma_f32_16x16x32_bf16 v[100:103], a[24:27], a[16:19], v[100:103]
    s_add_u32 s40, s40, 0x40000
    v_mfma_f32_16x16x32_bf16 v[104:107], a[28:31], a[0:3], v[104:107]
    ds_read_b64_tr_b16 a[74:75], v2 offset:1024
    v_mfma_f32_16x16x32_bf16 v[108:111], a[28:31], a[4:7], v[108:111]
    ds_read_b128 a[56:59], v233 offset:2048
    v_mfma_f32_16x16x32_bf16 v[112:115], a[28:31], a[8:11], v[112:115]
    s_add_u32 m0, s38, 16384
    v_mfma_f32_16x16x32_bf16 v[116:119], a[28:31], a[12:15], v[116:119]
    ds_read_b128 a[60:63], v233 offset:4096
    v_mfma_f32_16x16x32_bf16 v[120:123], a[28:31], a[16:19], v[120:123]
    v_mfma_f32_16x16x32_bf16 v[124:127], a[32:35], a[0:3], v[124:127]
    ds_read_b128 a[64:67], v233 offset:6144
    v_mfma_f32_16x16x32_bf16 v[128:131], a[32:35], a[4:7], v[128:131]
    buffer_load_dwordx4 v224, s[8:11], s40 offen lds
    v_mfma_f32_16x16x32_bf16 v[132:135], a[32:35], a[8:11], v[132:135]
    ds_read_b128 a[68:71], v233 offset:8192
    v_mfma_f32_16x16x32_bf16 v[136:139], a[32:35], a[12:15], v[136:139]
    ds_read_b64_tr_b16 a[76:77], v3 offset:0
    v_mfma_f32_16x16x32_bf16 v[140:143], a[32:35], a[16:19], v[140:143]
    s_add_u32 m0, s38, 17408
    v_mfma_f32_16x16x32_bf16 v[144:147], a[36:39], a[0:3], v[144:147]
    ds_read_b64_tr_b16 a[78:79], v3 offset:1024
    v_mfma_f32_16x16x32_bf16 v[148:151], a[36:39], a[4:7], v[148:151]
    ds_read_b64_tr_b16 a[80:81], v4 offset:0
    v_mfma_f32_16x16x32_bf16 v[152:155], a[36:39], a[8:11], v[152:155]
    buffer_load_dwordx4 v225, s[8:11], s40 offen lds
    v_mfma_f32_16x16x32_bf16 v[156:159], a[36:39], a[12:15], v[156:159]
    v_mfma_f32_16x16x32_bf16 v[160:163], a[36:39], a[16:19], v[160:163]
    ds_read_b64_tr_b16 a[82:83], v4 offset:1024
    v_mfma_f32_16x16x32_bf16 v[164:167], a[40:43], a[0:3], v[164:167]
    ds_read_b64_tr_b16 a[84:85], v5 offset:0
    v_mfma_f32_16x16x32_bf16 v[168:171], a[40:43], a[4:7], v[168:171]
    s_add_u32 m0, s38, 18432
    v_mfma_f32_16x16x32_bf16 v[172:175], a[40:43], a[8:11], v[172:175]
    ds_read_b64_tr_b16 a[86:87], v5 offset:1024
    v_mfma_f32_16x16x32_bf16 v[176:179], a[40:43], a[12:15], v[176:179]
    ds_read_b64_tr_b16 a[88:89], v6 offset:0
    v_mfma_f32_16x16x32_bf16 v[180:183], a[40:43], a[16:19], v[180:183]
    buffer_load_dwordx4 v226, s[8:11], s40 offen lds
    v_mfma_f32_16x16x32_bf16 v[184:187], a[44:47], a[0:3], v[184:187]
    ds_read_b64_tr_b16 a[90:91], v6 offset:1024
    v_mfma_f32_16x16x32_bf16 v[188:191], a[44:47], a[4:7], v[188:191]
    v_mfma_f32_16x16x32_bf16 v[192:195], a[44:47], a[8:11], v[192:195]
    ds_read_b64_tr_b16 a[92:93], v7 offset:0
    v_mfma_f32_16x16x32_bf16 v[196:199], a[44:47], a[12:15], v[196:199]
    s_add_u32 m0, s38, 19456
    v_mfma_f32_16x16x32_bf16 v[200:203], a[44:47], a[16:19], v[200:203]
    ds_read_b64_tr_b16 a[94:95], v7 offset:1024
    v_mfma_f32_16x16x32_bf16 v[204:207], a[48:51], a[0:3], v[204:207]
    ds_read_b64_tr_b16 a[96:97], v8 offset:0
    v_mfma_f32_16x16x32_bf16 v[208:211], a[48:51], a[4:7], v[208:211]
    buffer_load_dwordx4 v227, s[8:11], s40 offen lds
    v_mfma_f32_16x16x32_bf16 v[212:215], a[48:51], a[8:11], v[212:215]
    ds_read_b64_tr_b16 a[98:99], v8 offset:1024
    v_mfma_f32_16x16x32_bf16 v[216:219], a[48:51], a[12:15], v[216:219]
    ds_read_b64_tr_b16 a[100:101], v9 offset:0
    v_mfma_f32_16x16x32_bf16 v[220:223], a[48:51], a[16:19], v[220:223]
    ds_read_b64_tr_b16 a[102:103], v9 offset:1024
    s_waitcnt lgkmcnt(0)
    v_mfma_f32_16x16x32_bf16 v[64:67], a[72:75], a[52:55], v[64:67]
    v_mfma_f32_16x16x32_bf16 v[68:71], a[72:75], a[56:59], v[68:71]
    v_mfma_f32_16x16x32_bf16 v[72:75], a[72:75], a[60:63], v[72:75]
    v_mfma_f32_16x16x32_bf16 v[76:79], a[72:75], a[64:67], v[76:79]
    v_mfma_f32_16x16x32_bf16 v[80:83], a[72:75], a[68:71], v[80:83]
    v_mfma_f32_16x16x32_bf16 v[84:87], a[76:79], a[52:55], v[84:87]
    s_waitcnt vmcnt(8)
    s_barrier
    v_mfma_f32_16x16x32_bf16 v[88:91], a[76:79], a[56:59], v[88:91]
    ds_read_b128 a[0:3], v1 offset:10240
    v_mfma_f32_16x16x32_bf16 v[92:95], a[76:79], a[60:63], v[92:95]
    ds_read_b64_tr_b16 a[20:21], v2 offset:8192
    v_mfma_f32_16x16x32_bf16 v[96:99], a[76:79], a[64:67], v[96:99]
    s_add_u32 m0, s28, 16384
    v_mfma_f32_16x16x32_bf16 v[100:103], a[76:79], a[68:71], v[100:103]
    ds_read_b64_tr_b16 a[22:23], v2 offset:9216
    v_mfma_f32_16x16x32_bf16 v[104:107], a[80:83], a[52:55], v[104:107]
    ds_read_b128 a[4:7], v1 offset:12288
    v_mfma_f32_16x16x32_bf16 v[108:111], a[80:83], a[56:59], v[108:111]
    buffer_load_dwordx4 v17, s[12:15], s29 offen nt lds
    v_mfma_f32_16x16x32_bf16 v[112:115], a[80:83], a[60:63], v[112:115]
    ds_read_b128 a[8:11], v1 offset:14336
    v_mfma_f32_16x16x32_bf16 v[116:119], a[80:83], a[64:67], v[116:119]
    ds_read_b128 a[12:15], v1 offset:16384
    v_mfma_f32_16x16x32_bf16 v[120:123], a[80:83], a[68:71], v[120:123]
    buffer_load_dwordx4 v18, s[12:15], s29 offen offset:1024 nt lds
    v_mfma_f32_16x16x32_bf16 v[124:127], a[84:87], a[52:55], v[124:127]
    ds_read_b128 a[16:19], v1 offset:18432
    v_mfma_f32_16x16x32_bf16 v[128:131], a[84:87], a[56:59], v[128:131]
    ds_read_b64_tr_b16 a[24:25], v3 offset:8192
    v_mfma_f32_16x16x32_bf16 v[132:135], a[84:87], a[60:63], v[132:135]
    buffer_load_dwordx4 v19, s[12:15], s29 offen offset:2048 nt lds
    v_mfma_f32_16x16x32_bf16 v[136:139], a[84:87], a[64:67], v[136:139]
    ds_read_b64_tr_b16 a[26:27], v3 offset:9216
    v_mfma_f32_16x16x32_bf16 v[140:143], a[84:87], a[68:71], v[140:143]
    ds_read_b64_tr_b16 a[28:29], v4 offset:8192
    v_mfma_f32_16x16x32_bf16 v[144:147], a[88:91], a[52:55], v[144:147]
    buffer_load_dwordx4 v20, s[12:15], s29 offen offset:3072 nt lds
    v_mfma_f32_16x16x32_bf16 v[148:151], a[88:91], a[56:59], v[148:151]
    ds_read_b64_tr_b16 a[30:31], v4 offset:9216
    v_mfma_f32_16x16x32_bf16 v[152:155], a[88:91], a[60:63], v[152:155]
    ds_read_b64_tr_b16 a[32:33], v5 offset:8192
    v_mfma_f32_16x16x32_bf16 v[156:159], a[88:91], a[64:67], v[156:159]
    s_add_u32 s29, s29, 4096
    v_mfma_f32_16x16x32_bf16 v[160:163], a[88:91], a[68:71], v[160:163]
    ds_read_b64_tr_b16 a[34:35], v5 offset:9216
    v_mfma_f32_16x16x32_bf16 v[164:167], a[92:95], a[52:55], v[164:167]
    ds_read_b64_tr_b16 a[36:37], v6 offset:8192
    v_mfma_f32_16x16x32_bf16 v[168:171], a[92:95], a[56:59], v[168:171]
    s_add_u32 m0, s28, 20480
    v_mfma_f32_16x16x32_bf16 v[172:175], a[92:95], a[60:63], v[172:175]
    ds_read_b64_tr_b16 a[38:39], v6 offset:9216
    v_mfma_f32_16x16x32_bf16 v[176:179], a[92:95], a[64:67], v[176:179]
    ds_read_b64_tr_b16 a[40:41], v7 offset:8192
    v_mfma_f32_16x16x32_bf16 v[180:183], a[92:95], a[68:71], v[180:183]
    buffer_load_dwordx4 v17, s[12:15], s29 offen nt lds
    v_mfma_f32_16x16x32_bf16 v[184:187], a[96:99], a[52:55], v[184:187]
    ds_read_b64_tr_b16 a[42:43], v7 offset:9216
    v_mfma_f32_16x16x32_bf16 v[188:191], a[96:99], a[56:59], v[188:191]
    ds_read_b64_tr_b16 a[44:45], v8 offset:8192
    v_mfma_f32_16x16x32_bf16 v[192:195], a[96:99], a[60:63], v[192:195]
    buffer_load_dwordx4 v18, s[12:15], s29 offen offset:1024 nt lds
    v_mfma_f32_16x16x32_bf16 v[196:199], a[96:99], a[64:67], v[196:199]
    ds_read_b64_tr_b16 a[46:47], v8 offset:9216
    v_mfma_f32_16x16x32_bf16 v[200:203], a[96:99], a[68:71], v[200:203]
    ds_read_b64_tr_b16 a[48:49], v9 offset:8192
    v_mfma_f32_16x16x32_bf16 v[204:207], a[100:103], a[52:55], v[204:207]
    buffer_load_dwordx4 v19, s[12:15], s29 offen offset:2048 nt lds
    v_mfma_f32_16x16x32_bf16 v[208:211], a[100:103], a[56:59], v[208:211]
    ds_read_b64_tr_b16 a[50:51], v9 offset:9216
    v_mfma_f32_16x16x32_bf16 v[212:215], a[100:103], a[60:63], v[212:215]
    buffer_load_dwordx4 v20, s[12:15], s29 offen offset:3072 nt lds
    v_mfma_f32_16x16x32_bf16 v[216:219], a[100:103], a[64:67], v[216:219]
    s_add_u32 s29, s29, 4096
    v_mfma_f32_16x16x32_bf16 v[220:223], a[100:103], a[68:71], v[220:223]
    s_and_b32 s29, s29, 0x1ffff
    s_or_b32 s29, s29, s3
    s_waitcnt lgkmcnt(0)
    v_mfma_f32_16x16x32_bf16 v[64:67], a[20:23], a[0:3], v[64:67]
    v_mfma_f32_16x16x32_bf16 v[68:71], a[20:23], a[4:7], v[68:71]
    v_mfma_f32_16x16x32_bf16 v[72:75], a[20:23], a[8:11], v[72:75]
    v_mfma_f32_16x16x32_bf16 v[76:79], a[20:23], a[12:15], v[76:79]
    v_mfma_f32_16x16x32_bf16 v[80:83], a[20:23], a[16:19], v[80:83]
    v_mfma_f32_16x16x32_bf16 v[84:87], a[24:27], a[0:3], v[84:87]
    s_waitcnt vmcnt(8)
    s_barrier
    v_mfma_f32_16x16x32_bf16 v[88:91], a[24:27], a[4:7], v[88:91]
    v_mfma_f32_16x16x32_bf16 v[92:95], a[24:27], a[8:11], v[92:95]
    ds_read_b128 a[52:55], v233 offset:10240
    v_mfma_f32_16x16x32_bf16 v[96:99], a[24:27], a[12:15], v[96:99]
    v_mfma_f32_16x16x32_bf16 v[100:103], a[24:27], a[16:19], v[100:103]
    ds_read_b64_tr_b16 a[72:73], v2 offset:16384
    v_mfma_f32_16x16x32_bf16 v[104:107], a[28:31], a[0:3], v[104:107]
    ds_read_b64_tr_b16 a[74:75], v2 offset:17408
    v_mfma_f32_16x16x32_bf16 v[108:111], a[28:31], a[4:7], v[108:111]
    v_mfma_f32_16x16x32_bf16 v[112:115], a[28:31], a[8:11], v[112:115]
    ds_read_b128 a[56:59], v233 offset:12288
    v_mfma_f32_16x16x32_bf16 v[116:119], a[28:31], a[12:15], v[116:119]
    v_mfma_f32_16x16x32_bf16 v[120:123], a[28:31], a[16:19], v[120:123]
    ds_read_b128 a[60:63], v233 offset:14336
    v_mfma_f32_16x16x32_bf16 v[124:127], a[32:35], a[0:3], v[124:127]
    ds_read_b128 a[64:67], v233 offset:16384
    v_mfma_f32_16x16x32_bf16 v[128:131], a[32:35], a[4:7], v[128:131]
    v_mfma_f32_16x16x32_bf16 v[132:135], a[32:35], a[8:11], v[132:135]
    ds_read_b128 a[68:71], v233 offset:18432
    v_mfma_f32_16x16x32_bf16 v[136:139], a[32:35], a[12:15], v[136:139]
    ds_read_b64_tr_b16 a[76:77], v3 offset:16384
    v_mfma_f32_16x16x32_bf16 v[140:143], a[32:35], a[16:19], v[140:143]
    v_mfma_f32_16x16x32_bf16 v[144:147], a[36:39], a[0:3], v[144:147]
    ds_read_b64_tr_b16 a[78:79], v3 offset:17408
    v_mfma_f32_16x16x32_bf16 v[148:151], a[36:39], a[4:7], v[148:151]
    v_mfma_f32_16x16x32_bf16 v[152:155], a[36:39], a[8:11], v[152:155]
    ds_read_b64_tr_b16 a[80:81], v4 offset:16384
    v_mfma_f32_16x16x32_bf16 v[156:159], a[36:39], a[12:15], v[156:159]
    ds_read_b64_tr_b16 a[82:83], v4 offset:17408
    v_mfma_f32_16x16x32_bf16 v[160:163], a[36:39], a[16:19], v[160:163]
    v_mfma_f32_16x16x32_bf16 v[164:167], a[40:43], a[0:3], v[164:167]
    ds_read_b64_tr_b16 a[84:85], v5 offset:16384
    v_mfma_f32_16x16x32_bf16 v[168:171], a[40:43], a[4:7], v[168:171]
    v_mfma_f32_16x16x32_bf16 v[172:175], a[40:43], a[8:11], v[172:175]
    ds_read_b64_tr_b16 a[86:87], v5 offset:17408
    v_mfma_f32_16x16x32_bf16 v[176:179], a[40:43], a[12:15], v[176:179]
    ds_read_b64_tr_b16 a[88:89], v6 offset:16384
    v_mfma_f32_16x16x32_bf16 v[180:183], a[40:43], a[16:19], v[180:183]
    v_mfma_f32_16x16x32_bf16 v[184:187], a[44:47], a[0:3], v[184:187]
    ds_read_b64_tr_b16 a[90:91], v6 offset:17408
    v_mfma_f32_16x16x32_bf16 v[188:191], a[44:47], a[4:7], v[188:191]
    ds_read_b64_tr_b16 a[92:93], v7 offset:16384
    v_mfma_f32_16x16x32_bf16 v[192:195], a[44:47], a[8:11], v[192:195]
    v_mfma_f32_16x16x32_bf16 v[196:199], a[44:47], a[12:15], v[196:199]
    ds_read_b64_tr_b16 a[94:95], v7 offset:17408
    v_mfma_f32_16x16x32_bf16 v[200:203], a[44:47], a[16:19], v[200:203]
    v_mfma_f32_16x16x32_bf16 v[204:207], a[48:51], a[0:3], v[204:207]
    ds_read_b64_tr_b16 a[96:97], v8 offset:16384
    v_mfma_f32_16x16x32_bf16 v[208:211], a[48:51], a[4:7], v[208:211]
    ds_read_b64_tr_b16 a[98:99], v8 offset:17408
    v_mfma_f32_16x16x32_bf16 v[212:215], a[48:51], a[8:11], v[212:215]
    v_mfma_f32_16x16x32_bf16 v[216:219], a[48:51], a[12:15], v[216:219]
    ds_read_b64_tr_b16 a[100:101], v9 offset:16384
    v_mfma_f32_16x16x32_bf16 v[220:223], a[48:51], a[16:19], v[220:223]
    ds_read_b64_tr_b16 a[102:103], v9 offset:17408
    s_waitcnt lgkmcnt(0)
    v_mfma_f32_16x16x32_bf16 v[64:67], a[72:75], a[52:55], v[64:67]
    v_mfma_f32_16x16x32_bf16 v[68:71], a[72:75], a[56:59], v[68:71]
    v_mfma_f32_16x16x32_bf16 v[72:75], a[72:75], a[60:63], v[72:75]
    v_mfma_f32_16x16x32_bf16 v[76:79], a[72:75], a[64:67], v[76:79]
    v_mfma_f32_16x16x32_bf16 v[80:83], a[72:75], a[68:71], v[80:83]
    v_mfma_f32_16x16x32_bf16 v[84:87], a[76:79], a[52:55], v[84:87]
    s_barrier
    v_mfma_f32_16x16x32_bf16 v[88:91], a[76:79], a[56:59], v[88:91]
    v_mfma_f32_16x16x32_bf16 v[92:95], a[76:79], a[60:63], v[92:95]
    v_mfma_f32_16x16x32_bf16 v[96:99], a[76:79], a[64:67], v[96:99]
    s_add_u32 m0, s28, 24576
    v_mfma_f32_16x16x32_bf16 v[100:103], a[76:79], a[68:71], v[100:103]
    v_mfma_f32_16x16x32_bf16 v[104:107], a[80:83], a[52:55], v[104:107]
    v_mfma_f32_16x16x32_bf16 v[108:111], a[80:83], a[56:59], v[108:111]
    buffer_load_dwordx4 v21, s[16:19], s30 offen nt lds
    v_mfma_f32_16x16x32_bf16 v[112:115], a[80:83], a[60:63], v[112:115]
    v_mfma_f32_16x16x32_bf16 v[116:119], a[80:83], a[64:67], v[116:119]
    buffer_load_dwordx4 v22, s[16:19], s30 offen offset:1024 nt lds
    v_mfma_f32_16x16x32_bf16 v[120:123], a[80:83], a[68:71], v[120:123]
    v_mfma_f32_16x16x32_bf16 v[124:127], a[84:87], a[52:55], v[124:127]
    v_mfma_f32_16x16x32_bf16 v[128:131], a[84:87], a[56:59], v[128:131]
    buffer_load_dwordx4 v21, s[16:19], s30 offen offset:2048 nt lds
    v_mfma_f32_16x16x32_bf16 v[132:135], a[84:87], a[60:63], v[132:135]
    v_mfma_f32_16x16x32_bf16 v[136:139], a[84:87], a[64:67], v[136:139]
    v_mfma_f32_16x16x32_bf16 v[140:143], a[84:87], a[68:71], v[140:143]
    buffer_load_dwordx4 v22, s[16:19], s30 offen offset:3072 nt lds
    v_mfma_f32_16x16x32_bf16 v[144:147], a[88:91], a[52:55], v[144:147]
    v_mfma_f32_16x16x32_bf16 v[148:151], a[88:91], a[56:59], v[148:151]
    s_add_u32 s30, s30, 4096
    v_mfma_f32_16x16x32_bf16 v[152:155], a[88:91], a[60:63], v[152:155]
    v_mfma_f32_16x16x32_bf16 v[156:159], a[88:91], a[64:67], v[156:159]
    v_mfma_f32_16x16x32_bf16 v[160:163], a[88:91], a[68:71], v[160:163]
    s_add_u32 m0, s28, 28672
    v_mfma_f32_16x16x32_bf16 v[164:167], a[92:95], a[52:55], v[164:167]
    v_mfma_f32_16x16x32_bf16 v[168:171], a[92:95], a[56:59], v[168:171]
    buffer_load_dwordx4 v21, s[16:19], s30 offen nt lds
    v_mfma_f32_16x16x32_bf16 v[172:175], a[92:95], a[60:63], v[172:175]
    v_mfma_f32_16x16x32_bf16 v[176:179], a[92:95], a[64:67], v[176:179]
    v_mfma_f32_16x16x32_bf16 v[180:183], a[92:95], a[68:71], v[180:183]
    buffer_load_dwordx4 v22, s[16:19], s30 offen offset:1024 nt lds
    v_mfma_f32_16x16x32_bf16 v[184:187], a[96:99], a[52:55], v[184:187]
    v_mfma_f32_16x16x32_bf16 v[188:191], a[96:99], a[56:59], v[188:191]
    v_mfma_f32_16x16x32_bf16 v[192:195], a[96:99], a[60:63], v[192:195]
    buffer_load_dwordx4 v21, s[16:19], s30 offen offset:2048 nt lds
    v_mfma_f32_16x16x32_bf16 v[196:199], a[96:99], a[64:67], v[196:199]
    v_mfma_f32_16x16x32_bf16 v[200:203], a[96:99], a[68:71], v[200:203]
    buffer_load_dwordx4 v22, s[16:19], s30 offen offset:3072 nt lds
    v_mfma_f32_16x16x32_bf16 v[204:207], a[100:103], a[52:55], v[204:207]
    v_mfma_f32_16x16x32_bf16 v[208:211], a[100:103], a[56:59], v[208:211]
    v_mfma_f32_16x16x32_bf16 v[212:215], a[100:103], a[60:63], v[212:215]
    s_add_u32 s30, s30, 4096
    v_mfma_f32_16x16x32_bf16 v[216:219], a[100:103], a[64:67], v[216:219]
    v_mfma_f32_16x16x32_bf16 v[220:223], a[100:103], a[68:71], v[220:223]
    s_and_b32 s30, s30, 0x1ffff
    s_or_b32 s30, s30, s3
    v_mov_b32 v2, v31
    v_xor_b32 v3, 32, v31
    v_xor_b32 v4, 64, v31
    v_xor_b32 v5, 96, v31
    v_xor_b32 v6, 128, v31
    v_xor_b32 v7, 160, v31
    v_xor_b32 v8, 192, v31
    v_xor_b32 v9, 224, v31
    v_mul_f32 v64, s61, v64
    v_mul_f32 v65, s61, v65
    v_mul_f32 v66, s61, v66
    v_mul_f32 v67, s61, v67
    v_mul_f32 v84, s61, v84
    v_mul_f32 v85, s61, v85
    v_mul_f32 v86, s61, v86
    v_mul_f32 v87, s61, v87
    v_cvt_pk_bf16_f32 v64, v64, v65
    v_cvt_pk_bf16_f32 v65, v66, v67
    v_cvt_pk_bf16_f32 v84, v84, v85
    v_cvt_pk_bf16_f32 v85, v86, v87
    v_mul_f32 v104, s61, v104
    v_mul_f32 v105, s61, v105
    v_mul_f32 v106, s61, v106
    v_mul_f32 v107, s61, v107
    v_mul_f32 v124, s61, v124
    v_mul_f32 v125, s61, v125
    v_mul_f32 v126, s61, v126
    v_mul_f32 v127, s61, v127
    v_cvt_pk_bf16_f32 v104, v104, v105
    v_cvt_pk_bf16_f32 v105, v106, v107
    v_cvt_pk_bf16_f32 v124, v124, v125
    v_cvt_pk_bf16_f32 v125, v126, v127
    v_mul_f32 v144, s61, v144
    v_mul_f32 v145, s61, v145
    v_mul_f32 v146, s61, v146
    v_mul_f32 v147, s61, v147
    v_mul_f32 v164, s61, v164
    v_mul_f32 v165, s61, v165
    v_mul_f32 v166, s61, v166
    v_mul_f32 v167, s61, v167
    v_cvt_pk_bf16_f32 v144, v144, v145
    v_cvt_pk_bf16_f32 v145, v146, v147
    v_cvt_pk_bf16_f32 v164, v164, v165
    v_cvt_pk_bf16_f32 v165, v166, v167
    v_mul_f32 v184, s61, v184
    v_mul_f32 v185, s61, v185
    v_mul_f32 v186, s61, v186
    v_mul_f32 v187, s61, v187
    v_mul_f32 v204, s61, v204
    v_mul_f32 v205, s61, v205
    v_mul_f32 v206, s61, v206
    v_mul_f32 v207, s61, v207
    v_cvt_pk_bf16_f32 v184, v184, v185
    v_cvt_pk_bf16_f32 v185, v186, v187
    v_cvt_pk_bf16_f32 v204, v204, v205
    v_cvt_pk_bf16_f32 v205, v206, v207
    v_mul_f32 v68, s61, v68
    v_mul_f32 v69, s61, v69
    v_mul_f32 v70, s61, v70
    v_mul_f32 v71, s61, v71
    v_mul_f32 v88, s61, v88
    v_mul_f32 v89, s61, v89
    v_mul_f32 v90, s61, v90
    v_mul_f32 v91, s61, v91
    v_cvt_pk_bf16_f32 v68, v68, v69
    v_cvt_pk_bf16_f32 v69, v70, v71
    v_cvt_pk_bf16_f32 v88, v88, v89
    v_cvt_pk_bf16_f32 v89, v90, v91
    v_mul_f32 v108, s61, v108
    v_mul_f32 v109, s61, v109
    v_mul_f32 v110, s61, v110
    v_mul_f32 v111, s61, v111
    v_mul_f32 v128, s61, v128
    v_mul_f32 v129, s61, v129
    v_mul_f32 v130, s61, v130
    v_mul_f32 v131, s61, v131
    v_cvt_pk_bf16_f32 v108, v108, v109
    v_cvt_pk_bf16_f32 v109, v110, v111
    v_cvt_pk_bf16_f32 v128, v128, v129
    v_cvt_pk_bf16_f32 v129, v130, v131
    v_mul_f32 v148, s61, v148
    v_mul_f32 v149, s61, v149
    v_mul_f32 v150, s61, v150
    v_mul_f32 v151, s61, v151
    v_mul_f32 v168, s61, v168
    v_mul_f32 v169, s61, v169
    v_mul_f32 v170, s61, v170
    v_mul_f32 v171, s61, v171
    v_cvt_pk_bf16_f32 v148, v148, v149
    v_cvt_pk_bf16_f32 v149, v150, v151
    v_cvt_pk_bf16_f32 v168, v168, v169
    v_cvt_pk_bf16_f32 v169, v170, v171
    v_mul_f32 v188, s61, v188
    v_mul_f32 v189, s61, v189
    v_mul_f32 v190, s61, v190
    v_mul_f32 v191, s61, v191
    v_mul_f32 v208, s61, v208
    v_mul_f32 v209, s61, v209
    v_mul_f32 v210, s61, v210
    v_mul_f32 v211, s61, v211
    v_cvt_pk_bf16_f32 v188, v188, v189
    v_cvt_pk_bf16_f32 v189, v190, v191
    v_cvt_pk_bf16_f32 v208, v208, v209
    v_cvt_pk_bf16_f32 v209, v210, v211
    v_mul_f32 v72, s61, v72
    v_mul_f32 v73, s61, v73
    v_mul_f32 v74, s61, v74
    v_mul_f32 v75, s61, v75
    v_mul_f32 v92, s61, v92
    v_mul_f32 v93, s61, v93
    v_mul_f32 v94, s61, v94
    v_mul_f32 v95, s61, v95
    v_cvt_pk_bf16_f32 v72, v72, v73
    v_cvt_pk_bf16_f32 v73, v74, v75
    v_cvt_pk_bf16_f32 v92, v92, v93
    v_cvt_pk_bf16_f32 v93, v94, v95
    v_mul_f32 v112, s61, v112
    v_mul_f32 v113, s61, v113
    v_mul_f32 v114, s61, v114
    v_mul_f32 v115, s61, v115
    v_mul_f32 v132, s61, v132
    v_mul_f32 v133, s61, v133
    v_mul_f32 v134, s61, v134
    v_mul_f32 v135, s61, v135
    v_cvt_pk_bf16_f32 v112, v112, v113
    v_cvt_pk_bf16_f32 v113, v114, v115
    v_cvt_pk_bf16_f32 v132, v132, v133
    v_cvt_pk_bf16_f32 v133, v134, v135
    v_mul_f32 v152, s61, v152
    v_mul_f32 v153, s61, v153
    v_mul_f32 v154, s61, v154
    v_mul_f32 v155, s61, v155
    v_mul_f32 v172, s61, v172
    v_mul_f32 v173, s61, v173
    v_mul_f32 v174, s61, v174
    v_mul_f32 v175, s61, v175
    v_cvt_pk_bf16_f32 v152, v152, v153
    v_cvt_pk_bf16_f32 v153, v154, v155
    v_cvt_pk_bf16_f32 v172, v172, v173
    v_cvt_pk_bf16_f32 v173, v174, v175
    v_mul_f32 v192, s61, v192
    v_mul_f32 v193, s61, v193
    v_mul_f32 v194, s61, v194
    v_mul_f32 v195, s61, v195
    v_mul_f32 v212, s61, v212
    v_mul_f32 v213, s61, v213
    v_mul_f32 v214, s61, v214
    v_mul_f32 v215, s61, v215
    v_cvt_pk_bf16_f32 v192, v192, v193
    v_cvt_pk_bf16_f32 v193, v194, v195
    v_cvt_pk_bf16_f32 v212, v212, v213
    v_cvt_pk_bf16_f32 v213, v214, v215
    v_mul_f32 v76, s61, v76
    v_mul_f32 v77, s61, v77
    v_mul_f32 v78, s61, v78
    v_mul_f32 v79, s61, v79
    v_mul_f32 v96, s61, v96
    v_mul_f32 v97, s61, v97
    v_mul_f32 v98, s61, v98
    v_mul_f32 v99, s61, v99
    v_cvt_pk_bf16_f32 v76, v76, v77
    v_cvt_pk_bf16_f32 v77, v78, v79
    v_cvt_pk_bf16_f32 v96, v96, v97
    v_cvt_pk_bf16_f32 v97, v98, v99
    v_mul_f32 v116, s61, v116
    v_mul_f32 v117, s61, v117
    v_mul_f32 v118, s61, v118
    v_mul_f32 v119, s61, v119
    v_mul_f32 v136, s61, v136
    v_mul_f32 v137, s61, v137
    v_mul_f32 v138, s61, v138
    v_mul_f32 v139, s61, v139
    v_cvt_pk_bf16_f32 v116, v116, v117
    v_cvt_pk_bf16_f32 v117, v118, v119
    v_cvt_pk_bf16_f32 v136, v136, v137
    v_cvt_pk_bf16_f32 v137, v138, v139
    v_mul_f32 v156, s61, v156
    v_mul_f32 v157, s61, v157
    v_mul_f32 v158, s61, v158
    v_mul_f32 v159, s61, v159
    v_mul_f32 v176, s61, v176
    v_mul_f32 v177, s61, v177
    v_mul_f32 v178, s61, v178
    v_mul_f32 v179, s61, v179
    v_cvt_pk_bf16_f32 v156, v156, v157
    v_cvt_pk_bf16_f32 v157, v158, v159
    v_cvt_pk_bf16_f32 v176, v176, v177
    v_cvt_pk_bf16_f32 v177, v178, v179
    v_mul_f32 v196, s61, v196
    v_mul_f32 v197, s61, v197
    v_mul_f32 v198, s61, v198
    v_mul_f32 v199, s61, v199
    v_mul_f32 v216, s61, v216
    v_mul_f32 v217, s61, v217
    v_mul_f32 v218, s61, v218
    v_mul_f32 v219, s61, v219
    v_cvt_pk_bf16_f32 v196, v196, v197
    v_cvt_pk_bf16_f32 v197, v198, v199
    v_cvt_pk_bf16_f32 v216, v216, v217
    v_cvt_pk_bf16_f32 v217, v218, v219
    v_mul_f32 v80, s61, v80
    v_mul_f32 v81, s61, v81
    v_mul_f32 v82, s61, v82
    v_mul_f32 v83, s61, v83
    v_mul_f32 v100, s61, v100
    v_mul_f32 v101, s61, v101
    v_mul_f32 v102, s61, v102
    v_mul_f32 v103, s61, v103
    v_cvt_pk_bf16_f32 v80, v80, v81
    v_cvt_pk_bf16_f32 v81, v82, v83
    v_cvt_pk_bf16_f32 v100, v100, v101
    v_cvt_pk_bf16_f32 v101, v102, v103
    v_mul_f32 v120, s61, v120
    v_mul_f32 v121, s61, v121
    v_mul_f32 v122, s61, v122
    v_mul_f32 v123, s61, v123
    v_mul_f32 v140, s61, v140
    v_mul_f32 v141, s61, v141
    v_mul_f32 v142, s61, v142
    v_mul_f32 v143, s61, v143
    v_cvt_pk_bf16_f32 v120, v120, v121
    v_cvt_pk_bf16_f32 v121, v122, v123
    v_cvt_pk_bf16_f32 v140, v140, v141
    v_cvt_pk_bf16_f32 v141, v142, v143
    v_mul_f32 v160, s61, v160
    v_mul_f32 v161, s61, v161
    v_mul_f32 v162, s61, v162
    v_mul_f32 v163, s61, v163
    v_mul_f32 v180, s61, v180
    v_mul_f32 v181, s61, v181
    v_mul_f32 v182, s61, v182
    v_mul_f32 v183, s61, v183
    v_cvt_pk_bf16_f32 v160, v160, v161
    v_cvt_pk_bf16_f32 v161, v162, v163
    v_cvt_pk_bf16_f32 v180, v180, v181
    v_cvt_pk_bf16_f32 v181, v182, v183
    v_mul_f32 v200, s61, v200
    v_mul_f32 v201, s61, v201
    v_mul_f32 v202, s61, v202
    v_mul_f32 v203, s61, v203
    v_mul_f32 v220, s61, v220
    v_mul_f32 v221, s61, v221
    v_mul_f32 v222, s61, v222
    v_mul_f32 v223, s61, v223
    v_cvt_pk_bf16_f32 v200, v200, v201
    v_cvt_pk_bf16_f32 v201, v202, v203
    v_cvt_pk_bf16_f32 v220, v220, v221
    v_cvt_pk_bf16_f32 v221, v222, v223
    v_permlane32_swap_b32 v64, v84
    v_permlane32_swap_b32 v65, v85
    v_permlane32_swap_b32 v104, v124
    v_permlane32_swap_b32 v105, v125
    v_permlane32_swap_b32 v144, v164
    v_permlane32_swap_b32 v145, v165
    v_permlane32_swap_b32 v184, v204
    v_permlane32_swap_b32 v185, v205
    v_permlane32_swap_b32 v68, v88
    v_permlane32_swap_b32 v69, v89
    v_permlane32_swap_b32 v108, v128
    v_permlane32_swap_b32 v109, v129
    v_permlane32_swap_b32 v148, v168
    v_permlane32_swap_b32 v149, v169
    v_permlane32_swap_b32 v188, v208
    v_permlane32_swap_b32 v189, v209
    v_permlane32_swap_b32 v72, v92
    v_permlane32_swap_b32 v73, v93
    v_permlane32_swap_b32 v112, v132
    v_permlane32_swap_b32 v113, v133
    v_permlane32_swap_b32 v152, v172
    v_permlane32_swap_b32 v153, v173
    v_permlane32_swap_b32 v192, v212
    v_permlane32_swap_b32 v193, v213
    v_permlane32_swap_b32 v76, v96
    v_permlane32_swap_b32 v77, v97
    v_permlane32_swap_b32 v116, v136
    v_permlane32_swap_b32 v117, v137
    v_permlane32_swap_b32 v156, v176
    v_permlane32_swap_b32 v157, v177
    v_permlane32_swap_b32 v196, v216
    v_permlane32_swap_b32 v197, v217
    v_permlane32_swap_b32 v80, v100
    v_permlane32_swap_b32 v81, v101
    v_permlane32_swap_b32 v120, v140
    v_permlane32_swap_b32 v121, v141
    v_permlane32_swap_b32 v160, v180
    v_permlane32_swap_b32 v161, v181
    v_permlane32_swap_b32 v200, v220
    v_permlane32_swap_b32 v201, v221
    v_permlane16_swap_b32 v64, v84
    v_permlane16_swap_b32 v65, v85
    v_permlane16_swap_b32 v104, v124
    v_permlane16_swap_b32 v105, v125
    v_permlane16_swap_b32 v144, v164
    v_permlane16_swap_b32 v145, v165
    v_permlane16_swap_b32 v184, v204
    v_permlane16_swap_b32 v185, v205
    v_permlane16_swap_b32 v68, v88
    v_permlane16_swap_b32 v69, v89
    v_permlane16_swap_b32 v108, v128
    v_permlane16_swap_b32 v109, v129
    v_permlane16_swap_b32 v148, v168
    v_permlane16_swap_b32 v149, v169
    v_permlane16_swap_b32 v188, v208
    v_permlane16_swap_b32 v189, v209
    v_permlane16_swap_b32 v72, v92
    v_permlane16_swap_b32 v73, v93
    v_permlane16_swap_b32 v112, v132
    v_permlane16_swap_b32 v113, v133
    v_permlane16_swap_b32 v152, v172
    v_permlane16_swap_b32 v153, v173
    v_permlane16_swap_b32 v192, v212
    v_permlane16_swap_b32 v193, v213
    v_permlane16_swap_b32 v76, v96
    v_permlane16_swap_b32 v77, v97
    v_permlane16_swap_b32 v116, v136
    v_permlane16_swap_b32 v117, v137
    v_permlane16_swap_b32 v156, v176
    v_permlane16_swap_b32 v157, v177
    v_permlane16_swap_b32 v196, v216
    v_permlane16_swap_b32 v197, v217
    v_permlane16_swap_b32 v80, v100
    v_permlane16_swap_b32 v81, v101
    v_permlane16_swap_b32 v120, v140
    v_permlane16_swap_b32 v121, v141
    v_permlane16_swap_b32 v160, v180
    v_permlane16_swap_b32 v161, v181
    v_permlane16_swap_b32 v200, v220
    v_permlane16_swap_b32 v201, v221
    v_accvgpr_write_b32 a160, v64
    v_accvgpr_write_b32 a161, v65
    v_accvgpr_write_b32 a162, v84
    v_accvgpr_write_b32 a163, v85
    v_accvgpr_write_b32 a164, v104
    v_accvgpr_write_b32 a165, v105
    v_accvgpr_write_b32 a166, v124
    v_accvgpr_write_b32 a167, v125
    v_accvgpr_write_b32 a168, v144
    v_accvgpr_write_b32 a169, v145
    v_accvgpr_write_b32 a170, v164
    v_accvgpr_write_b32 a171, v165
    v_accvgpr_write_b32 a172, v184
    v_accvgpr_write_b32 a173, v185
    v_accvgpr_write_b32 a174, v204
    v_accvgpr_write_b32 a175, v205
    v_accvgpr_write_b32 a176, v68
    v_accvgpr_write_b32 a177, v69
    v_accvgpr_write_b32 a178, v88
    v_accvgpr_write_b32 a179, v89
    v_accvgpr_write_b32 a180, v108
    v_accvgpr_write_b32 a181, v109
    v_accvgpr_write_b32 a182, v128
    v_accvgpr_write_b32 a183, v129
    v_accvgpr_write_b32 a184, v148
    v_accvgpr_write_b32 a185, v149
    v_accvgpr_write_b32 a186, v168
    v_accvgpr_write_b32 a187, v169
    v_accvgpr_write_b32 a188, v188
    v_accvgpr_write_b32 a189, v189
    v_accvgpr_write_b32 a190, v208
    v_accvgpr_write_b32 a191, v209
    v_accvgpr_write_b32 a192, v72
    v_accvgpr_write_b32 a193, v73
    v_accvgpr_write_b32 a194, v92
    v_accvgpr_write_b32 a195, v93
    v_accvgpr_write_b32 a196, v112
    v_accvgpr_write_b32 a197, v113
    v_accvgpr_write_b32 a198, v132
    v_accvgpr_write_b32 a199, v133
    v_accvgpr_write_b32 a200, v152
    v_accvgpr_write_b32 a201, v153
    v_accvgpr_write_b32 a202, v172
    v_accvgpr_write_b32 a203, v173
    v_accvgpr_write_b32 a204, v192
    v_accvgpr_write_b32 a205, v193
    v_accvgpr_write_b32 a206, v212
    v_accvgpr_write_b32 a207, v213
    v_accvgpr_write_b32 a208, v76
    v_accvgpr_write_b32 a209, v77
    v_accvgpr_write_b32 a210, v96
    v_accvgpr_write_b32 a211, v97
    v_accvgpr_write_b32 a212, v116
    v_accvgpr_write_b32 a213, v117
    v_accvgpr_write_b32 a214, v136
    v_accvgpr_write_b32 a215, v137
    v_accvgpr_write_b32 a216, v156
    v_accvgpr_write_b32 a217, v157
    v_accvgpr_write_b32 a218, v176
    v_accvgpr_write_b32 a219, v177
    v_accvgpr_write_b32 a220, v196
    v_accvgpr_write_b32 a221, v197
    v_accvgpr_write_b32 a222, v216
    v_accvgpr_write_b32 a223, v217
    v_accvgpr_write_b32 a224, v80
    v_accvgpr_write_b32 a225, v81
    v_accvgpr_write_b32 a226, v100
    v_accvgpr_write_b32 a227, v101
    v_accvgpr_write_b32 a228, v120
    v_accvgpr_write_b32 a229, v121
    v_accvgpr_write_b32 a230, v140
    v_accvgpr_write_b32 a231, v141
    v_accvgpr_write_b32 a232, v160
    v_accvgpr_write_b32 a233, v161
    v_accvgpr_write_b32 a234, v180
    v_accvgpr_write_b32 a235, v181
    v_accvgpr_write_b32 a236, v200
    v_accvgpr_write_b32 a237, v201
    v_accvgpr_write_b32 a238, v220
    v_accvgpr_write_b32 a239, v221
    v_mov_b32 v196, 0x3f803f80
    v_mov_b32 v197, 0x3f803f80
    v_mov_b32 v198, 0x3f803f80
    v_mov_b32 v199, 0x3f803f80
    ds_read_b128 v[32:35], v13 offset:0
    ds_read_b128 v[36:39], v14 offset:0
    ds_read_b128 v[40:43], v15 offset:0
    ds_read_b128 v[44:47], v16 offset:0
    ds_read_b128 v[48:51], v13 offset:4096
    ds_read_b128 v[52:55], v14 offset:4096
    ds_read_b128 v[56:59], v15 offset:4096
    ds_read_b128 v[60:63], v16 offset:4096
    s_waitcnt lgkmcnt(0)
    s_barrier
    v_mfma_f32_16x16x32_bf16 v[64:67], v[32:35], a[160:163], 0
    v_mfma_f32_16x16x32_bf16 v[64:67], v[36:39], a[164:167], v[64:67]
    s_add_u32 m0, s28, 0
    v_mfma_f32_16x16x32_bf16 v[64:67], v[40:43], a[168:171], v[64:67]
    buffer_load_dwordx4 v17, s[12:15], s29 offen nt lds
    v_mfma_f32_16x16x32_bf16 v[64:67], v[44:47], a[172:175], v[64:67]
    buffer_load_dwordx4 v18, s[12:15], s29 offen offset:1024 nt lds
    v_mfma_f32_16x16x32_bf16 v[68:71], v[48:51], a[160:163], 0
    v_mfma_f32_16x16x32_bf16 v[68:71], v[52:55], a[164:167], v[68:71]
    buffer_load_dwordx4 v19, s[12:15], s29 offen offset:2048 nt lds
    v_mfma_f32_16x16x32_bf16 v[68:71], v[56:59], a[168:171], v[68:71]
    buffer_load_dwordx4 v20, s[12:15], s29 offen offset:3072 nt lds
    v_mfma_f32_16x16x32_bf16 v[68:71], v[60:63], a[172:175], v[68:71]
    s_add_u32 s29, s29, 4096
    v_mfma_f32_16x16x32_bf16 v[72:75], v[32:35], a[176:179], 0
    v_mfma_f32_16x16x32_bf16 v[72:75], v[36:39], a[180:183], v[72:75]
    s_add_u32 m0, s28, 4096
    v_mfma_f32_16x16x32_bf16 v[72:75], v[40:43], a[184:187], v[72:75]
    buffer_load_dwordx4 v17, s[12:15], s29 offen nt lds
    v_mfma_f32_16x16x32_bf16 v[72:75], v[44:47], a[188:191], v[72:75]
    buffer_load_dwordx4 v18, s[12:15], s29 offen offset:1024 nt lds
    v_mfma_f32_16x16x32_bf16 v[76:79], v[48:51], a[176:179], 0
    buffer_load_dwordx4 v19, s[12:15], s29 offen offset:2048 nt lds
    v_mfma_f32_16x16x32_bf16 v[76:79], v[52:55], a[180:183], v[76:79]
    buffer_load_dwordx4 v20, s[12:15], s29 offen offset:3072 nt lds
    v_mfma_f32_16x16x32_bf16 v[76:79], v[56:59], a[184:187], v[76:79]
    s_add_u32 s29, s29, 4096
    v_mfma_f32_16x16x32_bf16 v[76:79], v[60:63], a[188:191], v[76:79]
    s_and_b32 s29, s29, 0x1ffff
    s_or_b32 s29, s29, s3
    v_mfma_f32_16x16x32_bf16 v[80:83], v[32:35], a[192:195], 0
    v_mfma_f32_16x16x32_bf16 v[80:83], v[36:39], a[196:199], v[80:83]
    v_mfma_f32_16x16x32_bf16 v[80:83], v[40:43], a[200:203], v[80:83]
    v_mfma_f32_16x16x32_bf16 v[80:83], v[44:47], a[204:207], v[80:83]
    v_mfma_f32_16x16x32_bf16 v[84:87], v[48:51], a[192:195], 0
    v_mfma_f32_16x16x32_bf16 v[84:87], v[52:55], a[196:199], v[84:87]
    v_mfma_f32_16x16x32_bf16 v[84:87], v[56:59], a[200:203], v[84:87]
    v_mfma_f32_16x16x32_bf16 v[84:87], v[60:63], a[204:207], v[84:87]
    v_mfma_f32_16x16x32_bf16 v[88:91], v[32:35], a[208:211], 0
    v_mfma_f32_16x16x32_bf16 v[88:91], v[36:39], a[212:215], v[88:91]
    ds_read_b64_tr_b16 v[164:165], v2 offset:8192
    v_mfma_f32_16x16x32_bf16 v[88:91], v[40:43], a[216:219], v[88:91]
    ds_read_b64_tr_b16 v[166:167], v2 offset:12288
    v_mfma_f32_16x16x32_bf16 v[88:91], v[44:47], a[220:223], v[88:91]
    ds_read_b64_tr_b16 v[168:169], v3 offset:8192
    v_mfma_f32_16x16x32_bf16 v[92:95], v[48:51], a[208:211], 0
    ds_read_b64_tr_b16 v[170:171], v3 offset:12288
    v_mfma_f32_16x16x32_bf16 v[92:95], v[52:55], a[212:215], v[92:95]
    ds_read_b64_tr_b16 v[172:173], v4 offset:8192
    v_mfma_f32_16x16x32_bf16 v[92:95], v[56:59], a[216:219], v[92:95]
    ds_read_b64_tr_b16 v[174:175], v4 offset:12288
    v_mfma_f32_16x16x32_bf16 v[92:95], v[60:63], a[220:223], v[92:95]
    ds_read_b64_tr_b16 v[176:177], v5 offset:8192
    ds_read_b64_tr_b16 v[178:179], v5 offset:12288
    v_mfma_f32_16x16x32_bf16 v[96:99], v[32:35], a[224:227], 0
    ds_read_b64_tr_b16 v[180:181], v6 offset:8192
    v_mfma_f32_16x16x32_bf16 v[96:99], v[36:39], a[228:231], v[96:99]
    ds_read_b64_tr_b16 v[182:183], v6 offset:12288
    v_mfma_f32_16x16x32_bf16 v[96:99], v[40:43], a[232:235], v[96:99]
    ds_read_b64_tr_b16 v[184:185], v7 offset:8192
    v_mfma_f32_16x16x32_bf16 v[96:99], v[44:47], a[236:239], v[96:99]
    ds_read_b64_tr_b16 v[186:187], v7 offset:12288
    v_mfma_f32_16x16x32_bf16 v[100:103], v[48:51], a[224:227], 0
    ds_read_b64_tr_b16 v[188:189], v8 offset:8192
    v_mfma_f32_16x16x32_bf16 v[100:103], v[52:55], a[228:231], v[100:103]
    ds_read_b64_tr_b16 v[190:191], v8 offset:12288
    v_mfma_f32_16x16x32_bf16 v[100:103], v[56:59], a[232:235], v[100:103]
    ds_read_b64_tr_b16 v[192:193], v9 offset:8192
    v_mfma_f32_16x16x32_bf16 v[100:103], v[60:63], a[236:239], v[100:103]
    ds_read_b64_tr_b16 v[194:195], v9 offset:12288
    v_max3_f32 v24, v64, v65, v66
    v_max3_f32 v25, v67, v68, v69
    v_max3_f32 v24, v24, v70, v71
    v_max_f32 v24, v24, v25
    v_mov_b32 v25, v24
    s_nop 1
    v_permlane32_swap_b32 v24, v25
    v_max_f32 v24, v24, v25
    v_mov_b32 v25, v24
    s_nop 1
    v_permlane16_swap_b32 v24, v25
    v_max_f32 v24, v24, v25
    v_add_f32 v24, 0x40e00000, v24
    v_sub_f32 v124, 0, v24
    v_sub_f32 v125, 0, v24
    v_sub_f32 v126, 0, v24
    v_sub_f32 v127, 0, v24
    v_sub_f32 v64, v64, v24
    v_sub_f32 v65, v65, v24
    v_sub_f32 v66, v66, v24
    v_sub_f32 v67, v67, v24
    v_sub_f32 v68, v68, v24
    v_sub_f32 v69, v69, v24
    v_sub_f32 v70, v70, v24
    v_sub_f32 v71, v71, v24
    v_exp_f32 v200, v64
    v_exp_f32 v201, v65
    v_exp_f32 v202, v66
    v_exp_f32 v203, v67
    v_exp_f32 v204, v68
    v_cvt_pk_bf16_f32 v104, v200, v201
    v_exp_f32 v205, v69
    v_cvt_pk_bf16_f32 v105, v202, v203
    v_exp_f32 v206, v70
    v_exp_f32 v207, v71
    v_cvt_pk_bf16_f32 v106, v204, v205
    v_cvt_pk_bf16_f32 v107, v206, v207
    v_or3_b32 v23, v104, v105, v106
    v_or_b32 v23, v23, v107
    v_max3_f32 v24, v72, v73, v74
    v_max3_f32 v25, v75, v76, v77
    v_max3_f32 v24, v24, v78, v79
    v_max_f32 v24, v24, v25
    v_mov_b32 v25, v24
    s_nop 1
    v_permlane32_swap_b32 v24, v25
    v_max_f32 v24, v24, v25
    v_mov_b32 v25, v24
    s_nop 1
    v_permlane16_swap_b32 v24, v25
    v_max_f32 v24, v24, v25
    v_add_f32 v24, 0x40e00000, v24
    v_sub_f32 v128, 0, v24
    v_sub_f32 v129, 0, v24
    v_sub_f32 v130, 0, v24
    v_sub_f32 v131, 0, v24
    v_sub_f32 v72, v72, v24
    v_sub_f32 v73, v73, v24
    v_sub_f32 v74, v74, v24
    v_sub_f32 v75, v75, v24
    v_sub_f32 v76, v76, v24
    v_sub_f32 v77, v77, v24
    v_sub_f32 v78, v78, v24
    v_sub_f32 v79, v79, v24
    v_exp_f32 v208, v72
    v_exp_f32 v209, v73
    v_exp_f32 v210, v74
    v_exp_f32 v211, v75
    v_exp_f32 v212, v76
    v_cvt_pk_bf16_f32 v108, v208, v209
    v_exp_f32 v213, v77
    v_cvt_pk_bf16_f32 v109, v210, v211
    v_exp_f32 v214, v78
    v_exp_f32 v215, v79
    v_cvt_pk_bf16_f32 v110, v212, v213
    v_cvt_pk_bf16_f32 v111, v214, v215
    v_or3_b32 v23, v23, v108, v109
    v_or3_b32 v23, v23, v110, v111
    v_max3_f32 v24, v80, v81, v82
    v_max3_f32 v25, v83, v84, v85
    v_max3_f32 v24, v24, v86, v87
    v_max_f32 v24, v24, v25
    v_mov_b32 v25, v24
    s_nop 1
    v_permlane32_swap_b32 v24, v25
    v_max_f32 v24, v24, v25
    v_mov_b32 v25, v24
    s_nop 1
    v_permlane16_swap_b32 v24, v25
    v_max_f32 v24, v24, v25
    v_add_f32 v24, 0x40e00000, v24
    v_sub_f32 v132, 0, v24
    v_sub_f32 v133, 0, v24
    v_sub_f32 v134, 0, v24
    v_sub_f32 v135, 0, v24
    v_sub_f32 v80, v80, v24
    v_sub_f32 v81, v81, v24
    v_sub_f32 v82, v82, v24
    v_sub_f32 v83, v83, v24
    v_sub_f32 v84, v84, v24
    v_sub_f32 v85, v85, v24
    v_sub_f32 v86, v86, v24
    v_sub_f32 v87, v87, v24
    v_exp_f32 v200, v80
    v_exp_f32 v201, v81
    v_exp_f32 v202, v82
    v_exp_f32 v203, v83
    v_exp_f32 v204, v84
    v_cvt_pk_bf16_f32 v112, v200, v201
    v_exp_f32 v205, v85
    v_cvt_pk_bf16_f32 v113, v202, v203
    v_exp_f32 v206, v86
    v_exp_f32 v207, v87
    v_cvt_pk_bf16_f32 v114, v204, v205
    v_cvt_pk_bf16_f32 v115, v206, v207
    v_or3_b32 v23, v23, v112, v113
    v_or3_b32 v23, v23, v114, v115
    v_max3_f32 v24, v88, v89, v90
    v_max3_f32 v25, v91, v92, v93
    v_max3_f32 v24, v24, v94, v95
    v_max_f32 v24, v24, v25
    v_mov_b32 v25, v24
    s_nop 1
    v_permlane32_swap_b32 v24, v25
    v_max_f32 v24, v24, v25
    v_mov_b32 v25, v24
    s_nop 1
    v_permlane16_swap_b32 v24, v25
    v_max_f32 v24, v24, v25
    v_add_f32 v24, 0x40e00000, v24
    v_sub_f32 v136, 0, v24
    v_sub_f32 v137, 0, v24
    v_sub_f32 v138, 0, v24
    v_sub_f32 v139, 0, v24
    v_sub_f32 v88, v88, v24
    v_sub_f32 v89, v89, v24
    v_sub_f32 v90, v90, v24
    v_sub_f32 v91, v91, v24
    v_sub_f32 v92, v92, v24
    v_sub_f32 v93, v93, v24
    v_sub_f32 v94, v94, v24
    v_sub_f32 v95, v95, v24
    v_exp_f32 v208, v88
    v_exp_f32 v209, v89
    v_exp_f32 v210, v90
    v_exp_f32 v211, v91
    v_exp_f32 v212, v92
    v_cvt_pk_bf16_f32 v116, v208, v209
    v_exp_f32 v213, v93
    v_cvt_pk_bf16_f32 v117, v210, v211
    v_exp_f32 v214, v94
    v_exp_f32 v215, v95
    v_cvt_pk_bf16_f32 v118, v212, v213
    v_cvt_pk_bf16_f32 v119, v214, v215
    v_or3_b32 v23, v23, v116, v117
    v_or3_b32 v23, v23, v118, v119
    v_max3_f32 v24, v96, v97, v98
    v_max3_f32 v25, v99, v100, v101
    v_max3_f32 v24, v24, v102, v103
    v_max_f32 v24, v24, v25
    v_mov_b32 v25, v24
    s_nop 1
    v_permlane32_swap_b32 v24, v25
    v_max_f32 v24, v24, v25
    v_mov_b32 v25, v24
    s_nop 1
    v_permlane16_swap_b32 v24, v25
    v_max_f32 v24, v24, v25
    v_add_f32 v24, 0x40e00000, v24
    v_sub_f32 v140, 0, v24
    v_sub_f32 v141, 0, v24
    v_sub_f32 v142, 0, v24
    v_sub_f32 v143, 0, v24
    v_sub_f32 v96, v96, v24
    v_sub_f32 v97, v97, v24
    v_sub_f32 v98, v98, v24
    v_sub_f32 v99, v99, v24
    v_sub_f32 v100, v100, v24
    v_sub_f32 v101, v101, v24
    v_sub_f32 v102, v102, v24
    v_sub_f32 v103, v103, v24
    v_exp_f32 v200, v96
    v_exp_f32 v201, v97
    v_exp_f32 v202, v98
    v_exp_f32 v203, v99
    v_exp_f32 v204, v100
    v_cvt_pk_bf16_f32 v120, v200, v201
    v_exp_f32 v205, v101
    v_cvt_pk_bf16_f32 v121, v202, v203
    v_exp_f32 v206, v102
    v_exp_f32 v207, v103
    v_cvt_pk_bf16_f32 v122, v204, v205
    v_cvt_pk_bf16_f32 v123, v206, v207
    v_or3_b32 v23, v23, v120, v121
    v_or3_b32 v23, v23, v122, v123
    s_waitcnt lgkmcnt(0)
    v_mfma_f32_16x16x32_bf16 a[0:3], v[164:167], v[104:107], 0
    v_mfma_f32_16x16x32_bf16 a[20:23], v[168:171], v[104:107], 0
    v_mfma_f32_16x16x32_bf16 a[40:43], v[172:175], v[104:107], 0
    s_add_u32 m0, s28, 8192
    v_mfma_f32_16x16x32_bf16 a[60:63], v[176:179], v[104:107], 0
    v_mfma_f32_16x16x32_bf16 a[80:83], v[180:183], v[104:107], 0
    buffer_load_dwordx4 v21, s[16:19], s30 offen nt lds
    v_mfma_f32_16x16x32_bf16 a[100:103], v[184:187], v[104:107], 0
    v_mfma_f32_16x16x32_bf16 a[120:123], v[188:191], v[104:107], 0
    buffer_load_dwordx4 v22, s[16:19], s30 offen offset:1024 nt lds
    v_mfma_f32_16x16x32_bf16 a[140:143], v[192:195], v[104:107], 0
    v_mfma_f32_16x16x32_bf16 v[144:147], v[196:199], v[104:107], 0
    buffer_load_dwordx4 v21, s[16:19], s30 offen offset:2048 nt lds
    v_mfma_f32_16x16x32_bf16 a[4:7], v[164:167], v[108:111], 0
    v_mfma_f32_16x16x32_bf16 a[24:27], v[168:171], v[108:111], 0
    buffer_load_dwordx4 v22, s[16:19], s30 offen offset:3072 nt lds
    v_mfma_f32_16x16x32_bf16 a[44:47], v[172:175], v[108:111], 0
    v_mfma_f32_16x16x32_bf16 a[64:67], v[176:179], v[108:111], 0
    s_add_u32 s30, s30, 4096
    v_mfma_f32_16x16x32_bf16 a[84:87], v[180:183], v[108:111], 0
    v_mfma_f32_16x16x32_bf16 a[104:107], v[184:187], v[108:111], 0
    s_add_u32 m0, s28, 12288
    v_mfma_f32_16x16x32_bf16 a[124:127], v[188:191], v[108:111], 0
    v_mfma_f32_16x16x32_bf16 a[144:147], v[192:195], v[108:111], 0
    buffer_load_dwordx4 v21, s[16:19], s30 offen nt lds
    v_mfma_f32_16x16x32_bf16 v[148:151], v[196:199], v[108:111], 0
    v_mfma_f32_16x16x32_bf16 a[8:11], v[164:167], v[112:115], 0
    buffer_load_dwordx4 v22, s[16:19], s30 offen offset:1024 nt lds
    v_mfma_f32_16x16x32_bf16 a[28:31], v[168:171], v[112:115], 0
    v_mfma_f32_16x16x32_bf16 a[48:51], v[172:175], v[112:115], 0
    buffer_load_dwordx4 v21, s[16:19], s30 offen offset:2048 nt lds
    v_mfma_f32_16x16x32_bf16 a[68:71], v[176:179], v[112:115], 0
    v_mfma_f32_16x16x32_bf16 a[88:91], v[180:183], v[112:115], 0
    buffer_load_dwordx4 v22, s[16:19], s30 offen offset:3072 nt lds
    v_mfma_f32_16x16x32_bf16 a[108:111], v[184:187], v[112:115], 0
    v_mfma_f32_16x16x32_bf16 a[128:131], v[188:191], v[112:115], 0
    s_add_u32 s30, s30, 4096
    v_mfma_f32_16x16x32_bf16 a[148:151], v[192:195], v[112:115], 0
    v_mfma_f32_16x16x32_bf16 v[152:155], v[196:199], v[112:115], 0
    s_and_b32 s30, s30, 0x1ffff
    s_or_b32 s30, s30, s3
    v_mfma_f32_16x16x32_bf16 a[12:15], v[164:167], v[116:119], 0
    v_mfma_f32_16x16x32_bf16 a[32:35], v[168:171], v[116:119], 0
    s_waitcnt vmcnt(24)
    v_mfma_f32_16x16x32_bf16 a[52:55], v[172:175], v[116:119], 0
    v_mfma_f32_16x16x32_bf16 a[72:75], v[176:179], v[116:119], 0
    ds_read_b128 v[32:35], v13 offset:16384
    v_mfma_f32_16x16x32_bf16 a[92:95], v[180:183], v[116:119], 0
    v_mfma_f32_16x16x32_bf16 a[112:115], v[184:187], v[116:119], 0
    ds_read_b128 v[36:39], v14 offset:16384
    v_mfma_f32_16x16x32_bf16 a[132:135], v[188:191], v[116:119], 0
    v_mfma_f32_16x16x32_bf16 a[152:155], v[192:195], v[116:119], 0
    ds_read_b128 v[40:43], v15 offset:16384
    v_mfma_f32_16x16x32_bf16 v[156:159], v[196:199], v[116:119], 0
    v_mfma_f32_16x16x32_bf16 a[16:19], v[164:167], v[120:123], 0
    ds_read_b128 v[44:47], v16 offset:16384
    v_mfma_f32_16x16x32_bf16 a[36:39], v[168:171], v[120:123], 0
    v_mfma_f32_16x16x32_bf16 a[56:59], v[172:175], v[120:123], 0
    ds_read_b128 v[48:51], v13 offset:20480
    v_mfma_f32_16x16x32_bf16 a[76:79], v[176:179], v[120:123], 0
    v_mfma_f32_16x16x32_bf16 a[96:99], v[180:183], v[120:123], 0
    ds_read_b128 v[52:55], v14 offset:20480
    v_mfma_f32_16x16x32_bf16 a[116:119], v[184:187], v[120:123], 0
    v_mfma_f32_16x16x32_bf16 a[136:139], v[188:191], v[120:123], 0
    ds_read_b128 v[56:59], v15 offset:20480
    v_mfma_f32_16x16x32_bf16 a[156:159], v[192:195], v[120:123], 0
    v_mfma_f32_16x16x32_bf16 v[160:163], v[196:199], v[120:123], 0
    ds_read_b128 v[60:63], v16 offset:20480
    s_waitcnt lgkmcnt(0)
    s_barrier
    v_mfma_f32_16x16x32_bf16 v[64:67], v[32:35], a[160:163], v[124:127]
    v_mfma_f32_16x16x32_bf16 v[64:67], v[36:39], a[164:167], v[64:67]
    s_add_u32 m0, s28, 16384
    v_mfma_f32_16x16x32_bf16 v[64:67], v[40:43], a[168:171], v[64:67]
    buffer_load_dwordx4 v17, s[12:15], s29 offen nt lds
    v_mfma_f32_16x16x32_bf16 v[64:67], v[44:47], a[172:175], v[64:67]
    buffer_load_dwordx4 v18, s[12:15], s29 offen offset:1024 nt lds
    v_mfma_f32_16x16x32_bf16 v[68:71], v[48:51], a[160:163], v[124:127]
    v_mfma_f32_16x16x32_bf16 v[68:71], v[52:55], a[164:167], v[68:71]
    buffer_load_dwordx4 v19, s[12:15], s29 offen offset:2048 nt lds
    v_mfma_f32_16x16x32_bf16 v[68:71], v[56:59], a[168:171], v[68:71]
    buffer_load_dwordx4 v20, s[12:15], s29 offen offset:3072 nt lds
    v_mfma_f32_16x16x32_bf16 v[68:71], v[60:63], a[172:175], v[68:71]
    s_add_u32 s29, s29, 4096
    v_mfma_f32_16x16x32_bf16 v[72:75], v[32:35], a[176:179], v[128:131]
    v_exp_f32 v200, v64
    s_add_u32 m0, s28, 20480
    v_mfma_f32_16x16x32_bf16 v[72:75], v[36:39], a[180:183], v[72:75]
    v_exp_f32 v201, v65
    v_exp_f32 v202, v66
    buffer_load_dwordx4 v17, s[12:15], s29 offen nt lds
    v_mfma_f32_16x16x32_bf16 v[72:75], v[40:43], a[184:187], v[72:75]
    v_exp_f32 v203, v67
    v_exp_f32 v204, v68
    v_mfma_f32_16x16x32_bf16 v[72:75], v[44:47], a[188:191], v[72:75]
    buffer_load_dwordx4 v18, s[12:15], s29 offen offset:1024 nt lds
    v_cvt_pk_bf16_f32 v104, v200, v201
    v_exp_f32 v205, v69
    v_mfma_f32_16x16x32_bf16 v[76:79], v[48:51], a[176:179], v[128:131]
    buffer_load_dwordx4 v19, s[12:15], s29 offen offset:2048 nt lds
    v_cvt_pk_bf16_f32 v105, v202, v203
    v_exp_f32 v206, v70
    v_mfma_f32_16x16x32_bf16 v[76:79], v[52:55], a[180:183], v[76:79]
    buffer_load_dwordx4 v20, s[12:15], s29 offen offset:3072 nt lds
    v_exp_f32 v207, v71
    v_mfma_f32_16x16x32_bf16 v[76:79], v[56:59], a[184:187], v[76:79]
    v_cvt_pk_bf16_f32 v106, v204, v205
    s_add_u32 s29, s29, 4096
    v_cvt_pk_bf16_f32 v107, v206, v207
    v_mfma_f32_16x16x32_bf16 v[76:79], v[60:63], a[188:191], v[76:79]
    v_or3_b32 v23, v104, v105, v106
    s_and_b32 s29, s29, 0x1ffff
    s_or_b32 s29, s29, s3
    v_or_b32 v23, v23, v107
    v_mfma_f32_16x16x32_bf16 v[80:83], v[32:35], a[192:195], v[132:135]
    v_exp_f32 v208, v72
    v_mfma_f32_16x16x32_bf16 v[80:83], v[36:39], a[196:199], v[80:83]
    v_exp_f32 v209, v73
    v_exp_f32 v210, v74
    v_mfma_f32_16x16x32_bf16 v[80:83], v[40:43], a[200:203], v[80:83]
    v_exp_f32 v211, v75
    v_exp_f32 v212, v76
    v_mfma_f32_16x16x32_bf16 v[80:83], v[44:47], a[204:207], v[80:83]
    v_cvt_pk_bf16_f32 v108, v208, v209
    v_exp_f32 v213, v77
    v_mfma_f32_16x16x32_bf16 v[84:87], v[48:51], a[192:195], v[132:135]
    v_cvt_pk_bf16_f32 v109, v210, v211
    v_mfma_f32_16x16x32_bf16 v[84:87], v[52:55], a[196:199], v[84:87]
    v_exp_f32 v214, v78
    v_exp_f32 v215, v79
    v_mfma_f32_16x16x32_bf16 v[84:87], v[56:59], a[200:203], v[84:87]
    v_cvt_pk_bf16_f32 v110, v212, v213
    v_cvt_pk_bf16_f32 v111, v214, v215
    v_mfma_f32_16x16x32_bf16 v[84:87], v[60:63], a[204:207], v[84:87]
    v_or3_b32 v23, v23, v108, v109
    v_or3_b32 v23, v23, v110, v111
    v_mfma_f32_16x16x32_bf16 v[88:91], v[32:35], a[208:211], v[136:139]
    s_waitcnt vmcnt(24)
    v_exp_f32 v200, v80
    v_mfma_f32_16x16x32_bf16 v[88:91], v[36:39], a[212:215], v[88:91]
    ds_read_b64_tr_b16 v[164:165], v2 offset:24576
    v_exp_f32 v201, v81
    ds_read_b64_tr_b16 v[166:167], v2 offset:28672
    v_mfma_f32_16x16x32_bf16 v[88:91], v[40:43], a[216:219], v[88:91]
    v_exp_f32 v202, v82
    v_exp_f32 v203, v83
    ds_read_b64_tr_b16 v[168:169], v3 offset:24576
    v_mfma_f32_16x16x32_bf16 v[88:91], v[44:47], a[220:223], v[88:91]
    v_exp_f32 v204, v84
    v_cvt_pk_bf16_f32 v112, v200, v201
    ds_read_b64_tr_b16 v[170:171], v3 offset:28672
    v_mfma_f32_16x16x32_bf16 v[92:95], v[48:51], a[208:211], v[136:139]
    v_exp_f32 v205, v85
    v_cvt_pk_bf16_f32 v113, v202, v203
    ds_read_b64_tr_b16 v[172:173], v4 offset:24576
    v_mfma_f32_16x16x32_bf16 v[92:95], v[52:55], a[212:215], v[92:95]
    v_exp_f32 v206, v86
    ds_read_b64_tr_b16 v[174:175], v4 offset:28672
    v_exp_f32 v207, v87
    v_mfma_f32_16x16x32_bf16 v[92:95], v[56:59], a[216:219], v[92:95]
    v_cvt_pk_bf16_f32 v114, v204, v205
    ds_read_b64_tr_b16 v[176:177], v5 offset:24576
    v_cvt_pk_bf16_f32 v115, v206, v207
    v_mfma_f32_16x16x32_bf16 v[92:95], v[60:63], a[220:223], v[92:95]
    v_or3_b32 v23, v23, v112, v113
    ds_read_b64_tr_b16 v[178:179], v5 offset:28672
    v_or3_b32 v23, v23, v114, v115
    v_mfma_f32_16x16x32_bf16 v[96:99], v[32:35], a[224:227], v[140:143]
    v_exp_f32 v208, v88
    ds_read_b64_tr_b16 v[180:181], v6 offset:24576
    v_mfma_f32_16x16x32_bf16 v[96:99], v[36:39], a[228:231], v[96:99]
    v_exp_f32 v209, v89
    ds_read_b64_tr_b16 v[182:183], v6 offset:28672
    v_exp_f32 v210, v90
    v_mfma_f32_16x16x32_bf16 v[96:99], v[40:43], a[232:235], v[96:99]
    v_exp_f32 v211, v91
    ds_read_b64_tr_b16 v[184:185], v7 offset:24576
    v_exp_f32 v212, v92
    v_mfma_f32_16x16x32_bf16 v[96:99], v[44:47], a[236:239], v[96:99]
    v_cvt_pk_bf16_f32 v116, v208, v209
    ds_read_b64_tr_b16 v[186:187], v7 offset:28672
    v_exp_f32 v213, v93
    v_mfma_f32_16x16x32_bf16 v[100:103], v[48:51], a[224:227], v[140:143]
    v_cvt_pk_bf16_f32 v117, v210, v211
    ds_read_b64_tr_b16 v[188:189], v8 offset:24576
    v_mfma_f32_16x16x32_bf16 v[100:103], v[52:55], a[228:231], v[100:103]
    v_exp_f32 v214, v94
    ds_read_b64_tr_b16 v[190:191], v8 offset:28672
    v_exp_f32 v215, v95
    v_mfma_f32_16x16x32_bf16 v[100:103], v[56:59], a[232:235], v[100:103]
    v_cvt_pk_bf16_f32 v118, v212, v213
    ds_read_b64_tr_b16 v[192:193], v9 offset:24576
    v_cvt_pk_bf16_f32 v119, v214, v215
    v_mfma_f32_16x16x32_bf16 v[100:103], v[60:63], a[236:239], v[100:103]
    v_or3_b32 v23, v23, v116, v117
    ds_read_b64_tr_b16 v[194:195], v9 offset:28672
    v_or3_b32 v23, v23, v118, v119
    v_exp_f32 v200, v96
    v_exp_f32 v201, v97
    v_exp_f32 v202, v98
    v_exp_f32 v203, v99
    s_nop 0
    v_exp_f32 v204, v100
    v_cvt_pk_bf16_f32 v120, v200, v201
    v_exp_f32 v205, v101
    v_cvt_pk_bf16_f32 v121, v202, v203
    v_exp_f32 v206, v102
    v_exp_f32 v207, v103
    v_cvt_pk_bf16_f32 v122, v204, v205
    v_cvt_pk_bf16_f32 v123, v206, v207
    v_or3_b32 v23, v23, v120, v121
    v_or3_b32 v23, v23, v122, v123
    v_and_b32 v23, s62, v23
    v_cmp_ne_u32 vcc, 0, v23
    s_nop 4
    s_cbranch_vccz L_ok_1
    s_call_b64 s[58:59], L_rescale
L_ok_1:
    s_waitcnt lgkmcnt(0)
    v_mfma_f32_16x16x32_bf16 a[0:3], v[164:167], v[104:107], a[0:3]
    v_mfma_f32_16x16x32_bf16 a[20:23], v[168:171], v[104:107], a[20:23]
    v_mfma_f32_16x16x32_bf16 a[40:43], v[172:175], v[104:107], a[40:43]
    s_add_u32 m0, s28, 24576
    v_mfma_f32_16x16x32_bf16 a[60:63], v[176:179], v[104:107], a[60:63]
    v_mfma_f32_16x16x32_bf16 a[80:83], v[180:183], v[104:107], a[80:83]
    buffer_load_dwordx4 v21, s[16:19], s30 offen nt lds
    v_mfma_f32_16x16x32_bf16 a[100:103], v[184:187], v[104:107], a[100:103]
    v_mfma_f32_16x16x32_bf16 a[120:123], v[188:191], v[104:107], a[120:123]
    buffer_load_dwordx4 v22, s[16:19], s30 offen offset:1024 nt lds
    v_mfma_f32_16x16x32_bf16 a[140:143], v[192:195], v[104:107], a[140:143]
    v_mfma_f32_16x16x32_bf16 v[144:147], v[196:199], v[104:107], v[144:147]
    buffer_load_dwordx4 v21, s[16:19], s30 offen offset:2048 nt lds
    v_mfma_f32_16x16x32_bf16 a[4:7], v[164:167], v[108:111], a[4:7]
    v_mfma_f32_16x16x32_bf16 a[24:27], v[168:171], v[108:111], a[24:27]
    buffer_load_dwordx4 v22, s[16:19], s30 offen offset:3072 nt lds
    v_mfma_f32_16x16x32_bf16 a[44:47], v[172:175], v[108:111], a[44:47]
    v_mfma_f32_16x16x32_bf16 a[64:67], v[176:179], v[108:111], a[64:67]
    s_add_u32 s30, s30, 4096
    v_mfma_f32_16x16x32_bf16 a[84:87], v[180:183], v[108:111], a[84:87]
    v_mfma_f32_16x16x32_bf16 a[104:107], v[184:187], v[108:111], a[104:107]
    s_add_u32 m0, s28, 28672
    v_mfma_f32_16x16x32_bf16 a[124:127], v[188:191], v[108:111], a[124:127]
    v_mfma_f32_16x16x32_bf16 a[144:147], v[192:195], v[108:111], a[144:147]
    buffer_load_dwordx4 v21, s[16:19], s30 offen nt lds
    v_mfma_f32_16x16x32_bf16 v[148:151], v[196:199], v[108:111], v[148:151]
    v_mfma_f32_16x16x32_bf16 a[8:11], v[164:167], v[112:115], a[8:11]
    buffer_load_dwordx4 v22, s[16:19], s30 offen offset:1024 nt lds
    v_mfma_f32_16x16x32_bf16 a[28:31], v[168:171], v[112:115], a[28:31]
    v_mfma_f32_16x16x32_bf16 a[48:51], v[172:175], v[112:115], a[48:51]
    buffer_load_dwordx4 v21, s[16:19], s30 offen offset:2048 nt lds
    v_mfma_f32_16x16x32_bf16 a[68:71], v[176:179], v[112:115], a[68:71]
    v_mfma_f32_16x16x32_bf16 a[88:91], v[180:183], v[112:115], a[88:91]
    buffer_load_dwordx4 v22, s[16:19], s30 offen offset:3072 nt lds
    v_mfma_f32_16x16x32_bf16 a[108:111], v[184:187], v[112:115], a[108:111]
    v_mfma_f32_16x16x32_bf16 a[128:131], v[188:191], v[112:115], a[128:131]
    s_add_u32 s30, s30, 4096
    v_mfma_f32_16x16x32_bf16 a[148:151], v[192:195], v[112:115], a[148:151]
    v_mfma_f32_16x16x32_bf16 v[152:155], v[196:199], v[112:115], v[152:155]
    s_and_b32 s30, s30, 0x1ffff
    s_or_b32 s30, s30, s3
    v_mfma_f32_16x16x32_bf16 a[12:15], v[164:167], v[116:119], a[12:15]
    v_mfma_f32_16x16x32_bf16 a[32:35], v[168:171], v[116:119], a[32:35]
    s_waitcnt vmcnt(24)
    v_mfma_f32_16x16x32_bf16 a[52:55], v[172:175], v[116:119], a[52:55]
    v_mfma_f32_16x16x32_bf16 a[72:75], v[176:179], v[116:119], a[72:75]
    ds_read_b128 v[32:35], v13 offset:0
    v_mfma_f32_16x16x32_bf16 a[92:95], v[180:183], v[116:119], a[92:95]
    v_mfma_f32_16x16x32_bf16 a[112:115], v[184:187], v[116:119], a[112:115]
    ds_read_b128 v[36:39], v14 offset:0
    v_mfma_f32_16x16x32_bf16 a[132:135], v[188:191], v[116:119], a[132:135]
    v_mfma_f32_16x16x32_bf16 a[152:155], v[192:195], v[116:119], a[152:155]
    ds_read_b128 v[40:43], v15 offset:0
    v_mfma_f32_16x16x32_bf16 v[156:159], v[196:199], v[116:119], v[156:159]
    v_mfma_f32_16x16x32_bf16 a[16:19], v[164:167], v[120:123], a[16:19]
    ds_read_b128 v[44:47], v16 offset:0
    v_mfma_f32_16x16x32_bf16 a[36:39], v[168:171], v[120:123], a[36:39]
    v_mfma_f32_16x16x32_bf16 a[56:59], v[172:175], v[120:123], a[56:59]
    ds_read_b128 v[48:51], v13 offset:4096
    v_mfma_f32_16x16x32_bf16 a[76:79], v[176:179], v[120:123], a[76:79]
    v_mfma_f32_16x16x32_bf16 a[96:99], v[180:183], v[120:123], a[96:99]
    ds_read_b128 v[52:55], v14 offset:4096
    v_mfma_f32_16x16x32_bf16 a[116:119], v[184:187], v[120:123], a[116:119]
    v_mfma_f32_16x16x32_bf16 a[136:139], v[188:191], v[120:123], a[136:139]
    ds_read_b128 v[56:59], v15 offset:4096
    v_mfma_f32_16x16x32_bf16 a[156:159], v[192:195], v[120:123], a[156:159]
    v_mfma_f32_16x16x32_bf16 v[160:163], v[196:199], v[120:123], v[160:163]
    ds_read_b128 v[60:63], v16 offset:4096
    s_mov_b32 s56, 0
L_attn_loop:
    s_waitcnt lgkmcnt(0)
    s_barrier
    v_mfma_f32_16x16x32_bf16 v[64:67], v[32:35], a[160:163], v[124:127]
    v_mfma_f32_16x16x32_bf16 v[64:67], v[36:39], a[164:167], v[64:67]
    s_add_u32 m0, s28, 0
    v_mfma_f32_16x16x32_bf16 v[64:67], v[40:43], a[168:171], v[64:67]
    buffer_load_dwordx4 v17, s[12:15], s29 offen nt lds
    v_mfma_f32_16x16x32_bf16 v[64:67], v[44:47], a[172:175], v[64:67]
    buffer_load_dwordx4 v18, s[12:15], s29 offen offset:1024 nt lds
    v_mfma_f32_16x16x32_bf16 v[68:71], v[48:51], a[160:163], v[124:127]
    v_mfma_f32_16x16x32_bf16 v[68:71], v[52:55], a[164:167], v[68:71]
    buffer_load_dwordx4 v19, s[12:15], s29 offen offset:2048 nt lds
    v_mfma_f32_16x16x32_bf16 v[68:71], v[56:59], a[168:171], v[68:71]
    buffer_load_dwordx4 v20, s[12:15], s29 offen offset:3072 nt lds
    v_mfma_f32_16x16x32_bf16 v[68:71], v[60:63], a[172:175], v[68:71]
    s_add_u32 s29, s29, 4096
    v_mfma_f32_16x16x32_bf16 v[72:75], v[32:35], a[176:179], v[128:131]
    v_exp_f32 v200, v64
    s_add_u32 m0, s28, 4096
    v_mfma_f32_16x16x32_bf16 v[72:75], v[36:39], a[180:183], v[72:75]
    v_exp_f32 v201, v65
    v_exp_f32 v202, v66
    buffer_load_dwordx4 v17, s[12:15], s29 offen nt lds
    v_mfma_f32_16x16x32_bf16 v[72:75], v[40:43], a[184:187], v[72:75]
    v_exp_f32 v203, v67
    v_exp_f32 v204, v68
    v_mfma_f32_16x16x32_bf16 v[72:75], v[44:47], a[188:191], v[72:75]
    buffer_load_dwordx4 v18, s[12:15], s29 offen offset:1024 nt lds
    v_cvt_pk_bf16_f32 v104, v200, v201
    v_exp_f32 v205, v69
    v_mfma_f32_16x16x32_bf16 v[76:79], v[48:51], a[176:179], v[128:131]
    buffer_load_dwordx4 v19, s[12:15], s29 offen offset:2048 nt lds
    v_cvt_pk_bf16_f32 v105, v202, v203
    v_exp_f32 v206, v70
    v_mfma_f32_16x16x32_bf16 v[76:79], v[52:55], a[180:183], v[76:79]
    buffer_load_dwordx4 v20, s[12:15], s29 offen offset:3072 nt lds
    v_exp_f32 v207, v71
    v_mfma_f32_16x16x32_bf16 v[76:79], v[56:59], a[184:187], v[76:79]
    v_cvt_pk_bf16_f32 v106, v204, v205
    s_add_u32 s29, s29, 4096
    v_cvt_pk_bf16_f32 v107, v206, v207
    v_mfma_f32_16x16x32_bf16 v[76:79], v[60:63], a[188:191], v[76:79]
    v_or3_b32 v23, v104, v105, v106
    s_and_b32 s29, s29, 0x1ffff
    s_or_b32 s29, s29, s3
    v_or_b32 v23, v23, v107
    v_mfma_f32_16x16x32_bf16 v[80:83], v[32:35], a[192:195], v[132:135]
    v_exp_f32 v208, v72
    v_mfma_f32_16x16x32_bf16 v[80:83], v[36:39], a[196:199], v[80:83]
    v_exp_f32 v209, v73
    v_exp_f32 v210, v74
    v_mfma_f32_16x16x32_bf16 v[80:83], v[40:43], a[200:203], v[80:83]
    v_exp_f32 v211, v75
    v_exp_f32 v212, v76
    v_mfma_f32_16x16x32_bf16 v[80:83], v[44:47], a[204:207], v[80:83]
    v_cvt_pk_bf16_f32 v108, v208, v209
    v_exp_f32 v213, v77
    v_mfma_f32_16x16x32_bf16 v[84:87], v[48:51], a[192:195], v[132:135]
    v_cvt_pk_bf16_f32 v109, v210, v211
    v_mfma_f32_16x16x32_bf16 v[84:87], v[52:55], a[196:199], v[84:87]
    v_exp_f32 v214, v78
    v_exp_f32 v215, v79
    v_mfma_f32_16x16x32_bf16 v[84:87], v[56:59], a[200:203], v[84:87]
    v_cvt_pk_bf16_f32 v110, v212, v213
    v_cvt_pk_bf16_f32 v111, v214, v215
    v_mfma_f32_16x16x32_bf16 v[84:87], v[60:63], a[204:207], v[84:87]
    v_or3_b32 v23, v23, v108, v109
    v_or3_b32 v23, v23, v110, v111
    v_mfma_f32_16x16x32_bf16 v[88:91], v[32:35], a[208:211], v[136:139]
    s_waitcnt vmcnt(24)
    v_exp_f32 v200, v80
    v_mfma_f32_16x16x32_bf16 v[88:91], v[36:39], a[212:215], v[88:91]
    ds_read_b64_tr_b16 v[164:165], v2 offset:8192
    v_exp_f32 v201, v81
    ds_read_b64_tr_b16 v[166:167], v2 offset:12288
    v_mfma_f32_16x16x32_bf16 v[88:91], v[40:43], a[216:219], v[88:91]
    v_exp_f32 v202, v82
    v_exp_f32 v203, v83
    ds_read_b64_tr_b16 v[168:169], v3 offset:8192
    v_mfma_f32_16x16x32_bf16 v[88:91], v[44:47], a[220:223], v[88:91]
    v_exp_f32 v204, v84
    v_cvt_pk_bf16_f32 v112, v200, v201
    ds_read_b64_tr_b16 v[170:171], v3 offset:12288
    v_mfma_f32_16x16x32_bf16 v[92:95], v[48:51], a[208:211], v[136:139]
    v_exp_f32 v205, v85
    v_cvt_pk_bf16_f32 v113, v202, v203
    ds_read_b64_tr_b16 v[172:173], v4 offset:8192
    v_mfma_f32_16x16x32_bf16 v[92:95], v[52:55], a[212:215], v[92:95]
    v_exp_f32 v206, v86
    ds_read_b64_tr_b16 v[174:175], v4 offset:12288
    v_exp_f32 v207, v87
    v_mfma_f32_16x16x32_bf16 v[92:95], v[56:59], a[216:219], v[92:95]
    v_cvt_pk_bf16_f32 v114, v204, v205
    ds_read_b64_tr_b16 v[176:177], v5 offset:8192
    v_cvt_pk_bf16_f32 v115, v206, v207
    v_mfma_f32_16x16x32_bf16 v[92:95], v[60:63], a[220:223], v[92:95]
    v_or3_b32 v23, v23, v112, v113
    ds_read_b64_tr_b16 v[178:179], v5 offset:12288
    v_or3_b32 v23, v23, v114, v115
    v_mfma_f32_16x16x32_bf16 v[96:99], v[32:35], a[224:227], v[140:143]
    v_exp_f32 v208, v88
    ds_read_b64_tr_b16 v[180:181], v6 offset:8192
    v_mfma_f32_16x16x32_bf16 v[96:99], v[36:39], a[228:231], v[96:99]
    v_exp_f32 v209, v89
    ds_read_b64_tr_b16 v[182:183], v6 offset:12288
    v_exp_f32 v210, v90
    v_mfma_f32_16x16x32_bf16 v[96:99], v[40:43], a[232:235], v[96:99]
    v_exp_f32 v211, v91
    ds_read_b64_tr_b16 v[184:185], v7 offset:8192
    v_exp_f32 v212, v92
    v_mfma_f32_16x16x32_bf16 v[96:99], v[44:47], a[236:239], v[96:99]
    v_cvt_pk_bf16_f32 v116, v208, v209
    ds_read_b64_tr_b16 v[186:187], v7 offset:12288
    v_exp_f32 v213, v93
    v_mfma_f32_16x16x32_bf16 v[100:103], v[48:51], a[224:227], v[140:143]
    v_cvt_pk_bf16_f32 v117, v210, v211
    ds_read_b64_tr_b16 v[188:189], v8 offset:8192
    v_mfma_f32_16x16x32_bf16 v[100:103], v[52:55], a[228:231], v[100:103]
    v_exp_f32 v214, v94
    ds_read_b64_tr_b16 v[190:191], v8 offset:12288
    v_exp_f32 v215, v95
    v_mfma_f32_16x16x32_bf16 v[100:103], v[56:59], a[232:235], v[100:103]
    v_cvt_pk_bf16_f32 v118, v212, v213
    ds_read_b64_tr_b16 v[192:193], v9 offset:8192
    v_cvt_pk_bf16_f32 v119, v214, v215
    v_mfma_f32_16x16x32_bf16 v[100:103], v[60:63], a[236:239], v[100:103]
    v_or3_b32 v23, v23, v116, v117
    ds_read_b64_tr_b16 v[194:195], v9 offset:12288
    v_or3_b32 v23, v23, v118, v119
    v_exp_f32 v200, v96
    v_exp_f32 v201, v97
    v_exp_f32 v202, v98
    v_exp_f32 v203, v99
    s_nop 0
    v_exp_f32 v204, v100
    v_cvt_pk_bf16_f32 v120, v200, v201
    v_exp_f32 v205, v101
    v_cvt_pk_bf16_f32 v121, v202, v203
    v_exp_f32 v206, v102
    v_exp_f32 v207, v103
    v_cvt_pk_bf16_f32 v122, v204, v205
    v_cvt_pk_bf16_f32 v123, v206, v207
    v_or3_b32 v23, v23, v120, v121
    v_or3_b32 v23, v23, v122, v123
    v_and_b32 v23, s62, v23
    v_cmp_ne_u32 vcc, 0, v23
    s_nop 4
    s_cbranch_vccz L_ok_2
    s_call_b64 s[58:59], L_rescale
L_ok_2:
    s_waitcnt lgkmcnt(0)
    v_mfma_f32_16x16x32_bf16 a[0:3], v[164:167], v[104:107], a[0:3]
    v_mfma_f32_16x16x32_bf16 a[20:23], v[168:171], v[104:107], a[20:23]
    v_mfma_f32_16x16x32_bf16 a[40:43], v[172:175], v[104:107], a[40:43]
    s_add_u32 m0, s28, 8192
    v_mfma_f32_16x16x32_bf16 a[60:63], v[176:179], v[104:107], a[60:63]
    v_mfma_f32_16x16x32_bf16 a[80:83], v[180:183], v[104:107], a[80:83]
    buffer_load_dwordx4 v21, s[16:19], s30 offen nt lds
    v_mfma_f32_16x16x32_bf16 a[100:103], v[184:187], v[104:107], a[100:103]
    v_mfma_f32_16x16x32_bf16 a[120:123], v[188:191], v[104:107], a[120:123]
    buffer_load_dwordx4 v22, s[16:19], s30 offen offset:1024 nt lds
    v_mfma_f32_16x16x32_bf16 a[140:143], v[192:195], v[104:107], a[140:143]
    v_mfma_f32_16x16x32_bf16 v[144:147], v[196:199], v[104:107], v[144:147]
    buffer_load_dwordx4 v21, s[16:19], s30 offen offset:2048 nt lds
    v_mfma_f32_16x16x32_bf16 a[4:7], v[164:167], v[108:111], a[4:7]
    v_mfma_f32_16x16x32_bf16 a[24:27], v[168:171], v[108:111], a[24:27]
    buffer_load_dwordx4 v22, s[16:19], s30 offen offset:3072 nt lds
    v_mfma_f32_16x16x32_bf16 a[44:47], v[172:175], v[108:111], a[44:47]
    v_mfma_f32_16x16x32_bf16 a[64:67], v[176:179], v[108:111], a[64:67]
    s_add_u32 s30, s30, 4096
    v_mfma_f32_16x16x32_bf16 a[84:87], v[180:183], v[108:111], a[84:87]
    v_mfma_f32_16x16x32_bf16 a[104:107], v[184:187], v[108:111], a[104:107]
    s_add_u32 m0, s28, 12288
    v_mfma_f32_16x16x32_bf16 a[124:127], v[188:191], v[108:111], a[124:127]
    v_mfma_f32_16x16x32_bf16 a[144:147], v[192:195], v[108:111], a[144:147]
    buffer_load_dwordx4 v21, s[16:19], s30 offen nt lds
    v_mfma_f32_16x16x32_bf16 v[148:151], v[196:199], v[108:111], v[148:151]
    v_mfma_f32_16x16x32_bf16 a[8:11], v[164:167], v[112:115], a[8:11]
    buffer_load_dwordx4 v22, s[16:19], s30 offen offset:1024 nt lds
    v_mfma_f32_16x16x32_bf16 a[28:31], v[168:171], v[112:115], a[28:31]
    v_mfma_f32_16x16x32_bf16 a[48:51], v[172:175], v[112:115], a[48:51]
    buffer_load_dwordx4 v21, s[16:19], s30 offen offset:2048 nt lds
    v_mfma_f32_16x16x32_bf16 a[68:71], v[176:179], v[112:115], a[68:71]
    v_mfma_f32_16x16x32_bf16 a[88:91], v[180:183], v[112:115], a[88:91]
    buffer_load_dwordx4 v22, s[16:19], s30 offen offset:3072 nt lds
    v_mfma_f32_16x16x32_bf16 a[108:111], v[184:187], v[112:115], a[108:111]
    v_mfma_f32_16x16x32_bf16 a[128:131], v[188:191], v[112:115], a[128:131]
    s_add_u32 s30, s30, 4096
    v_mfma_f32_16x16x32_bf16 a[148:151], v[192:195], v[112:115], a[148:151]
    v_mfma_f32_16x16x32_bf16 v[152:155], v[196:199], v[112:115], v[152:155]
    s_and_b32 s30, s30, 0x1ffff
    s_or_b32 s30, s30, s3
    v_mfma_f32_16x16x32_bf16 a[12:15], v[164:167], v[116:119], a[12:15]
    v_mfma_f32_16x16x32_bf16 a[32:35], v[168:171], v[116:119], a[32:35]
    s_waitcnt vmcnt(24)
    v_mfma_f32_16x16x32_bf16 a[52:55], v[172:175], v[116:119], a[52:55]
    v_mfma_f32_16x16x32_bf16 a[72:75], v[176:179], v[116:119], a[72:75]
    ds_read_b128 v[32:35], v13 offset:16384
    v_mfma_f32_16x16x32_bf16 a[92:95], v[180:183], v[116:119], a[92:95]
    v_mfma_f32_16x16x32_bf16 a[112:115], v[184:187], v[116:119], a[112:115]
    ds_read_b128 v[36:39], v14 offset:16384
    v_mfma_f32_16x16x32_bf16 a[132:135], v[188:191], v[116:119], a[132:135]
    v_mfma_f32_16x16x32_bf16 a[152:155], v[192:195], v[116:119], a[152:155]
    ds_read_b128 v[40:43], v15 offset:16384
    v_mfma_f32_16x16x32_bf16 v[156:159], v[196:199], v[116:119], v[156:159]
    v_mfma_f32_16x16x32_bf16 a[16:19], v[164:167], v[120:123], a[16:19]
    ds_read_b128 v[44:47], v16 offset:16384
    v_mfma_f32_16x16x32_bf16 a[36:39], v[168:171], v[120:123], a[36:39]
    v_mfma_f32_16x16x32_bf16 a[56:59], v[172:175], v[120:123], a[56:59]
    ds_read_b128 v[48:51], v13 offset:20480
    v_mfma_f32_16x16x32_bf16 a[76:79], v[176:179], v[120:123], a[76:79]
    v_mfma_f32_16x16x32_bf16 a[96:99], v[180:183], v[120:123], a[96:99]
    ds_read_b128 v[52:55], v14 offset:20480
    v_mfma_f32_16x16x32_bf16 a[116:119], v[184:187], v[120:123], a[116:119]
    v_mfma_f32_16x16x32_bf16 a[136:139], v[188:191], v[120:123], a[136:139]
    ds_read_b128 v[56:59], v15 offset:20480
    v_mfma_f32_16x16x32_bf16 a[156:159], v[192:195], v[120:123], a[156:159]
    v_mfma_f32_16x16x32_bf16 v[160:163], v[196:199], v[120:123], v[160:163]
    ds_read_b128 v[60:63], v16 offset:20480
    s_waitcnt lgkmcnt(0)
    s_barrier
    v_mfma_f32_16x16x32_bf16 v[64:67], v[32:35], a[160:163], v[124:127]
    v_mfma_f32_16x16x32_bf16 v[64:67], v[36:39], a[164:167], v[64:67]
    s_add_u32 m0, s28, 16384
    v_mfma_f32_16x16x32_bf16 v[64:67], v[40:43], a[168:171], v[64:67]
    buffer_load_dwordx4 v17, s[12:15], s29 offen nt lds
    v_mfma_f32_16x16x32_bf16 v[64:67], v[44:47], a[172:175], v[64:67]
    buffer_load_dwordx4 v18, s[12:15], s29 offen offset:1024 nt lds
    v_mfma_f32_16x16x32_bf16 v[68:71], v[48:51], a[160:163], v[124:127]
    v_mfma_f32_16x16x32_bf16 v[68:71], v[52:55], a[164:167], v[68:71]
    buffer_load_dwordx4 v19, s[12:15], s29 offen offset:2048 nt lds
    v_mfma_f32_16x16x32_bf16 v[68:71], v[56:59], a[168:171], v[68:71]
    buffer_load_dwordx4 v20, s[12:15], s29 offen offset:3072 nt lds
    v_mfma_f32_16x16x32_bf16 v[68:71], v[60:63], a[172:175], v[68:71]
    s_add_u32 s29, s29, 4096
    v_mfma_f32_16x16x32_bf16 v[72:75], v[32:35], a[176:179], v[128:131]
    v_exp_f32 v200, v64
    s_add_u32 m0, s28, 20480
    v_mfma_f32_16x16x32_bf16 v[72:75], v[36:39], a[180:183], v[72:75]
    v_exp_f32 v201, v65
    v_exp_f32 v202, v66
    buffer_load_dwordx4 v17, s[12:15], s29 offen nt lds
    v_mfma_f32_16x16x32_bf16 v[72:75], v[40:43], a[184:187], v[72:75]
    v_exp_f32 v203, v67
    v_exp_f32 v204, v68
    v_mfma_f32_16x16x32_bf16 v[72:75], v[44:47], a[188:191], v[72:75]
    buffer_load_dwordx4 v18, s[12:15], s29 offen offset:1024 nt lds
    v_cvt_pk_bf16_f32 v104, v200, v201
    v_exp_f32 v205, v69
    v_mfma_f32_16x16x32_bf16 v[76:79], v[48:51], a[176:179], v[128:131]
    buffer_load_dwordx4 v19, s[12:15], s29 offen offset:2048 nt lds
    v_cvt_pk_bf16_f32 v105, v202, v203
    v_exp_f32 v206, v70
    v_mfma_f32_16x16x32_bf16 v[76:79], v[52:55], a[180:183], v[76:79]
    buffer_load_dwordx4 v20, s[12:15], s29 offen offset:3072 nt lds
    v_exp_f32 v207, v71
    v_mfma_f32_16x16x32_bf16 v[76:79], v[56:59], a[184:187], v[76:79]
    v_cvt_pk_bf16_f32 v106, v204, v205
    s_add_u32 s29, s29, 4096
    v_cvt_pk_bf16_f32 v107, v206, v207
    v_mfma_f32_16x16x32_bf16 v[76:79], v[60:63], a[188:191], v[76:79]
    v_or3_b32 v23, v104, v105, v106
    s_and_b32 s29, s29, 0x1ffff
    s_or_b32 s29, s29, s3
    v_or_b32 v23, v23, v107
    v_mfma_f32_16x16x32_bf16 v[80:83], v[32:35], a[192:195], v[132:135]
    v_exp_f32 v208, v72
    v_mfma_f32_16x16x32_bf16 v[80:83], v[36:39], a[196:199], v[80:83]
    v_exp_f32 v209, v73
    v_exp_f32 v210, v74
    v_mfma_f32_16x16x32_bf16 v[80:83], v[40:43], a[200:203], v[80:83]
    v_exp_f32 v211, v75
    v_exp_f32 v212, v76
    v_mfma_f32_16x16x32_bf16 v[80:83], v[44:47], a[204:207], v[80:83]
    v_cvt_pk_bf16_f32 v108, v208, v209
    v_exp_f32 v213, v77
    v_mfma_f32_16x16x32_bf16 v[84:87], v[48:51], a[192:195], v[132:135]
    v_cvt_pk_bf16_f32 v109, v210, v211
    v_mfma_f32_16x16x32_bf16 v[84:87], v[52:55], a[196:199], v[84:87]
    v_exp_f32 v214, v78
    v_exp_f32 v215, v79
    v_mfma_f32_16x16x32_bf16 v[84:87], v[56:59], a[200:203], v[84:87]
    v_cvt_pk_bf16_f32 v110, v212, v213
    v_cvt_pk_bf16_f32 v111, v214, v215
    v_mfma_f32_16x16x32_bf16 v[84:87], v[60:63], a[204:207], v[84:87]
    v_or3_b32 v23, v23, v108, v109
    v_or3_b32 v23, v23, v110, v111
    v_mfma_f32_16x16x32_bf16 v[88:91], v[32:35], a[208:211], v[136:139]
    s_waitcnt vmcnt(24)
    v_exp_f32 v200, v80
    v_mfma_f32_16x16x32_bf16 v[88:91], v[36:39], a[212:215], v[88:91]
    ds_read_b64_tr_b16 v[164:165], v2 offset:24576
    v_exp_f32 v201, v81
    ds_read_b64_tr_b16 v[166:167], v2 offset:28672
    v_mfma_f32_16x16x32_bf16 v[88:91], v[40:43], a[216:219], v[88:91]
    v_exp_f32 v202, v82
    v_exp_f32 v203, v83
    ds_read_b64_tr_b16 v[168:169], v3 offset:24576
    v_mfma_f32_16x16x32_bf16 v[88:91], v[44:47], a[220:223], v[88:91]
    v_exp_f32 v204, v84
    v_cvt_pk_bf16_f32 v112, v200, v201
    ds_read_b64_tr_b16 v[170:171], v3 offset:28672
    v_mfma_f32_16x16x32_bf16 v[92:95], v[48:51], a[208:211], v[136:139]
    v_exp_f32 v205, v85
    v_cvt_pk_bf16_f32 v113, v202, v203
    ds_read_b64_tr_b16 v[172:173], v4 offset:24576
    v_mfma_f32_16x16x32_bf16 v[92:95], v[52:55], a[212:215], v[92:95]
    v_exp_f32 v206, v86
    ds_read_b64_tr_b16 v[174:175], v4 offset:28672
    v_exp_f32 v207, v87
    v_mfma_f32_16x16x32_bf16 v[92:95], v[56:59], a[216:219], v[92:95]
    v_cvt_pk_bf16_f32 v114, v204, v205
    ds_read_b64_tr_b16 v[176:177], v5 offset:24576
    v_cvt_pk_bf16_f32 v115, v206, v207
    v_mfma_f32_16x16x32_bf16 v[92:95], v[60:63], a[220:223], v[92:95]
    v_or3_b32 v23, v23, v112, v113
    ds_read_b64_tr_b16 v[178:179], v5 offset:28672
    v_or3_b32 v23, v23, v114, v115
    v_mfma_f32_16x16x32_bf16 v[96:99], v[32:35], a[224:227], v[140:143]
    v_exp_f32 v208, v88
    ds_read_b64_tr_b16 v[180:181], v6 offset:24576
    v_mfma_f32_16x16x32_bf16 v[96:99], v[36:39], a[228:231], v[96:99]
    v_exp_f32 v209, v89
    ds_read_b64_tr_b16 v[182:183], v6 offset:28672
    v_exp_f32 v210, v90
    v_mfma_f32_16x16x32_bf16 v[96:99], v[40:43], a[232:235], v[96:99]
    v_exp_f32 v211, v91
    ds_read_b64_tr_b16 v[184:185], v7 offset:24576
    v_exp_f32 v212, v92
    v_mfma_f32_16x16x32_bf16 v[96:99], v[44:47], a[236:239], v[96:99]
    v_cvt_pk_bf16_f32 v116, v208, v209
    ds_read_b64_tr_b16 v[186:187], v7 offset:28672
    v_exp_f32 v213, v93
    v_mfma_f32_16x16x32_bf16 v[100:103], v[48:51], a[224:227], v[140:143]
    v_cvt_pk_bf16_f32 v117, v210, v211
    ds_read_b64_tr_b16 v[188:189], v8 offset:24576
    v_mfma_f32_16x16x32_bf16 v[100:103], v[52:55], a[228:231], v[100:103]
    v_exp_f32 v214, v94
    ds_read_b64_tr_b16 v[190:191], v8 offset:28672
    v_exp_f32 v215, v95
    v_mfma_f32_16x16x32_bf16 v[100:103], v[56:59], a[232:235], v[100:103]
    v_cvt_pk_bf16_f32 v118, v212, v213
    ds_read_b64_tr_b16 v[192:193], v9 offset:24576
    v_cvt_pk_bf16_f32 v119, v214, v215
    v_mfma_f32_16x16x32_bf16 v[100:103], v[60:63], a[236:239], v[100:103]
    v_or3_b32 v23, v23, v116, v117
    ds_read_b64_tr_b16 v[194:195], v9 offset:28672
    v_or3_b32 v23, v23, v118, v119
    v_exp_f32 v200, v96
    v_exp_f32 v201, v97
    v_exp_f32 v202, v98
    v_exp_f32 v203, v99
    s_nop 0
    v_exp_f32 v204, v100
    v_cvt_pk_bf16_f32 v120, v200, v201
    v_exp_f32 v205, v101
    v_cvt_pk_bf16_f32 v121, v202, v203
    v_exp_f32 v206, v102
    v_exp_f32 v207, v103
    v_cvt_pk_bf16_f32 v122, v204, v205
    v_cvt_pk_bf16_f32 v123, v206, v207
    v_or3_b32 v23, v23, v120, v121
    v_or3_b32 v23, v23, v122, v123
    v_and_b32 v23, s62, v23
    v_cmp_ne_u32 vcc, 0, v23
    s_nop 4
    s_cbranch_vccz L_ok_3
    s_call_b64 s[58:59], L_rescale
L_ok_3:
    s_waitcnt lgkmcnt(0)
    v_mfma_f32_16x16x32_bf16 a[0:3], v[164:167], v[104:107], a[0:3]
    v_mfma_f32_16x16x32_bf16 a[20:23], v[168:171], v[104:107], a[20:23]
    v_mfma_f32_16x16x32_bf16 a[40:43], v[172:175], v[104:107], a[40:43]
    s_add_u32 m0, s28, 24576
    v_mfma_f32_16x16x32_bf16 a[60:63], v[176:179], v[104:107], a[60:63]
    v_mfma_f32_16x16x32_bf16 a[80:83], v[180:183], v[104:107], a[80:83]
    buffer_load_dwordx4 v21, s[16:19], s30 offen nt lds
    v_mfma_f32_16x16x32_bf16 a[100:103], v[184:187], v[104:107], a[100:103]
    v_mfma_f32_16x16x32_bf16 a[120:123], v[188:191], v[104:107], a[120:123]
    buffer_load_dwordx4 v22, s[16:19], s30 offen offset:1024 nt lds
    v_mfma_f32_16x16x32_bf16 a[140:143], v[192:195], v[104:107], a[140:143]
    v_mfma_f32_16x16x32_bf16 v[144:147], v[196:199], v[104:107], v[144:147]
    buffer_load_dwordx4 v21, s[16:19], s30 offen offset:2048 nt lds
    v_mfma_f32_16x16x32_bf16 a[4:7], v[164:167], v[108:111], a[4:7]
    v_mfma_f32_16x16x32_bf16 a[24:27], v[168:171], v[108:111], a[24:27]
    buffer_load_dwordx4 v22, s[16:19], s30 offen offset:3072 nt lds
    v_mfma_f32_16x16x32_bf16 a[44:47], v[172:175], v[108:111], a[44:47]
    v_mfma_f32_16x16x32_bf16 a[64:67], v[176:179], v[108:111], a[64:67]
    s_add_u32 s30, s30, 4096
    v_mfma_f32_16x16x32_bf16 a[84:87], v[180:183], v[108:111], a[84:87]
    v_mfma_f32_16x16x32_bf16 a[104:107], v[184:187], v[108:111], a[104:107]
    s_add_u32 m0, s28, 28672
    v_mfma_f32_16x16x32_bf16 a[124:127], v[188:191], v[108:111], a[124:127]
    v_mfma_f32_16x16x32_bf16 a[144:147], v[192:195], v[108:111], a[144:147]
    buffer_load_dwordx4 v21, s[16:19], s30 offen nt lds
    v_mfma_f32_16x16x32_bf16 v[148:151], v[196:199], v[108:111], v[148:151]
    v_mfma_f32_16x16x32_bf16 a[8:11], v[164:167], v[112:115], a[8:11]
    buffer_load_dwordx4 v22, s[16:19], s30 offen offset:1024 nt lds
    v_mfma_f32_16x16x32_bf16 a[28:31], v[168:171], v[112:115], a[28:31]
    v_mfma_f32_16x16x32_bf16 a[48:51], v[172:175], v[112:115], a[48:51]
    buffer_load_dwordx4 v21, s[16:19], s30 offen offset:2048 nt lds
    v_mfma_f32_16x16x32_bf16 a[68:71], v[176:179], v[112:115], a[68:71]
    v_mfma_f32_16x16x32_bf16 a[88:91], v[180:183], v[112:115], a[88:91]
    buffer_load_dwordx4 v22, s[16:19], s30 offen offset:3072 nt lds
    v_mfma_f32_16x16x32_bf16 a[108:111], v[184:187], v[112:115], a[108:111]
    v_mfma_f32_16x16x32_bf16 a[128:131], v[188:191], v[112:115], a[128:131]
    s_add_u32 s30, s30, 4096
    v_mfma_f32_16x16x32_bf16 a[148:151], v[192:195], v[112:115], a[148:151]
    v_mfma_f32_16x16x32_bf16 v[152:155], v[196:199], v[112:115], v[152:155]
    s_and_b32 s30, s30, 0x1ffff
    s_or_b32 s30, s30, s3
    v_mfma_f32_16x16x32_bf16 a[12:15], v[164:167], v[116:119], a[12:15]
    v_mfma_f32_16x16x32_bf16 a[32:35], v[168:171], v[116:119], a[32:35]
    s_waitcnt vmcnt(24)
    v_mfma_f32_16x16x32_bf16 a[52:55], v[172:175], v[116:119], a[52:55]
    v_mfma_f32_16x16x32_bf16 a[72:75], v[176:179], v[116:119], a[72:75]
    ds_read_b128 v[32:35], v13 offset:0
    v_mfma_f32_16x16x32_bf16 a[92:95], v[180:183], v[116:119], a[92:95]
    v_mfma_f32_16x16x32_bf16 a[112:115], v[184:187], v[116:119], a[112:115]
    ds_read_b128 v[36:39], v14 offset:0
    v_mfma_f32_16x16x32_bf16 a[132:135], v[188:191], v[116:119], a[132:135]
    v_mfma_f32_16x16x32_bf16 a[152:155], v[192:195], v[116:119], a[152:155]
    ds_read_b128 v[40:43], v15 offset:0
    v_mfma_f32_16x16x32_bf16 v[156:159], v[196:199], v[116:119], v[156:159]
    v_mfma_f32_16x16x32_bf16 a[16:19], v[164:167], v[120:123], a[16:19]
    ds_read_b128 v[44:47], v16 offset:0
    v_mfma_f32_16x16x32_bf16 a[36:39], v[168:171], v[120:123], a[36:39]
    v_mfma_f32_16x16x32_bf16 a[56:59], v[172:175], v[120:123], a[56:59]
    ds_read_b128 v[48:51], v13 offset:4096
    v_mfma_f32_16x16x32_bf16 a[76:79], v[176:179], v[120:123], a[76:79]
    v_mfma_f32_16x16x32_bf16 a[96:99], v[180:183], v[120:123], a[96:99]
    ds_read_b128 v[52:55], v14 offset:4096
    v_mfma_f32_16x16x32_bf16 a[116:119], v[184:187], v[120:123], a[116:119]
    v_mfma_f32_16x16x32_bf16 a[136:139], v[188:191], v[120:123], a[136:139]
    ds_read_b128 v[56:59], v15 offset:4096
    v_mfma_f32_16x16x32_bf16 a[156:159], v[192:195], v[120:123], a[156:159]
    v_mfma_f32_16x16x32_bf16 v[160:163], v[196:199], v[120:123], v[160:163]
    ds_read_b128 v[60:63], v16 offset:4096
    s_add_u32 s56, s56, 1
    s_cmp_lt_u32 s56, 6
    s_cbranch_scc1 L_attn_loop
    s_load_dwordx2 s[74:75], s[0:1], 88
    v_mov_b32 v235, 0
    s_waitcnt lgkmcnt(0)
    s_mov_b32 s76, s74
    s_mov_b32 s77, s75
    s_mov_b32 s78, 256
    s_mov_b32 s79, 0x20000
    s_cmp_lg_u32 s24, 0
    s_cbranch_scc1 L_nn_o
    buffer_load_dword v234, v235, s[76:79], 0 offen sc1
    s_branch L_nn_e
L_nn_o:
    buffer_load_dword v234, v235, s[4:7], 0 offen
L_nn_e:
    s_waitcnt lgkmcnt(0)
    s_barrier
    v_mfma_f32_16x16x32_bf16 v[64:67], v[32:35], a[160:163], v[124:127]
    v_mfma_f32_16x16x32_bf16 v[64:67], v[36:39], a[164:167], v[64:67]
    v_mfma_f32_16x16x32_bf16 v[64:67], v[40:43], a[168:171], v[64:67]
    v_mfma_f32_16x16x32_bf16 v[64:67], v[44:47], a[172:175], v[64:67]
    v_mfma_f32_16x16x32_bf16 v[68:71], v[48:51], a[160:163], v[124:127]
    v_mfma_f32_16x16x32_bf16 v[68:71], v[52:55], a[164:167], v[68:71]
    v_mfma_f32_16x16x32_bf16 v[68:71], v[56:59], a[168:171], v[68:71]
    v_mfma_f32_16x16x32_bf16 v[68:71], v[60:63], a[172:175], v[68:71]
    v_mfma_f32_16x16x32_bf16 v[72:75], v[32:35], a[176:179], v[128:131]
    s_nop 2
    v_exp_f32 v200, v64
    v_mfma_f32_16x16x32_bf16 v[72:75], v[36:39], a[180:183], v[72:75]
    v_exp_f32 v201, v65
    v_exp_f32 v202, v66
    v_mfma_f32_16x16x32_bf16 v[72:75], v[40:43], a[184:187], v[72:75]
    v_exp_f32 v203, v67
    v_exp_f32 v204, v68
    v_mfma_f32_16x16x32_bf16 v[72:75], v[44:47], a[188:191], v[72:75]
    v_cvt_pk_bf16_f32 v104, v200, v201
    v_exp_f32 v205, v69
    v_mfma_f32_16x16x32_bf16 v[76:79], v[48:51], a[176:179], v[128:131]
    v_cvt_pk_bf16_f32 v105, v202, v203
    v_mfma_f32_16x16x32_bf16 v[76:79], v[52:55], a[180:183], v[76:79]
    v_exp_f32 v206, v70
    v_exp_f32 v207, v71
    v_mfma_f32_16x16x32_bf16 v[76:79], v[56:59], a[184:187], v[76:79]
    v_cvt_pk_bf16_f32 v106, v204, v205
    v_cvt_pk_bf16_f32 v107, v206, v207
    v_mfma_f32_16x16x32_bf16 v[76:79], v[60:63], a[188:191], v[76:79]
    v_or3_b32 v23, v104, v105, v106
    v_or_b32 v23, v23, v107
    v_mfma_f32_16x16x32_bf16 v[80:83], v[32:35], a[192:195], v[132:135]
    v_exp_f32 v208, v72
    v_mfma_f32_16x16x32_bf16 v[80:83], v[36:39], a[196:199], v[80:83]
    v_exp_f32 v209, v73
    v_exp_f32 v210, v74
    v_mfma_f32_16x16x32_bf16 v[80:83], v[40:43], a[200:203], v[80:83]
    v_exp_f32 v211, v75
    v_exp_f32 v212, v76
    v_mfma_f32_16x16x32_bf16 v[80:83], v[44:47], a[204:207], v[80:83]
    v_cvt_pk_bf16_f32 v108, v208, v209
    v_exp_f32 v213, v77
    v_mfma_f32_16x16x32_bf16 v[84:87], v[48:51], a[192:195], v[132:135]
    v_cvt_pk_bf16_f32 v109, v210, v211
    v_mfma_f32_16x16x32_bf16 v[84:87], v[52:55], a[196:199], v[84:87]
    v_exp_f32 v214, v78
    v_exp_f32 v215, v79
    v_mfma_f32_16x16x32_bf16 v[84:87], v[56:59], a[200:203], v[84:87]
    v_cvt_pk_bf16_f32 v110, v212, v213
    v_cvt_pk_bf16_f32 v111, v214, v215
    v_mfma_f32_16x16x32_bf16 v[84:87], v[60:63], a[204:207], v[84:87]
    v_or3_b32 v23, v23, v108, v109
    v_or3_b32 v23, v23, v110, v111
    v_mfma_f32_16x16x32_bf16 v[88:91], v[32:35], a[208:211], v[136:139]
    s_waitcnt vmcnt(17)
    v_exp_f32 v200, v80
    v_mfma_f32_16x16x32_bf16 v[88:91], v[36:39], a[212:215], v[88:91]
    ds_read_b64_tr_b16 v[164:165], v2 offset:8192
    v_exp_f32 v201, v81
    ds_read_b64_tr_b16 v[166:167], v2 offset:12288
    v_mfma_f32_16x16x32_bf16 v[88:91], v[40:43], a[216:219], v[88:91]
    v_exp_f32 v202, v82
    v_exp_f32 v203, v83
    ds_read_b64_tr_b16 v[168:169], v3 offset:8192
    v_mfma_f32_16x16x32_bf16 v[88:91], v[44:47], a[220:223], v[88:91]
    v_exp_f32 v204, v84
    v_cvt_pk_bf16_f32 v112, v200, v201
    ds_read_b64_tr_b16 v[170:171], v3 offset:12288
    v_mfma_f32_16x16x32_bf16 v[92:95], v[48:51], a[208:211], v[136:139]
    v_exp_f32 v205, v85
    v_cvt_pk_bf16_f32 v113, v202, v203
    ds_read_b64_tr_b16 v[172:173], v4 offset:8192
    v_mfma_f32_16x16x32_bf16 v[92:95], v[52:55], a[212:215], v[92:95]
    v_exp_f32 v206, v86
    ds_read_b64_tr_b16 v[174:175], v4 offset:12288
    v_exp_f32 v207, v87
    v_mfma_f32_16x16x32_bf16 v[92:95], v[56:59], a[216:219], v[92:95]
    v_cvt_pk_bf16_f32 v114, v204, v205
    ds_read_b64_tr_b16 v[176:177], v5 offset:8192
    v_cvt_pk_bf16_f32 v115, v206, v207
    v_mfma_f32_16x16x32_bf16 v[92:95], v[60:63], a[220:223], v[92:95]
    v_or3_b32 v23, v23, v112, v113
    ds_read_b64_tr_b16 v[178:179], v5 offset:12288
    v_or3_b32 v23, v23, v114, v115
    v_mfma_f32_16x16x32_bf16 v[96:99], v[32:35], a[224:227], v[140:143]
    v_exp_f32 v208, v88
    ds_read_b64_tr_b16 v[180:181], v6 offset:8192
    v_mfma_f32_16x16x32_bf16 v[96:99], v[36:39], a[228:231], v[96:99]
    v_exp_f32 v209, v89
    ds_read_b64_tr_b16 v[182:183], v6 offset:12288
    v_exp_f32 v210, v90
    v_mfma_f32_16x16x32_bf16 v[96:99], v[40:43], a[232:235], v[96:99]
    v_exp_f32 v211, v91
    ds_read_b64_tr_b16 v[184:185], v7 offset:8192
    v_exp_f32 v212, v92
    v_mfma_f32_16x16x32_bf16 v[96:99], v[44:47], a[236:239], v[96:99]
    v_cvt_pk_bf16_f32 v116, v208, v209
    ds_read_b64_tr_b16 v[186:187], v7 offset:12288
    v_exp_f32 v213, v93
    v_mfma_f32_16x16x32_bf16 v[100:103], v[48:51], a[224:227], v[140:143]
    v_cvt_pk_bf16_f32 v117, v210, v211
    ds_read_b64_tr_b16 v[188:189], v8 offset:8192
    v_mfma_f32_16x16x32_bf16 v[100:103], v[52:55], a[228:231], v[100:103]
    v_exp_f32 v214, v94
    ds_read_b64_tr_b16 v[190:191], v8 offset:12288
    v_exp_f32 v215, v95
    v_mfma_f32_16x16x32_bf16 v[100:103], v[56:59], a[232:235], v[100:103]
    v_cvt_pk_bf16_f32 v118, v212, v213
    ds_read_b64_tr_b16 v[192:193], v9 offset:8192
    v_cvt_pk_bf16_f32 v119, v214, v215
    v_mfma_f32_16x16x32_bf16 v[100:103], v[60:63], a[236:239], v[100:103]
    v_or3_b32 v23, v23, v116, v117
    ds_read_b64_tr_b16 v[194:195], v9 offset:12288
    v_or3_b32 v23, v23, v118, v119
    v_exp_f32 v200, v96
    v_exp_f32 v201, v97
    v_exp_f32 v202, v98
    v_exp_f32 v203, v99
    s_nop 0
    v_exp_f32 v204, v100
    v_cvt_pk_bf16_f32 v120, v200, v201
    v_exp_f32 v205, v101
    v_cvt_pk_bf16_f32 v121, v202, v203
    v_exp_f32 v206, v102
    v_exp_f32 v207, v103
    v_cvt_pk_bf16_f32 v122, v204, v205
    v_cvt_pk_bf16_f32 v123, v206, v207
    v_or3_b32 v23, v23, v120, v121
    v_or3_b32 v23, v23, v122, v123
    v_and_b32 v23, s62, v23
    v_cmp_ne_u32 vcc, 0, v23
    s_nop 4
    s_cbranch_vccz L_ok_14
    s_call_b64 s[58:59], L_rescale
L_ok_14:
    s_waitcnt lgkmcnt(0)
    v_mfma_f32_16x16x32_bf16 a[0:3], v[164:167], v[104:107], a[0:3]
    v_mfma_f32_16x16x32_bf16 a[20:23], v[168:171], v[104:107], a[20:23]
    v_mfma_f32_16x16x32_bf16 a[40:43], v[172:175], v[104:107], a[40:43]
    v_mfma_f32_16x16x32_bf16 a[60:63], v[176:179], v[104:107], a[60:63]
    v_mfma_f32_16x16x32_bf16 a[80:83], v[180:183], v[104:107], a[80:83]
    v_mfma_f32_16x16x32_bf16 a[100:103], v[184:187], v[104:107], a[100:103]
    v_mfma_f32_16x16x32_bf16 a[120:123], v[188:191], v[104:107], a[120:123]
    v_mfma_f32_16x16x32_bf16 a[140:143], v[192:195], v[104:107], a[140:143]
    v_mfma_f32_16x16x32_bf16 v[144:147], v[196:199], v[104:107], v[144:147]
    v_mfma_f32_16x16x32_bf16 a[4:7], v[164:167], v[108:111], a[4:7]
    v_mfma_f32_16x16x32_bf16 a[24:27], v[168:171], v[108:111], a[24:27]
    v_mfma_f32_16x16x32_bf16 a[44:47], v[172:175], v[108:111], a[44:47]
    v_mfma_f32_16x16x32_bf16 a[64:67], v[176:179], v[108:111], a[64:67]
    v_mfma_f32_16x16x32_bf16 a[84:87], v[180:183], v[108:111], a[84:87]
    v_mfma_f32_16x16x32_bf16 a[104:107], v[184:187], v[108:111], a[104:107]
    v_mfma_f32_16x16x32_bf16 a[124:127], v[188:191], v[108:111], a[124:127]
    v_mfma_f32_16x16x32_bf16 a[144:147], v[192:195], v[108:111], a[144:147]
    v_mfma_f32_16x16x32_bf16 v[148:151], v[196:199], v[108:111], v[148:151]
    v_mfma_f32_16x16x32_bf16 a[8:11], v[164:167], v[112:115], a[8:11]
    v_mfma_f32_16x16x32_bf16 a[28:31], v[168:171], v[112:115], a[28:31]
    v_mfma_f32_16x16x32_bf16 a[48:51], v[172:175], v[112:115], a[48:51]
    v_mfma_f32_16x16x32_bf16 a[68:71], v[176:179], v[112:115], a[68:71]
    v_mfma_f32_16x16x32_bf16 a[88:91], v[180:183], v[112:115], a[88:91]
    v_mfma_f32_16x16x32_bf16 a[108:111], v[184:187], v[112:115], a[108:111]
    v_mfma_f32_16x16x32_bf16 a[128:131], v[188:191], v[112:115], a[128:131]
    v_mfma_f32_16x16x32_bf16 a[148:151], v[192:195], v[112:115], a[148:151]
    v_mfma_f32_16x16x32_bf16 v[152:155], v[196:199], v[112:115], v[152:155]
    v_mfma_f32_16x16x32_bf16 a[12:15], v[164:167], v[116:119], a[12:15]
    v_mfma_f32_16x16x32_bf16 a[32:35], v[168:171], v[116:119], a[32:35]
    s_waitcnt vmcnt(9)
    v_mfma_f32_16x16x32_bf16 a[52:55], v[172:175], v[116:119], a[52:55]
    v_mfma_f32_16x16x32_bf16 a[72:75], v[176:179], v[116:119], a[72:75]
    ds_read_b128 v[32:35], v13 offset:16384
    v_mfma_f32_16x16x32_bf16 a[92:95], v[180:183], v[116:119], a[92:95]
    v_mfma_f32_16x16x32_bf16 a[112:115], v[184:187], v[116:119], a[112:115]
    ds_read_b128 v[36:39], v14 offset:16384
    v_mfma_f32_16x16x32_bf16 a[132:135], v[188:191], v[116:119], a[132:135]
    v_mfma_f32_16x16x32_bf16 a[152:155], v[192:195], v[116:119], a[152:155]
    ds_read_b128 v[40:43], v15 offset:16384
    v_mfma_f32_16x16x32_bf16 v[156:159], v[196:199], v[116:119], v[156:159]
    v_mfma_f32_16x16x32_bf16 a[16:19], v[164:167], v[120:123], a[16:19]
    ds_read_b128 v[44:47], v16 offset:16384
    v_mfma_f32_16x16x32_bf16 a[36:39], v[168:171], v[120:123], a[36:39]
    v_mfma_f32_16x16x32_bf16 a[56:59], v[172:175], v[120:123], a[56:59]
    ds_read_b128 v[48:51], v13 offset:20480
    v_mfma_f32_16x16x32_bf16 a[76:79], v[176:179], v[120:123], a[76:79]
    v_mfma_f32_16x16x32_bf16 a[96:99], v[180:183], v[120:123], a[96:99]
    ds_read_b128 v[52:55], v14 offset:20480
    v_mfma_f32_16x16x32_bf16 a[116:119], v[184:187], v[120:123], a[116:119]
    v_mfma_f32_16x16x32_bf16 a[136:139], v[188:191], v[120:123], a[136:139]
    ds_read_b128 v[56:59], v15 offset:20480
    v_mfma_f32_16x16x32_bf16 a[156:159], v[192:195], v[120:123], a[156:159]
    v_mfma_f32_16x16x32_bf16 v[160:163], v[196:199], v[120:123], v[160:163]
    ds_read_b128 v[60:63], v16 offset:20480
    s_and_b32 s43, s2, 7
    s_lshl_b32 s43, s43, 2
    s_add_u32 s43, s43, 128
    v_mov_b32 v237, s43
    v_mov_b32 v236, 1
    s_cmp_lg_u32 s24, 0
    s_cbranch_scc1 L_tk_o
    v_cmp_eq_u32 vcc, 0, v0
    s_nop 3
    s_and_saveexec_b64 s[74:75], vcc
    buffer_atomic_add v236, v237, s[76:79], 0 offen sc0
    s_mov_b64 exec, s[74:75]
    s_branch L_tk_e
L_tk_o:
    buffer_load_dword v236, v235, s[4:7], 0 offen
L_tk_e:
    s_waitcnt lgkmcnt(0)
    s_barrier
    v_mfma_f32_16x16x32_bf16 v[64:67], v[32:35], a[160:163], v[124:127]
    v_mfma_f32_16x16x32_bf16 v[64:67], v[36:39], a[164:167], v[64:67]
    v_mfma_f32_16x16x32_bf16 v[64:67], v[40:43], a[168:171], v[64:67]
    v_mfma_f32_16x16x32_bf16 v[64:67], v[44:47], a[172:175], v[64:67]
    v_mfma_f32_16x16x32_bf16 v[68:71], v[48:51], a[160:163], v[124:127]
    v_mfma_f32_16x16x32_bf16 v[68:71], v[52:55], a[164:167], v[68:71]
    v_mfma_f32_16x16x32_bf16 v[68:71], v[56:59], a[168:171], v[68:71]
    v_mfma_f32_16x16x32_bf16 v[68:71], v[60:63], a[172:175], v[68:71]
    v_mfma_f32_16x16x32_bf16 v[72:75], v[32:35], a[176:179], v[128:131]
    s_nop 2
    v_exp_f32 v200, v64
    v_mfma_f32_16x16x32_bf16 v[72:75], v[36:39], a[180:183], v[72:75]
    v_exp_f32 v201, v65
    v_exp_f32 v202, v66
    v_mfma_f32_16x16x32_bf16 v[72:75], v[40:43], a[184:187], v[72:75]
    v_exp_f32 v203, v67
    v_exp_f32 v204, v68
    v_mfma_f32_16x16x32_bf16 v[72:75], v[44:47], a[188:191], v[72:75]
    v_cvt_pk_bf16_f32 v104, v200, v201
    v_exp_f32 v205, v69
    v_mfma_f32_16x16x32_bf16 v[76:79], v[48:51], a[176:179], v[128:131]
    v_cvt_pk_bf16_f32 v105, v202, v203
    v_mfma_f32_16x16x32_bf16 v[76:79], v[52:55], a[180:183], v[76:79]
    v_exp_f32 v206, v70
    v_exp_f32 v207, v71
    v_mfma_f32_16x16x32_bf16 v[76:79], v[56:59], a[184:187], v[76:79]
    v_cvt_pk_bf16_f32 v106, v204, v205
    v_cvt_pk_bf16_f32 v107, v206, v207
    v_mfma_f32_16x16x32_bf16 v[76:79], v[60:63], a[188:191], v[76:79]
    v_or3_b32 v23, v104, v105, v106
    v_or_b32 v23, v23, v107
    v_mfma_f32_16x16x32_bf16 v[80:83], v[32:35], a[192:195], v[132:135]
    v_exp_f32 v208, v72
    v_mfma_f32_16x16x32_bf16 v[80:83], v[36:39], a[196:199], v[80:83]
    v_exp_f32 v209, v73
    v_exp_f32 v210, v74
    v_mfma_f32_16x16x32_bf16 v[80:83], v[40:43], a[200:203], v[80:83]
    v_exp_f32 v211, v75
    v_exp_f32 v212, v76
    v_mfma_f32_16x16x32_bf16 v[80:83], v[44:47], a[204:207], v[80:83]
    v_cvt_pk_bf16_f32 v108, v208, v209
    v_exp_f32 v213, v77
    v_mfma_f32_16x16x32_bf16 v[84:87], v[48:51], a[192:195], v[132:135]
    v_cvt_pk_bf16_f32 v109, v210, v211
    v_mfma_f32_16x16x32_bf16 v[84:87], v[52:55], a[196:199], v[84:87]
    v_exp_f32 v214, v78
    v_exp_f32 v215, v79
    v_mfma_f32_16x16x32_bf16 v[84:87], v[56:59], a[200:203], v[84:87]
    v_cvt_pk_bf16_f32 v110, v212, v213
    v_cvt_pk_bf16_f32 v111, v214, v215
    v_mfma_f32_16x16x32_bf16 v[84:87], v[60:63], a[204:207], v[84:87]
    v_or3_b32 v23, v23, v108, v109
    v_or3_b32 v23, v23, v110, v111
    v_mfma_f32_16x16x32_bf16 v[88:91], v[32:35], a[208:211], v[136:139]
    s_waitcnt vmcnt(2)
    v_exp_f32 v200, v80
    v_mfma_f32_16x16x32_bf16 v[88:91], v[36:39], a[212:215], v[88:91]
    ds_read_b64_tr_b16 v[164:165], v2 offset:24576
    v_exp_f32 v201, v81
    ds_read_b64_tr_b16 v[166:167], v2 offset:28672
    v_mfma_f32_16x16x32_bf16 v[88:91], v[40:43], a[216:219], v[88:91]
    v_exp_f32 v202, v82
    v_exp_f32 v203, v83
    ds_read_b64_tr_b16 v[168:169], v3 offset:24576
    v_mfma_f32_16x16x32_bf16 v[88:91], v[44:47], a[220:223], v[88:91]
    v_exp_f32 v204, v84
    v_cvt_pk_bf16_f32 v112, v200, v201
    ds_read_b64_tr_b16 v[170:171], v3 offset:28672
    v_mfma_f32_16x16x32_bf16 v[92:95], v[48:51], a[208:211], v[136:139]
    v_exp_f32 v205, v85
    v_cvt_pk_bf16_f32 v113, v202, v203
    ds_read_b64_tr_b16 v[172:173], v4 offset:24576
    v_mfma_f32_16x16x32_bf16 v[92:95], v[52:55], a[212:215], v[92:95]
    v_exp_f32 v206, v86
    ds_read_b64_tr_b16 v[174:175], v4 offset:28672
    v_exp_f32 v207, v87
    v_mfma_f32_16x16x32_bf16 v[92:95], v[56:59], a[216:219], v[92:95]
    v_cvt_pk_bf16_f32 v114, v204, v205
    ds_read_b64_tr_b16 v[176:177], v5 offset:24576
    v_cvt_pk_bf16_f32 v115, v206, v207
    v_mfma_f32_16x16x32_bf16 v[92:95], v[60:63], a[220:223], v[92:95]
    v_or3_b32 v23, v23, v112, v113
    ds_read_b64_tr_b16 v[178:179], v5 offset:28672
    v_or3_b32 v23, v23, v114, v115
    v_mfma_f32_16x16x32_bf16 v[96:99], v[32:35], a[224:227], v[140:143]
    v_exp_f32 v208, v88
    ds_read_b64_tr_b16 v[180:181], v6 offset:24576
    v_mfma_f32_16x16x32_bf16 v[96:99], v[36:39], a[228:231], v[96:99]
    v_exp_f32 v209, v89
    ds_read_b64_tr_b16 v[182:183], v6 offset:28672
    v_exp_f32 v210, v90
    v_mfma_f32_16x16x32_bf16 v[96:99], v[40:43], a[232:235], v[96:99]
    v_exp_f32 v211, v91
    ds_read_b64_tr_b16 v[184:185], v7 offset:24576
    v_exp_f32 v212, v92
    v_mfma_f32_16x16x32_bf16 v[96:99], v[44:47], a[236:239], v[96:99]
    v_cvt_pk_bf16_f32 v116, v208, v209
    ds_read_b64_tr_b16 v[186:187], v7 offset:28672
    v_exp_f32 v213, v93
    v_mfma_f32_16x16x32_bf16 v[100:103], v[48:51], a[224:227], v[140:143]
    v_cvt_pk_bf16_f32 v117, v210, v211
    ds_read_b64_tr_b16 v[188:189], v8 offset:24576
    v_mfma_f32_16x16x32_bf16 v[100:103], v[52:55], a[228:231], v[100:103]
    v_exp_f32 v214, v94
    ds_read_b64_tr_b16 v[190:191], v8 offset:28672
    v_exp_f32 v215, v95
    v_mfma_f32_16x16x32_bf16 v[100:103], v[56:59], a[232:235], v[100:103]
    v_cvt_pk_bf16_f32 v118, v212, v213
    ds_read_b64_tr_b16 v[192:193], v9 offset:24576
    v_cvt_pk_bf16_f32 v119, v214, v215
    v_mfma_f32_16x16x32_bf16 v[100:103], v[60:63], a[236:239], v[100:103]
    v_or3_b32 v23, v23, v116, v117
    ds_read_b64_tr_b16 v[194:195], v9 offset:28672
    v_or3_b32 v23, v23, v118, v119
    v_exp_f32 v200, v96
    v_exp_f32 v201, v97
    v_exp_f32 v202, v98
    v_exp_f32 v203, v99
    s_nop 0
    v_exp_f32 v204, v100
    v_cvt_pk_bf16_f32 v120, v200, v201
    v_exp_f32 v205, v101
    v_cvt_pk_bf16_f32 v121, v202, v203
    v_exp_f32 v206, v102
    v_exp_f32 v207, v103
    v_cvt_pk_bf16_f32 v122, v204, v205
    v_cvt_pk_bf16_f32 v123, v206, v207
    v_or3_b32 v23, v23, v120, v121
    v_or3_b32 v23, v23, v122, v123
    v_and_b32 v23, s62, v23
    v_cmp_ne_u32 vcc, 0, v23
    s_nop 4
    s_cbranch_vccz L_ok_15
    s_call_b64 s[58:59], L_rescale
L_ok_15:
    s_waitcnt lgkmcnt(0)
    v_lshlrev_b32 v26, 4, v0
    v_mfma_f32_16x16x32_bf16 a[0:3], v[164:167], v[104:107], a[0:3]
    v_mfma_f32_16x16x32_bf16 a[20:23], v[168:171], v[104:107], a[20:23]
    v_mfma_f32_16x16x32_bf16 a[40:43], v[172:175], v[104:107], a[40:43]
    v_mfma_f32_16x16x32_bf16 a[60:63], v[176:179], v[104:107], a[60:63]
    v_mfma_f32_16x16x32_bf16 a[80:83], v[180:183], v[104:107], a[80:83]
    v_mfma_f32_16x16x32_bf16 a[100:103], v[184:187], v[104:107], a[100:103]
    v_mfma_f32_16x16x32_bf16 a[120:123], v[188:191], v[104:107], a[120:123]
    v_mfma_f32_16x16x32_bf16 a[140:143], v[192:195], v[104:107], a[140:143]
    v_mfma_f32_16x16x32_bf16 v[144:147], v[196:199], v[104:107], v[144:147]
    v_mfma_f32_16x16x32_bf16 a[4:7], v[164:167], v[108:111], a[4:7]
    v_mfma_f32_16x16x32_bf16 a[24:27], v[168:171], v[108:111], a[24:27]
    v_mfma_f32_16x16x32_bf16 a[44:47], v[172:175], v[108:111], a[44:47]
    s_nop 4
    v_rcp_f32 v124, v144
    s_add_u32 s41, s60, 0
    v_accvgpr_read_b32 v64, a0
    v_accvgpr_read_b32 v65, a1
    v_accvgpr_read_b32 v66, a2
    v_accvgpr_read_b32 v67, a3
    v_accvgpr_read_b32 v68, a20
    v_accvgpr_read_b32 v69, a21
    v_accvgpr_read_b32 v70, a22
    v_accvgpr_read_b32 v71, a23
    v_mul_f32 v64, v64, v124
    v_mul_f32 v65, v65, v124
    v_mfma_f32_16x16x32_bf16 a[64:67], v[176:179], v[108:111], a[64:67]
    v_mul_f32 v66, v66, v124
    v_mul_f32 v67, v67, v124
    v_mul_f32 v68, v68, v124
    v_mul_f32 v69, v69, v124
    v_mul_f32 v70, v70, v124
    v_mul_f32 v71, v71, v124
    v_cvt_pk_bf16_f32 v64, v64, v65
    v_cvt_pk_bf16_f32 v65, v66, v67
    v_cvt_pk_bf16_f32 v66, v68, v69
    v_cvt_pk_bf16_f32 v67, v70, v71
    buffer_store_dwordx4 v[64:67], v26, s[20:23], s41 offen sc1
    s_add_u32 s41, s60, 81920
    v_accvgpr_read_b32 v72, a40
    v_mfma_f32_16x16x32_bf16 a[84:87], v[180:183], v[108:111], a[84:87]
    v_accvgpr_read_b32 v73, a41
    v_accvgpr_read_b32 v74, a42
    v_accvgpr_read_b32 v75, a43
    v_accvgpr_read_b32 v76, a60
    v_accvgpr_read_b32 v77, a61
    v_accvgpr_read_b32 v78, a62
    v_accvgpr_read_b32 v79, a63
    v_mul_f32 v72, v72, v124
    v_mul_f32 v73, v73, v124
    v_mul_f32 v74, v74, v124
    v_mul_f32 v75, v75, v124
    v_mul_f32 v76, v76, v124
    v_mul_f32 v77, v77, v124
    v_mfma_f32_16x16x32_bf16 a[104:107], v[184:187], v[108:111], a[104:107]
    v_mul_f32 v78, v78, v124
    v_mul_f32 v79, v79, v124
    v_cvt_pk_bf16_f32 v72, v72, v73
    v_cvt_pk_bf16_f32 v73, v74, v75
    v_cvt_pk_bf16_f32 v74, v76, v77
    v_cvt_pk_bf16_f32 v75, v78, v79
    buffer_store_dwordx4 v[72:75], v26, s[20:23], s41 offen sc1
    s_add_u32 s41, s60, 163840
    v_accvgpr_read_b32 v80, a80
    v_accvgpr_read_b32 v81, a81
    v_accvgpr_read_b32 v82, a82
    v_accvgpr_read_b32 v83, a83
    v_mfma_f32_16x16x32_bf16 a[124:127], v[188:191], v[108:111], a[124:127]
    v_accvgpr_read_b32 v84, a100
    v_accvgpr_read_b32 v85, a101
    v_accvgpr_read_b32 v86, a102
    v_accvgpr_read_b32 v87, a103
    v_mul_f32 v80, v80, v124
    v_mul_f32 v81, v81, v124
    v_mul_f32 v82, v82, v124
    v_mul_f32 v83, v83, v124
    v_mul_f32 v84, v84, v124
    v_mul_f32 v85, v85, v124
    v_mul_f32 v86, v86, v124
    v_mul_f32 v87, v87, v124
    v_cvt_pk_bf16_f32 v80, v80, v81
    v_mfma_f32_16x16x32_bf16 a[144:147], v[192:195], v[108:111], a[144:147]
    v_cvt_pk_bf16_f32 v81, v82, v83
    v_cvt_pk_bf16_f32 v82, v84, v85
    v_cvt_pk_bf16_f32 v83, v86, v87
    buffer_store_dwordx4 v[80:83], v26, s[20:23], s41 offen sc1
    s_add_u32 s41, s60, 245760
    v_accvgpr_read_b32 v88, a120
    v_accvgpr_read_b32 v89, a121
    v_accvgpr_read_b32 v90, a122
    v_accvgpr_read_b32 v91, a123
    v_accvgpr_read_b32 v92, a140
    v_accvgpr_read_b32 v93, a141
    v_accvgpr_read_b32 v94, a142
    v_accvgpr_read_b32 v95, a143
    v_mfma_f32_16x16x32_bf16 v[148:151], v[196:199], v[108:111], v[148:151]
    v_mul_f32 v88, v88, v124
    v_mul_f32 v89, v89, v124
    v_mul_f32 v90, v90, v124
    v_mul_f32 v91, v91, v124
    v_mul_f32 v92, v92, v124
    v_mul_f32 v93, v93, v124
    v_mul_f32 v94, v94, v124
    v_mul_f32 v95, v95, v124
    v_cvt_pk_bf16_f32 v88, v88, v89
    v_cvt_pk_bf16_f32 v89, v90, v91
    v_cvt_pk_bf16_f32 v90, v92, v93
    v_cvt_pk_bf16_f32 v91, v94, v95
    buffer_store_dwordx4 v[88:91], v26, s[20:23], s41 offen sc1
    v_mfma_f32_16x16x32_bf16 a[8:11], v[164:167], v[112:115], a[8:11]
    v_mfma_f32_16x16x32_bf16 a[28:31], v[168:171], v[112:115], a[28:31]
    v_mfma_f32_16x16x32_bf16 a[48:51], v[172:175], v[112:115], a[48:51]
    v_rcp_f32 v125, v148
    s_add_u32 s41, s60, 1024
    v_accvgpr_read_b32 v64, a4
    v_accvgpr_read_b32 v65, a5
    v_accvgpr_read_b32 v66, a6
    v_accvgpr_read_b32 v67, a7
    v_accvgpr_read_b32 v68, a24
    v_accvgpr_read_b32 v69, a25
    v_accvgpr_read_b32 v70, a26
    v_accvgpr_read_b32 v71, a27
    v_mul_f32 v64, v64, v125
    v_mul_f32 v65, v65, v125
    v_mfma_f32_16x16x32_bf16 a[68:71], v[176:179], v[112:115], a[68:71]
    v_mul_f32 v66, v66, v125
    v_mul_f32 v67, v67, v125
    v_mul_f32 v68, v68, v125
    v_mul_f32 v69, v69, v125
    v_mul_f32 v70, v70, v125
    v_mul_f32 v71, v71, v125
    v_cvt_pk_bf16_f32 v64, v64, v65
    v_cvt_pk_bf16_f32 v65, v66, v67
    v_cvt_pk_bf16_f32 v66, v68, v69
    v_cvt_pk_bf16_f32 v67, v70, v71
    buffer_store_dwordx4 v[64:67], v26, s[20:23], s41 offen sc1
    s_add_u32 s41, s60, 82944
    v_accvgpr_read_b32 v72, a44
    v_mfma_f32_16x16x32_bf16 a[88:91], v[180:183], v[112:115], a[88:91]
    v_accvgpr_read_b32 v73, a45
    v_accvgpr_read_b32 v74, a46
    v_accvgpr_read_b32 v75, a47
    v_accvgpr_read_b32 v76, a64
    v_accvgpr_read_b32 v77, a65
    v_accvgpr_read_b32 v78, a66
    v_accvgpr_read_b32 v79, a67
    v_mul_f32 v72, v72, v125
    v_mul_f32 v73, v73, v125
    v_mul_f32 v74, v74, v125
    v_mul_f32 v75, v75, v125
    v_mul_f32 v76, v76, v125
    v_mul_f32 v77, v77, v125
    v_mfma_f32_16x16x32_bf16 a[108:111], v[184:187], v[112:115], a[108:111]
    v_mul_f32 v78, v78, v125
    v_mul_f32 v79, v79, v125
    v_cvt_pk_bf16_f32 v72, v72, v73
    v_cvt_pk_bf16_f32 v73, v74, v75
    v_cvt_pk_bf16_f32 v74, v76, v77
    v_cvt_pk_bf16_f32 v75, v78, v79
    buffer_store_dwordx4 v[72:75], v26, s[20:23], s41 offen sc1
    s_add_u32 s41, s60, 164864
    v_accvgpr_read_b32 v80, a84
    v_accvgpr_read_b32 v81, a85
    v_accvgpr_read_b32 v82, a86
    v_accvgpr_read_b32 v83, a87
    v_mfma_f32_16x16x32_bf16 a[128:131], v[188:191], v[112:115], a[128:131]
    v_accvgpr_read_b32 v84, a104
    v_accvgpr_read_b32 v85, a105
    v_accvgpr_read_b32 v86, a106
    v_accvgpr_read_b32 v87, a107
    v_mul_f32 v80, v80, v125
    v_mul_f32 v81, v81, v125
    v_mul_f32 v82, v82, v125
    v_mul_f32 v83, v83, v125
    v_mul_f32 v84, v84, v125
    v_mul_f32 v85, v85, v125
    v_mul_f32 v86, v86, v125
    v_mul_f32 v87, v87, v125
    v_cvt_pk_bf16_f32 v80, v80, v81
    v_mfma_f32_16x16x32_bf16 a[148:151], v[192:195], v[112:115], a[148:151]
    v_cvt_pk_bf16_f32 v81, v82, v83
    v_cvt_pk_bf16_f32 v82, v84, v85
    v_cvt_pk_bf16_f32 v83, v86, v87
    buffer_store_dwordx4 v[80:83], v26, s[20:23], s41 offen sc1
    s_add_u32 s41, s60, 246784
    v_accvgpr_read_b32 v88, a124
    v_accvgpr_read_b32 v89, a125
    v_accvgpr_read_b32 v90, a126
    v_accvgpr_read_b32 v91, a127
    v_accvgpr_read_b32 v92, a144
    v_accvgpr_read_b32 v93, a145
    v_accvgpr_read_b32 v94, a146
    v_accvgpr_read_b32 v95, a147
    v_mfma_f32_16x16x32_bf16 v[152:155], v[196:199], v[112:115], v[152:155]
    v_mul_f32 v88, v88, v125
    v_mul_f32 v89, v89, v125
    v_mul_f32 v90, v90, v125
    v_mul_f32 v91, v91, v125
    v_mul_f32 v92, v92, v125
    v_mul_f32 v93, v93, v125
    v_mul_f32 v94, v94, v125
    v_mul_f32 v95, v95, v125
    v_cvt_pk_bf16_f32 v88, v88, v89
    v_cvt_pk_bf16_f32 v89, v90, v91
    v_cvt_pk_bf16_f32 v90, v92, v93
    v_cvt_pk_bf16_f32 v91, v94, v95
    buffer_store_dwordx4 v[88:91], v26, s[20:23], s41 offen sc1
    v_mfma_f32_16x16x32_bf16 a[12:15], v[164:167], v[116:119], a[12:15]
    v_mfma_f32_16x16x32_bf16 a[32:35], v[168:171], v[116:119], a[32:35]
    v_mfma_f32_16x16x32_bf16 a[52:55], v[172:175], v[116:119], a[52:55]
    v_rcp_f32 v126, v152
    s_add_u32 s41, s60, 2048
    v_accvgpr_read_b32 v64, a8
    v_accvgpr_read_b32 v65, a9
    v_accvgpr_read_b32 v66, a10
    v_accvgpr_read_b32 v67, a11
    v_accvgpr_read_b32 v68, a28
    v_accvgpr_read_b32 v69, a29
    v_accvgpr_read_b32 v70, a30
    v_accvgpr_read_b32 v71, a31
    v_mul_f32 v64, v64, v126
    v_mul_f32 v65, v65, v126
    v_mfma_f32_16x16x32_bf16 a[72:75], v[176:179], v[116:119], a[72:75]
    v_mul_f32 v66, v66, v126
    v_mul_f32 v67, v67, v126
    v_mul_f32 v68, v68, v126
    v_mul_f32 v69, v69, v126
    v_mul_f32 v70, v70, v126
    v_mul_f32 v71, v71, v126
    v_cvt_pk_bf16_f32 v64, v64, v65
    v_cvt_pk_bf16_f32 v65, v66, v67
    v_cvt_pk_bf16_f32 v66, v68, v69
    v_cvt_pk_bf16_f32 v67, v70, v71
    buffer_store_dwordx4 v[64:67], v26, s[20:23], s41 offen sc1
    s_add_u32 s41, s60, 83968
    v_accvgpr_read_b32 v72, a48
    v_mfma_f32_16x16x32_bf16 a[92:95], v[180:183], v[116:119], a[92:95]
    v_accvgpr_read_b32 v73, a49
    v_accvgpr_read_b32 v74, a50
    v_accvgpr_read_b32 v75, a51
    v_accvgpr_read_b32 v76, a68
    v_accvgpr_read_b32 v77, a69
    v_accvgpr_read_b32 v78, a70
    v_accvgpr_read_b32 v79, a71
    v_mul_f32 v72, v72, v126
    v_mul_f32 v73, v73, v126
    v_mul_f32 v74, v74, v126
    v_mul_f32 v75, v75, v126
    v_mul_f32 v76, v76, v126
    v_mul_f32 v77, v77, v126
    v_mfma_f32_16x16x32_bf16 a[112:115], v[184:187], v[116:119], a[112:115]
    v_mul_f32 v78, v78, v126
    v_mul_f32 v79, v79, v126
    v_cvt_pk_bf16_f32 v72, v72, v73
    v_cvt_pk_bf16_f32 v73, v74, v75
    v_cvt_pk_bf16_f32 v74, v76, v77
    v_cvt_pk_bf16_f32 v75, v78, v79
    buffer_store_dwordx4 v[72:75], v26, s[20:23], s41 offen sc1
    s_add_u32 s41, s60, 165888
    v_accvgpr_read_b32 v80, a88
    v_accvgpr_read_b32 v81, a89
    v_accvgpr_read_b32 v82, a90
    v_accvgpr_read_b32 v83, a91
    v_mfma_f32_16x16x32_bf16 a[132:135], v[188:191], v[116:119], a[132:135]
    v_accvgpr_read_b32 v84, a108
    v_accvgpr_read_b32 v85, a109
    v_accvgpr_read_b32 v86, a110
    v_accvgpr_read_b32 v87, a111
    v_mul_f32 v80, v80, v126
    v_mul_f32 v81, v81, v126
    v_mul_f32 v82, v82, v126
    v_mul_f32 v83, v83, v126
    v_mul_f32 v84, v84, v126
    v_mul_f32 v85, v85, v126
    v_mul_f32 v86, v86, v126
    v_mul_f32 v87, v87, v126
    v_cvt_pk_bf16_f32 v80, v80, v81
    v_mfma_f32_16x16x32_bf16 a[152:155], v[192:195], v[116:119], a[152:155]
    v_cvt_pk_bf16_f32 v81, v82, v83
    v_cvt_pk_bf16_f32 v82, v84, v85
    v_cvt_pk_bf16_f32 v83, v86, v87
    buffer_store_dwordx4 v[80:83], v26, s[20:23], s41 offen sc1
    s_add_u32 s41, s60, 247808
    v_accvgpr_read_b32 v88, a128
    v_accvgpr_read_b32 v89, a129
    v_accvgpr_read_b32 v90, a130
    v_accvgpr_read_b32 v91, a131
    v_accvgpr_read_b32 v92, a148
    v_accvgpr_read_b32 v93, a149
    v_accvgpr_read_b32 v94, a150
    v_accvgpr_read_b32 v95, a151
    v_mfma_f32_16x16x32_bf16 v[156:159], v[196:199], v[116:119], v[156:159]
    v_mul_f32 v88, v88, v126
    v_mul_f32 v89, v89, v126
    v_mul_f32 v90, v90, v126
    v_mul_f32 v91, v91, v126
    v_mul_f32 v92, v92, v126
    v_mul_f32 v93, v93, v126
    v_mul_f32 v94, v94, v126
    v_mul_f32 v95, v95, v126
    v_cvt_pk_bf16_f32 v88, v88, v89
    v_cvt_pk_bf16_f32 v89, v90, v91
    v_cvt_pk_bf16_f32 v90, v92, v93
    v_cvt_pk_bf16_f32 v91, v94, v95
    buffer_store_dwordx4 v[88:91], v26, s[20:23], s41 offen sc1
    v_mfma_f32_16x16x32_bf16 a[16:19], v[164:167], v[120:123], a[16:19]
    v_mfma_f32_16x16x32_bf16 a[36:39], v[168:171], v[120:123], a[36:39]
    v_mfma_f32_16x16x32_bf16 a[56:59], v[172:175], v[120:123], a[56:59]
    v_rcp_f32 v127, v156
    s_add_u32 s41, s60, 3072
    v_accvgpr_read_b32 v64, a12
    v_accvgpr_read_b32 v65, a13
    v_accvgpr_read_b32 v66, a14
    v_accvgpr_read_b32 v67, a15
    v_accvgpr_read_b32 v68, a32
    v_accvgpr_read_b32 v69, a33
    v_accvgpr_read_b32 v70, a34
    v_accvgpr_read_b32 v71, a35
    v_mul_f32 v64, v64, v127
    v_mul_f32 v65, v65, v127
    v_mfma_f32_16x16x32_bf16 a[76:79], v[176:179], v[120:123], a[76:79]
    v_mul_f32 v66, v66, v127
    v_mul_f32 v67, v67, v127
    v_mul_f32 v68, v68, v127
    v_mul_f32 v69, v69, v127
    v_mul_f32 v70, v70, v127
    v_mul_f32 v71, v71, v127
    v_cvt_pk_bf16_f32 v64, v64, v65
    v_cvt_pk_bf16_f32 v65, v66, v67
    v_cvt_pk_bf16_f32 v66, v68, v69
    v_cvt_pk_bf16_f32 v67, v70, v71
    buffer_store_dwordx4 v[64:67], v26, s[20:23], s41 offen sc1
    s_add_u32 s41, s60, 84992
    v_accvgpr_read_b32 v72, a52
    v_mfma_f32_16x16x32_bf16 a[96:99], v[180:183], v[120:123], a[96:99]
    v_accvgpr_read_b32 v73, a53
    v_accvgpr_read_b32 v74, a54
    v_accvgpr_read_b32 v75, a55
    v_accvgpr_read_b32 v76, a72
    v_accvgpr_read_b32 v77, a73
    v_accvgpr_read_b32 v78, a74
    v_accvgpr_read_b32 v79, a75
    v_mul_f32 v72, v72, v127
    v_mul_f32 v73, v73, v127
    v_mul_f32 v74, v74, v127
    v_mul_f32 v75, v75, v127
    v_mul_f32 v76, v76, v127
    v_mul_f32 v77, v77, v127
    v_mfma_f32_16x16x32_bf16 a[116:119], v[184:187], v[120:123], a[116:119]
    v_mul_f32 v78, v78, v127
    v_mul_f32 v79, v79, v127
    v_cvt_pk_bf16_f32 v72, v72, v73
    v_cvt_pk_bf16_f32 v73, v74, v75
    v_cvt_pk_bf16_f32 v74, v76, v77
    v_cvt_pk_bf16_f32 v75, v78, v79
    buffer_store_dwordx4 v[72:75], v26, s[20:23], s41 offen sc1
    s_add_u32 s41, s60, 166912
    v_accvgpr_read_b32 v80, a92
    v_accvgpr_read_b32 v81, a93
    v_accvgpr_read_b32 v82, a94
    v_accvgpr_read_b32 v83, a95
    v_mfma_f32_16x16x32_bf16 a[136:139], v[188:191], v[120:123], a[136:139]
    v_accvgpr_read_b32 v84, a112
    v_accvgpr_read_b32 v85, a113
    v_accvgpr_read_b32 v86, a114
    v_accvgpr_read_b32 v87, a115
    v_mul_f32 v80, v80, v127
    v_mul_f32 v81, v81, v127
    v_mul_f32 v82, v82, v127
    v_mul_f32 v83, v83, v127
    v_mul_f32 v84, v84, v127
    v_mul_f32 v85, v85, v127
    v_mul_f32 v86, v86, v127
    v_mul_f32 v87, v87, v127
    v_cvt_pk_bf16_f32 v80, v80, v81
    v_mfma_f32_16x16x32_bf16 a[156:159], v[192:195], v[120:123], a[156:159]
    v_cvt_pk_bf16_f32 v81, v82, v83
    v_cvt_pk_bf16_f32 v82, v84, v85
    v_cvt_pk_bf16_f32 v83, v86, v87
    buffer_store_dwordx4 v[80:83], v26, s[20:23], s41 offen sc1
    s_add_u32 s41, s60, 248832
    v_accvgpr_read_b32 v88, a132
    v_accvgpr_read_b32 v89, a133
    v_accvgpr_read_b32 v90, a134
    v_accvgpr_read_b32 v91, a135
    v_accvgpr_read_b32 v92, a152
    v_accvgpr_read_b32 v93, a153
    v_accvgpr_read_b32 v94, a154
    v_accvgpr_read_b32 v95, a155
    v_mfma_f32_16x16x32_bf16 v[160:163], v[196:199], v[120:123], v[160:163]
    v_mul_f32 v88, v88, v127
    v_mul_f32 v89, v89, v127
    v_mul_f32 v90, v90, v127
    v_mul_f32 v91, v91, v127
    v_mul_f32 v92, v92, v127
    v_mul_f32 v93, v93, v127
    v_mul_f32 v94, v94, v127
    v_mul_f32 v95, v95, v127
    v_cvt_pk_bf16_f32 v88, v88, v89
    v_cvt_pk_bf16_f32 v89, v90, v91
    v_cvt_pk_bf16_f32 v90, v92, v93
    v_cvt_pk_bf16_f32 v91, v94, v95
    buffer_store_dwordx4 v[88:91], v26, s[20:23], s41 offen sc1
    v_rcp_f32 v128, v160
    s_add_u32 s41, s60, 4096
    v_accvgpr_read_b32 v64, a16
    v_accvgpr_read_b32 v65, a17
    v_accvgpr_read_b32 v66, a18
    v_accvgpr_read_b32 v67, a19
    v_accvgpr_read_b32 v68, a36
    v_accvgpr_read_b32 v69, a37
    v_accvgpr_read_b32 v70, a38
    v_accvgpr_read_b32 v71, a39
    v_mul_f32 v64, v64, v128
    v_mul_f32 v65, v65, v128
    v_mul_f32 v66, v66, v128
    v_mul_f32 v67, v67, v128
    v_mul_f32 v68, v68, v128
    v_mul_f32 v69, v69, v128
    v_mul_f32 v70, v70, v128
    v_mul_f32 v71, v71, v128
    v_cvt_pk_bf16_f32 v64, v64, v65
    v_cvt_pk_bf16_f32 v65, v66, v67
    v_cvt_pk_bf16_f32 v66, v68, v69
    v_cvt_pk_bf16_f32 v67, v70, v71
    buffer_store_dwordx4 v[64:67], v26, s[20:23], s41 offen sc1
    s_add_u32 s41, s60, 86016
    v_accvgpr_read_b32 v72, a56
    v_accvgpr_read_b32 v73, a57
    v_accvgpr_read_b32 v74, a58
    v_accvgpr_read_b32 v75, a59
    v_accvgpr_read_b32 v76, a76
    v_accvgpr_read_b32 v77, a77
    v_accvgpr_read_b32 v78, a78
    v_accvgpr_read_b32 v79, a79
    v_mul_f32 v72, v72, v128
    v_mul_f32 v73, v73, v128
    v_mul_f32 v74, v74, v128
    v_mul_f32 v75, v75, v128
    v_mul_f32 v76, v76, v128
    v_mul_f32 v77, v77, v128
    v_mul_f32 v78, v78, v128
    v_mul_f32 v79, v79, v128
    v_cvt_pk_bf16_f32 v72, v72, v73
    v_cvt_pk_bf16_f32 v73, v74, v75
    v_cvt_pk_bf16_f32 v74, v76, v77
    v_cvt_pk_bf16_f32 v75, v78, v79
    buffer_store_dwordx4 v[72:75], v26, s[20:23], s41 offen sc1
    s_add_u32 s41, s60, 167936
    v_accvgpr_read_b32 v80, a96
    v_accvgpr_read_b32 v81, a97
    v_accvgpr_read_b32 v82, a98
    v_accvgpr_read_b32 v83, a99
    v_accvgpr_read_b32 v84, a116
    v_accvgpr_read_b32 v85, a117
    v_accvgpr_read_b32 v86, a118
    v_accvgpr_read_b32 v87, a119
    v_mul_f32 v80, v80, v128
    v_mul_f32 v81, v81, v128
    v_mul_f32 v82, v82, v128
    v_mul_f32 v83, v83, v128
    v_mul_f32 v84, v84, v128
    v_mul_f32 v85, v85, v128
    v_mul_f32 v86, v86, v128
    v_mul_f32 v87, v87, v128
    v_cvt_pk_bf16_f32 v80, v80, v81
    v_cvt_pk_bf16_f32 v81, v82, v83
    v_cvt_pk_bf16_f32 v82, v84, v85
    v_cvt_pk_bf16_f32 v83, v86, v87
    buffer_store_dwordx4 v[80:83], v26, s[20:23], s41 offen sc1
    s_add_u32 s41, s60, 249856
    v_accvgpr_read_b32 v88, a136
    v_accvgpr_read_b32 v89, a137
    v_accvgpr_read_b32 v90, a138
    v_accvgpr_read_b32 v91, a139
    v_accvgpr_read_b32 v92, a156
    v_accvgpr_read_b32 v93, a157
    v_accvgpr_read_b32 v94, a158
    v_accvgpr_read_b32 v95, a159
    v_mul_f32 v88, v88, v128
    v_mul_f32 v89, v89, v128
    v_mul_f32 v90, v90, v128
    v_mul_f32 v91, v91, v128
    v_mul_f32 v92, v92, v128
    v_mul_f32 v93, v93, v128
    v_mul_f32 v94, v94, v128
    v_mul_f32 v95, v95, v128
    v_cvt_pk_bf16_f32 v88, v88, v89
    v_cvt_pk_bf16_f32 v89, v90, v91
    v_cvt_pk_bf16_f32 v90, v92, v93
    v_cvt_pk_bf16_f32 v91, v94, v95
    buffer_store_dwordx4 v[88:91], v26, s[20:23], s41 offen sc1
    s_lshl_b32 s40, s25, 3
    s_lshr_b32 s41, s26, 1
    s_add_u32 s40, s40, s41
    s_lshl_b32 s40, s40, 4
    s_lshr_b32 s41, s27, 1
    s_add_u32 s40, s40, s41
    s_lshl_b32 s67, s40, 7
    s_load_dwordx4 s[68:71], s[0:1], 80
    s_load_dwordx2 s[72:73], s[0:1], 96
    s_and_b32 s42, s2, 7
    s_lshr_b32 s25, s42, 2
    s_and_b32 s26, s42, 3
    s_mul_i32 s44, s25, 40
    s_add_u32 s46, s0, s44
    s_addc_u32 s47, s1, 0
    s_load_dwordx2 s[64:65], s[46:47], 32
    v_mov_b32 v22, 32832
    s_waitcnt vmcnt(20)
    s_cmp_lg_u32 s24, 0
    s_cbranch_scc1 L_g2_tk
    s_mov_b32 s45, 0
L_g2_nonce0:
    v_readfirstlane_b32 s66, v234
    s_nop 3
    s_cmp_lg_u32 s66, 0
    s_cbranch_scc1 L_g2_nonce0_ok
    buffer_load_dword v234, v235, s[76:79], 0 offen sc1
    s_waitcnt vmcnt(0)
    s_add_u32 s45, s45, 1
    s_cmp_lt_u32 s45, 400000
    s_cbranch_scc1 L_g2_nonce0
L_g2_nonce0_ok:
    v_cmp_eq_u32 vcc, 0, v0
    s_nop 3
    s_and_saveexec_b64 s[74:75], vcc
    ds_write_b32 v22, v236
    ds_write_b32 v22, v234 offset:4
    s_waitcnt lgkmcnt(0)
    s_mov_b64 exec, s[74:75]
L_g2_tk:
    s_barrier
    ds_read_b32 v21, v22
    ds_read_b32 v234, v22 offset:4
    s_waitcnt lgkmcnt(0)
    v_readfirstlane_b32 s36, v21
    s_nop 3
    s_mul_hi_u32 s27, s36, 0x55555556
    s_mul_i32 s42, s27, 3
    s_sub_u32 s28, s36, s42
    s_lshl_b32 s42, s25, 7
    s_lshl_b32 s43, s26, 5
    s_add_u32 s42, s42, s43
    s_mul_i32 s42, s42, 80
    s_lshl_b32 s43, s27, 3
    s_add_u32 s42, s42, s43
    s_lshl_b32 s43, s24, 1
    s_add_u32 s42, s42, s43
    s_lshl_b32 s29, s42, 10
    s_mul_i32 s34, s26, 1179648
    s_mul_i32 s42, s28, 384
    s_add_u32 s34, s34, s42
    s_mul_i32 s42, s24, 9216
    s_add_u32 s34, s34, s42
    s_lshl_b32 s40, s27, 7
    s_add_u32 s41, s40, 127
    s_mul_i32 s40, s40, 52429
    s_lshr_b32 s40, s40, 23
    s_mul_i32 s41, s41, 52429
    s_lshr_b32 s41, s41, 23
    s_min_u32 s40, s40, 7
    s_min_u32 s41, s41, 7
    s_lshl_b32 s42, s25, 3
    s_add_u32 s40, s40, s42
    s_lshl_b32 s40, s40, 4
    s_add_u32 s41, s41, s42
    s_lshl_b32 s41, s41, 4
    s_lshl_b32 s42, s26, 2
    s_add_u32 s40, s40, s42
    s_add_u32 s41, s41, s42
    v_mov_b32 v23, s40
    v_mov_b32 v21, s41
    v_cmp_gt_u32 vcc, 4, v0
    s_nop 1
    v_cndmask_b32 v23, v21, v23, vcc
    v_and_b32 v21, 3, v0
    v_add_u32 v23, v23, v21
    v_lshlrev_b32 v23, 7, v23
    s_mov_b32 s35, 0
    s_add_u32 s38, s28, s27
    s_and_b32 s38, s38, 3
    s_mul_i32 s43, s28, 3
    s_add_u32 s43, s43, s27
    s_add_u32 s56, s43, 0
    s_and_b32 s56, s56, 7
    s_add_u32 s57, s43, 1
    s_and_b32 s57, s57, 7
    s_add_u32 s58, s43, 2
    s_and_b32 s58, s58, 7
    s_add_u32 s59, s43, 3
    s_and_b32 s59, s59, 7
    s_add_u32 s60, s43, 4
    s_and_b32 s60, s60, 7
    s_add_u32 s61, s43, 5
    s_and_b32 s61, s61, 7
    s_add_u32 s62, s43, 6
    s_and_b32 s62, s62, 7
    s_add_u32 s63, s43, 7
    s_and_b32 s63, s63, 7
    v_mov_b32 v26, 82048
    v_lshlrev_b32 v8, 4, v0
    v_add_u32 v12, 0, v0
    v_mul_u32_u24 v13, 2731, v12
    v_lshrrev_b32 v13, 16, v13
    v_mul_u32_u24 v14, 24, v13
    v_sub_u32 v14, v12, v14
    v_lshrrev_b32 v15, 1, v13
    v_and_b32 v15, 3, v15
    v_lshlrev_b32 v15, 1, v15
    v_xor_b32 v14, v14, v15
    v_lshlrev_b32 v14, 4, v14
    v_mul_u32_u24 v13, 1152, v13
    v_add_u32 v13, v13, v14
    v_add_u32 v9, s34, v13
    v_add_u32 v12, 64, v0
    v_mul_u32_u24 v13, 2731, v12
    v_lshrrev_b32 v13, 16, v13
    v_mul_u32_u24 v14, 24, v13
    v_sub_u32 v14, v12, v14
    v_lshrrev_b32 v15, 1, v13
    v_and_b32 v15, 3, v15
    v_lshlrev_b32 v15, 1, v15
    v_xor_b32 v14, v14, v15
    v_lshlrev_b32 v14, 4, v14
    v_mul_u32_u24 v13, 1152, v13
    v_add_u32 v13, v13, v14
    v_add_u32 v10, s34, v13
    v_add_u32 v12, 128, v0
    v_mul_u32_u24 v13, 2731, v12
    v_lshrrev_b32 v13, 16, v13
    v_mul_u32_u24 v14, 24, v13
    v_sub_u32 v14, v12, v14
    v_lshrrev_b32 v15, 1, v13
    v_and_b32 v15, 3, v15
    v_lshlrev_b32 v15, 1, v15
    v_xor_b32 v14, v14, v15
    v_lshlrev_b32 v14, 4, v14
    v_mul_u32_u24 v13, 1152, v13
    v_add_u32 v13, v13, v14
    v_add_u32 v11, s34, v13
    s_lshr_b32 s42, s24, 1
    s_lshl_b32 s42, s42, 12
    v_add_u32 v1, s42, v8
    v_lshrrev_b32 v12, 4, v0
    v_and_b32 v13, 15, v0
    v_lshrrev_b32 v13, 2, v13
    v_lshlrev_b32 v14, 2, v12
    v_add_u32 v14, v14, v13
    v_lshrrev_b32 v15, 1, v14
    v_and_b32 v15, 3, v15
    v_lshlrev_b32 v15, 1, v15
    v_mul_u32_u24 v16, 384, v14
    v_and_b32 v17, 3, v0
    v_lshrrev_b32 v18, 1, v17
    v_and_b32 v17, 1, v17
    v_lshlrev_b32 v17, 3, v17
    v_add_u32 v16, v16, v17
    v_add_u32 v16, 32768, v16
    s_and_b32 s42, s24, 1
    s_mul_i32 s42, s42, 12
    s_add_u32 s43, s42, 0
    v_add_u32 v19, s43, v18
    v_xor_b32 v19, v19, v15
    v_lshlrev_b32 v19, 4, v19
    v_add_u32 v2, v19, v16
    s_add_u32 s43, s42, 2
    v_add_u32 v19, s43, v18
    v_xor_b32 v19, v19, v15
    v_lshlrev_b32 v19, 4, v19
    v_add_u32 v3, v19, v16
    s_add_u32 s43, s42, 4
    v_add_u32 v19, s43, v18
    v_xor_b32 v19, v19, v15
    v_lshlrev_b32 v19, 4, v19
    v_add_u32 v4, v19, v16
    s_add_u32 s43, s42, 6
    v_add_u32 v19, s43, v18
    v_xor_b32 v19, v19, v15
    v_lshlrev_b32 v19, 4, v19
    v_add_u32 v5, v19, v16
    s_add_u32 s43, s42, 8
    v_add_u32 v19, s43, v18
    v_xor_b32 v19, v19, v15
    v_lshlrev_b32 v19, 4, v19
    v_add_u32 v6, v19, v16
    s_add_u32 s43, s42, 10
    v_add_u32 v19, s43, v18
    v_xor_b32 v19, v19, v15
    v_lshlrev_b32 v19, 4, v19
    v_add_u32 v7, v19, v16
    s_waitcnt vmcnt(20) lgkmcnt(0)
    s_mov_b32 s20, s70
    s_mov_b32 s21, s71
    s_mov_b32 s22, 256
    s_mov_b32 s23, 0x20000
    s_mov_b32 s45, 0
L_g2_nonce:
    v_readfirstlane_b32 s66, v234
    s_nop 3
    s_cmp_lg_u32 s66, 0
    s_cbranch_scc1 L_g2_nonce_ok
    v_mov_b32 v235, 0
    buffer_load_dword v234, v235, s[20:23], 0 offen sc1
    s_waitcnt vmcnt(0)
    s_add_u32 s45, s45, 1
    s_cmp_lt_u32 s45, 400000
    s_cbranch_scc1 L_g2_nonce
L_g2_nonce_ok:
    s_add_u32 s20, s72, 50331648
    s_addc_u32 s21, s73, 0
    s_mov_b32 s22, 65536
    s_mov_b32 s23, 0x20000
    s_mov_b32 s4, s72
    s_mov_b32 s5, s73
    s_mov_b32 s6, 20971520
    s_mov_b32 s7, 0x20000
    s_mov_b32 s8, s64
    s_mov_b32 s9, s65
    s_mov_b32 s10, 4718592
    s_mov_b32 s11, 0x20000
    s_add_u32 s12, s72, 33554432
    s_addc_u32 s13, s73, 0
    s_mov_b32 s14, 11796480
    s_mov_b32 s15, 0x20000
    s_mov_b32 s16, s68
    s_mov_b32 s17, s69
    s_mov_b32 s18, 2949120
    s_mov_b32 s19, 0x20000
    s_lshl_b32 s79, s24, 11
    s_mul_i32 s39, s24, 3072
    s_add_u32 s39, s39, 32768
    v_mov_b32 v32, 0
    v_mov_b32 v33, 0
    v_mov_b32 v34, 0
    v_mov_b32 v35, 0
    v_mov_b32 v36, 0
    v_mov_b32 v37, 0
    v_mov_b32 v38, 0
    v_mov_b32 v39, 0
    v_mov_b32 v40, 0
    v_mov_b32 v41, 0
    v_mov_b32 v42, 0
    v_mov_b32 v43, 0
    v_mov_b32 v44, 0
    v_mov_b32 v45, 0
    v_mov_b32 v46, 0
    v_mov_b32 v47, 0
    v_mov_b32 v48, 0
    v_mov_b32 v49, 0
    v_mov_b32 v50, 0
    v_mov_b32 v51, 0
    v_mov_b32 v52, 0
    v_mov_b32 v53, 0
    v_mov_b32 v54, 0
    v_mov_b32 v55, 0
    v_mov_b32 v56, 0
    v_mov_b32 v57, 0
    v_mov_b32 v58, 0
    v_mov_b32 v59, 0
    v_mov_b32 v60, 0
    v_mov_b32 v61, 0
    v_mov_b32 v62, 0
    v_mov_b32 v63, 0
    v_mov_b32 v64, 0
    v_mov_b32 v65, 0
    v_mov_b32 v66, 0
    v_mov_b32 v67, 0
    v_mov_b32 v68, 0
    v_mov_b32 v69, 0
    v_mov_b32 v70, 0
    v_mov_b32 v71, 0
    v_mov_b32 v72, 0
    v_mov_b32 v73, 0
    v_mov_b32 v74, 0
    v_mov_b32 v75, 0
    v_mov_b32 v76, 0
    v_mov_b32 v77, 0
    v_mov_b32 v78, 0
    v_mov_b32 v79, 0
    v_mov_b32 v80, 0
    v_mov_b32 v81, 0
    v_mov_b32 v82, 0
    v_mov_b32 v83, 0
    v_mov_b32 v84, 0
    v_mov_b32 v85, 0
    v_mov_b32 v86, 0
    v_mov_b32 v87, 0
    v_mov_b32 v88, 0
    v_mov_b32 v89, 0
    v_mov_b32 v90, 0
    v_mov_b32 v91, 0
    v_mov_b32 v92, 0
    v_mov_b32 v93, 0
    v_mov_b32 v94, 0
    v_mov_b32 v95, 0
    v_mov_b32 v96, 0
    v_mov_b32 v97, 0
    v_mov_b32 v98, 0
    v_mov_b32 v99, 0
    v_mov_b32 v100, 0
    v_mov_b32 v101, 0
    v_mov_b32 v102, 0
    v_mov_b32 v103, 0
    v_mov_b32 v104, 0
    v_mov_b32 v105, 0
    v_mov_b32 v106, 0
    v_mov_b32 v107, 0
    v_mov_b32 v108, 0
    v_mov_b32 v109, 0
    v_mov_b32 v110, 0
    v_mov_b32 v111, 0
    v_mov_b32 v112, 0
    v_mov_b32 v113, 0
    v_mov_b32 v114, 0
    v_mov_b32 v115, 0
    v_mov_b32 v116, 0
    v_mov_b32 v117, 0
    v_mov_b32 v118, 0
    v_mov_b32 v119, 0
    v_mov_b32 v120, 0
    v_mov_b32 v121, 0
    v_mov_b32 v122, 0
    v_mov_b32 v123, 0
    v_mov_b32 v124, 0
    v_mov_b32 v125, 0
    v_mov_b32 v126, 0
    v_mov_b32 v127, 0
    buffer_load_dword v24, v23, s[20:23], 0 offen sc1
    s_waitcnt vmcnt(0)
    s_barrier
    s_cmp_lg_u32 s24, 0
    s_cbranch_scc1 L_g2_sig
    v_mov_b32 v13, s67
    v_mov_b32 v14, s66
    v_cmp_eq_u32 vcc, 0, v0
    s_nop 3
    s_and_saveexec_b64 s[74:75], vcc
    buffer_store_dword v14, v13, s[20:23], 0 offen sc1
    s_mov_b64 exec, s[74:75]
L_g2_sig:
    s_cmp_ge_u32 s36, 30
    s_cbranch_scc1 L_g2_done
    s_cmp_lg_u32 s24, 0
    s_cbranch_scc1 L_g2_pk0_end
    s_mov_b32 s45, 0
    s_waitcnt vmcnt(63)
    s_branch L_g2_pk0_chk
L_g2_pk0_ld:
    buffer_load_dword v24, v23, s[20:23], 0 offen sc1
    s_waitcnt vmcnt(0)
L_g2_pk0_chk:
    v_cmp_eq_u32 vcc, s66, v24
    s_nop 3
    s_lshr_b32 s47, vcc_lo, 4
    s_and_b32 s46, vcc_lo, s47
    s_and_b32 s46, s46, 15
    s_andn2_b32 s46, s46, s35
    s_cmp_lg_u32 s46, 0
    s_cbranch_scc1 L_g2_pk0_got
    s_sleep 2
    s_add_u32 s45, s45, 1
    s_cmp_lt_u32 s45, 400000
    s_cbranch_scc1 L_g2_pk0_ld
    s_andn2_b32 s46, 15, s35
L_g2_pk0_got:
    s_ff1_i32_b32 s46, s46
    v_mov_b32 v25, s46
    ds_write_b32 v26, v25
    s_waitcnt lgkmcnt(0)
L_g2_pk0_end:
    s_barrier
    ds_read_b32 v25, v26
    s_waitcnt lgkmcnt(0)
    v_readfirstlane_b32 s37, v25
    s_nop 3
    s_lshl_b32 s46, 1, s37
    s_or_b32 s35, s35, s46
    s_mul_i32 s30, s37, 655360
    s_add_u32 s30, s30, s29
    s_mul_i32 s31, s37, 294912
    s_mul_i32 s48, s56, 81920
    s_add_u32 s48, s48, s30
    s_add_u32 m0, s79, 0
    s_nop 0
    buffer_load_dwordx4 v8, s[4:7], s48 offen sc1 lds
    buffer_load_dwordx4 v8, s[4:7], s48 offen offset:1024 sc1 lds
    s_mul_i32 s49, s56, 36864
    s_add_u32 s49, s49, s31
    s_add_u32 m0, s39, 0
    s_nop 0
    buffer_load_dwordx4 v9, s[8:11], s49 offen lds
    s_add_u32 m0, s39, 1024
    s_nop 0
    buffer_load_dwordx4 v10, s[8:11], s49 offen lds
    s_add_u32 m0, s39, 2048
    s_nop 0
    buffer_load_dwordx4 v11, s[8:11], s49 offen lds
    s_mul_i32 s48, s57, 81920
    s_add_u32 s48, s48, s30
    s_add_u32 m0, s79, 8192
    s_nop 0
    buffer_load_dwordx4 v8, s[4:7], s48 offen sc1 lds
    buffer_load_dwordx4 v8, s[4:7], s48 offen offset:1024 sc1 lds
    s_mul_i32 s49, s57, 36864
    s_add_u32 s49, s49, s31
    s_add_u32 m0, s39, 12288
    s_nop 0
    buffer_load_dwordx4 v9, s[8:11], s49 offen lds
    s_add_u32 m0, s39, 13312
    s_nop 0
    buffer_load_dwordx4 v10, s[8:11], s49 offen lds
    s_add_u32 m0, s39, 14336
    s_nop 0
    buffer_load_dwordx4 v11, s[8:11], s49 offen lds
    s_mul_i32 s48, s58, 81920
    s_add_u32 s48, s48, s30
    s_add_u32 m0, s79, 16384
    s_nop 0
    buffer_load_dwordx4 v8, s[4:7], s48 offen sc1 lds
    buffer_load_dwordx4 v8, s[4:7], s48 offen offset:1024 sc1 lds
    s_mul_i32 s49, s58, 36864
    s_add_u32 s49, s49, s31
    s_add_u32 m0, s39, 24576
    s_nop 0
    buffer_load_dwordx4 v9, s[8:11], s49 offen lds
    s_add_u32 m0, s39, 25600
    s_nop 0
    buffer_load_dwordx4 v10, s[8:11], s49 offen lds
    s_add_u32 m0, s39, 26624
    s_nop 0
    buffer_load_dwordx4 v11, s[8:11], s49 offen lds
    s_mul_i32 s48, s59, 81920
    s_add_u32 s48, s48, s30
    s_add_u32 m0, s79, 24576
    s_nop 0
    buffer_load_dwordx4 v8, s[4:7], s48 offen sc1 lds
    buffer_load_dwordx4 v8, s[4:7], s48 offen offset:1024 sc1 lds
    s_mul_i32 s49, s59, 36864
    s_add_u32 s49, s49, s31
    s_add_u32 m0, s39, 36864
    s_nop 0
    buffer_load_dwordx4 v9, s[8:11], s49 offen lds
    s_add_u32 m0, s39, 37888
    s_nop 0
    buffer_load_dwordx4 v10, s[8:11], s49 offen lds
    s_add_u32 m0, s39, 38912
    s_nop 0
    buffer_load_dwordx4 v11, s[8:11], s49 offen lds
    s_waitcnt vmcnt(15)
    s_barrier
    ds_read_b128 v[128:131], v1 offset:0
    ds_read_b64_tr_b16 v[160:161], v2 offset:0
    ds_read_b64_tr_b16 v[162:163], v2 offset:6144
    ds_read_b128 v[132:135], v1 offset:1024
    ds_read_b128 v[136:139], v1 offset:2048
    ds_read_b128 v[140:143], v1 offset:3072
    ds_read_b64_tr_b16 v[164:165], v3 offset:0
    ds_read_b64_tr_b16 v[166:167], v3 offset:6144
    ds_read_b64_tr_b16 v[168:169], v4 offset:0
    ds_read_b64_tr_b16 v[170:171], v4 offset:6144
    ds_read_b64_tr_b16 v[172:173], v5 offset:0
    ds_read_b64_tr_b16 v[174:175], v5 offset:6144
    ds_read_b64_tr_b16 v[176:177], v6 offset:0
    ds_read_b64_tr_b16 v[178:179], v6 offset:6144
    ds_read_b64_tr_b16 v[180:181], v7 offset:0
    ds_read_b64_tr_b16 v[182:183], v7 offset:6144
    s_mov_b32 s50, 0
    s_waitcnt lgkmcnt(0)
L_g2_seg:
    s_waitcnt lgkmcnt(0)
    v_mfma_f32_16x16x32_bf16 v[32:35], v[160:163], v[128:131], v[32:35]
    v_mfma_f32_16x16x32_bf16 v[56:59], v[160:163], v[132:135], v[56:59]
    s_waitcnt vmcnt(10)
    s_barrier
    v_mfma_f32_16x16x32_bf16 v[80:83], v[160:163], v[136:139], v[80:83]
    ds_read_b128 v[144:147], v1 offset:8192
    s_mul_i32 s48, s60, 81920
    v_mfma_f32_16x16x32_bf16 v[104:107], v[160:163], v[140:143], v[104:107]
    ds_read_b64_tr_b16 v[184:185], v2 offset:12288
    s_add_u32 s48, s48, s30
    v_mfma_f32_16x16x32_bf16 v[36:39], v[164:167], v[128:131], v[36:39]
    ds_read_b64_tr_b16 v[186:187], v2 offset:18432
    v_mfma_f32_16x16x32_bf16 v[60:63], v[164:167], v[132:135], v[60:63]
    ds_read_b128 v[148:151], v1 offset:9216
    s_add_u32 m0, s79, 0
    v_mfma_f32_16x16x32_bf16 v[84:87], v[164:167], v[136:139], v[84:87]
    ds_read_b128 v[152:155], v1 offset:10240
    v_mfma_f32_16x16x32_bf16 v[108:111], v[164:167], v[140:143], v[108:111]
    ds_read_b128 v[156:159], v1 offset:11264
    buffer_load_dwordx4 v8, s[4:7], s48 offen sc1 lds
    v_mfma_f32_16x16x32_bf16 v[40:43], v[168:171], v[128:131], v[40:43]
    ds_read_b64_tr_b16 v[188:189], v3 offset:12288
    buffer_load_dwordx4 v8, s[4:7], s48 offen offset:1024 sc1 lds
    v_mfma_f32_16x16x32_bf16 v[64:67], v[168:171], v[132:135], v[64:67]
    ds_read_b64_tr_b16 v[190:191], v3 offset:18432
    v_mfma_f32_16x16x32_bf16 v[88:91], v[168:171], v[136:139], v[88:91]
    ds_read_b64_tr_b16 v[192:193], v4 offset:12288
    s_mul_i32 s49, s60, 36864
    v_mfma_f32_16x16x32_bf16 v[112:115], v[168:171], v[140:143], v[112:115]
    ds_read_b64_tr_b16 v[194:195], v4 offset:18432
    v_mfma_f32_16x16x32_bf16 v[44:47], v[172:175], v[128:131], v[44:47]
    ds_read_b64_tr_b16 v[196:197], v5 offset:12288
    s_add_u32 s49, s49, s31
    v_mfma_f32_16x16x32_bf16 v[68:71], v[172:175], v[132:135], v[68:71]
    ds_read_b64_tr_b16 v[198:199], v5 offset:18432
    s_add_u32 m0, s39, 0
    v_mfma_f32_16x16x32_bf16 v[92:95], v[172:175], v[136:139], v[92:95]
    ds_read_b64_tr_b16 v[200:201], v6 offset:12288
    v_mfma_f32_16x16x32_bf16 v[116:119], v[172:175], v[140:143], v[116:119]
    ds_read_b64_tr_b16 v[202:203], v6 offset:18432
    buffer_load_dwordx4 v9, s[8:11], s49 offen lds
    v_mfma_f32_16x16x32_bf16 v[48:51], v[176:179], v[128:131], v[48:51]
    ds_read_b64_tr_b16 v[204:205], v7 offset:12288
    v_mfma_f32_16x16x32_bf16 v[72:75], v[176:179], v[132:135], v[72:75]
    ds_read_b64_tr_b16 v[206:207], v7 offset:18432
    s_add_u32 m0, s39, 1024
    v_mfma_f32_16x16x32_bf16 v[96:99], v[176:179], v[136:139], v[96:99]
    buffer_load_dwordx4 v10, s[8:11], s49 offen lds
    v_mfma_f32_16x16x32_bf16 v[120:123], v[176:179], v[140:143], v[120:123]
    v_mfma_f32_16x16x32_bf16 v[52:55], v[180:183], v[128:131], v[52:55]
    s_add_u32 m0, s39, 2048
    v_mfma_f32_16x16x32_bf16 v[76:79], v[180:183], v[132:135], v[76:79]
    v_mfma_f32_16x16x32_bf16 v[100:103], v[180:183], v[136:139], v[100:103]
    buffer_load_dwordx4 v11, s[8:11], s49 offen lds
    v_mfma_f32_16x16x32_bf16 v[124:127], v[180:183], v[140:143], v[124:127]
    s_waitcnt lgkmcnt(0)
    v_mfma_f32_16x16x32_bf16 v[32:35], v[184:187], v[144:147], v[32:35]
    v_mfma_f32_16x16x32_bf16 v[56:59], v[184:187], v[148:151], v[56:59]
    s_waitcnt vmcnt(10)
    s_barrier
    v_mfma_f32_16x16x32_bf16 v[80:83], v[184:187], v[152:155], v[80:83]
    ds_read_b128 v[128:131], v1 offset:16384
    s_mul_i32 s48, s61, 81920
    v_mfma_f32_16x16x32_bf16 v[104:107], v[184:187], v[156:159], v[104:107]
    ds_read_b64_tr_b16 v[160:161], v2 offset:24576
    s_add_u32 s48, s48, s30
    v_mfma_f32_16x16x32_bf16 v[36:39], v[188:191], v[144:147], v[36:39]
    ds_read_b64_tr_b16 v[162:163], v2 offset:30720
    v_mfma_f32_16x16x32_bf16 v[60:63], v[188:191], v[148:151], v[60:63]
    ds_read_b128 v[132:135], v1 offset:17408
    s_add_u32 m0, s79, 8192
    v_mfma_f32_16x16x32_bf16 v[84:87], v[188:191], v[152:155], v[84:87]
    ds_read_b128 v[136:139], v1 offset:18432
    buffer_load_dwordx4 v8, s[4:7], s48 offen sc1 lds
    v_mfma_f32_16x16x32_bf16 v[108:111], v[188:191], v[156:159], v[108:111]
    ds_read_b128 v[140:143], v1 offset:19456
    v_mfma_f32_16x16x32_bf16 v[40:43], v[192:195], v[144:147], v[40:43]
    ds_read_b64_tr_b16 v[164:165], v3 offset:24576
    buffer_load_dwordx4 v8, s[4:7], s48 offen offset:1024 sc1 lds
    v_mfma_f32_16x16x32_bf16 v[64:67], v[192:195], v[148:151], v[64:67]
    ds_read_b64_tr_b16 v[166:167], v3 offset:30720
    s_mul_i32 s49, s61, 36864
    v_mfma_f32_16x16x32_bf16 v[88:91], v[192:195], v[152:155], v[88:91]
    ds_read_b64_tr_b16 v[168:169], v4 offset:24576
    v_mfma_f32_16x16x32_bf16 v[112:115], v[192:195], v[156:159], v[112:115]
    ds_read_b64_tr_b16 v[170:171], v4 offset:30720
    s_add_u32 s49, s49, s31
    v_mfma_f32_16x16x32_bf16 v[44:47], v[196:199], v[144:147], v[44:47]
    ds_read_b64_tr_b16 v[172:173], v5 offset:24576
    v_mfma_f32_16x16x32_bf16 v[68:71], v[196:199], v[148:151], v[68:71]
    ds_read_b64_tr_b16 v[174:175], v5 offset:30720
    s_add_u32 m0, s39, 12288
    v_mfma_f32_16x16x32_bf16 v[92:95], v[196:199], v[152:155], v[92:95]
    ds_read_b64_tr_b16 v[176:177], v6 offset:24576
    buffer_load_dwordx4 v9, s[8:11], s49 offen lds
    v_mfma_f32_16x16x32_bf16 v[116:119], v[196:199], v[156:159], v[116:119]
    ds_read_b64_tr_b16 v[178:179], v6 offset:30720
    v_mfma_f32_16x16x32_bf16 v[48:51], v[200:203], v[144:147], v[48:51]
    ds_read_b64_tr_b16 v[180:181], v7 offset:24576
    s_add_u32 m0, s39, 13312
    v_mfma_f32_16x16x32_bf16 v[72:75], v[200:203], v[148:151], v[72:75]
    ds_read_b64_tr_b16 v[182:183], v7 offset:30720
    buffer_load_dwordx4 v10, s[8:11], s49 offen lds
    v_mfma_f32_16x16x32_bf16 v[96:99], v[200:203], v[152:155], v[96:99]
    v_mfma_f32_16x16x32_bf16 v[120:123], v[200:203], v[156:159], v[120:123]
    s_add_u32 m0, s39, 14336
    v_mfma_f32_16x16x32_bf16 v[52:55], v[204:207], v[144:147], v[52:55]
    buffer_load_dwordx4 v11, s[8:11], s49 offen lds
    v_mfma_f32_16x16x32_bf16 v[76:79], v[204:207], v[148:151], v[76:79]
    v_mfma_f32_16x16x32_bf16 v[100:103], v[204:207], v[152:155], v[100:103]
    buffer_load_dword v24, v23, s[20:23], 0 offen sc1
    v_mfma_f32_16x16x32_bf16 v[124:127], v[204:207], v[156:159], v[124:127]
    s_waitcnt lgkmcnt(0)
    v_mfma_f32_16x16x32_bf16 v[32:35], v[160:163], v[128:131], v[32:35]
    v_mfma_f32_16x16x32_bf16 v[56:59], v[160:163], v[132:135], v[56:59]
    s_waitcnt vmcnt(11)
    s_barrier
    v_mfma_f32_16x16x32_bf16 v[80:83], v[160:163], v[136:139], v[80:83]
    ds_read_b128 v[144:147], v1 offset:24576
    s_mul_i32 s48, s62, 81920
    v_mfma_f32_16x16x32_bf16 v[104:107], v[160:163], v[140:143], v[104:107]
    ds_read_b64_tr_b16 v[184:185], v2 offset:36864
    s_add_u32 s48, s48, s30
    v_mfma_f32_16x16x32_bf16 v[36:39], v[164:167], v[128:131], v[36:39]
    ds_read_b64_tr_b16 v[186:187], v2 offset:43008
    v_mfma_f32_16x16x32_bf16 v[60:63], v[164:167], v[132:135], v[60:63]
    ds_read_b128 v[148:151], v1 offset:25600
    s_add_u32 m0, s79, 16384
    v_mfma_f32_16x16x32_bf16 v[84:87], v[164:167], v[136:139], v[84:87]
    ds_read_b128 v[152:155], v1 offset:26624
    v_mfma_f32_16x16x32_bf16 v[108:111], v[164:167], v[140:143], v[108:111]
    ds_read_b128 v[156:159], v1 offset:27648
    buffer_load_dwordx4 v8, s[4:7], s48 offen sc1 lds
    v_mfma_f32_16x16x32_bf16 v[40:43], v[168:171], v[128:131], v[40:43]
    ds_read_b64_tr_b16 v[188:189], v3 offset:36864
    buffer_load_dwordx4 v8, s[4:7], s48 offen offset:1024 sc1 lds
    v_mfma_f32_16x16x32_bf16 v[64:67], v[168:171], v[132:135], v[64:67]
    ds_read_b64_tr_b16 v[190:191], v3 offset:43008
    v_mfma_f32_16x16x32_bf16 v[88:91], v[168:171], v[136:139], v[88:91]
    ds_read_b64_tr_b16 v[192:193], v4 offset:36864
    s_mul_i32 s49, s62, 36864
    v_mfma_f32_16x16x32_bf16 v[112:115], v[168:171], v[140:143], v[112:115]
    ds_read_b64_tr_b16 v[194:195], v4 offset:43008
    v_mfma_f32_16x16x32_bf16 v[44:47], v[172:175], v[128:131], v[44:47]
    ds_read_b64_tr_b16 v[196:197], v5 offset:36864
    s_add_u32 s49, s49, s31
    v_mfma_f32_16x16x32_bf16 v[68:71], v[172:175], v[132:135], v[68:71]
    ds_read_b64_tr_b16 v[198:199], v5 offset:43008
    s_add_u32 m0, s39, 24576
    v_mfma_f32_16x16x32_bf16 v[92:95], v[172:175], v[136:139], v[92:95]
    ds_read_b64_tr_b16 v[200:201], v6 offset:36864
    v_mfma_f32_16x16x32_bf16 v[116:119], v[172:175], v[140:143], v[116:119]
    ds_read_b64_tr_b16 v[202:203], v6 offset:43008
    buffer_load_dwordx4 v9, s[8:11], s49 offen lds
    v_mfma_f32_16x16x32_bf16 v[48:51], v[176:179], v[128:131], v[48:51]
    ds_read_b64_tr_b16 v[204:205], v7 offset:36864
    v_mfma_f32_16x16x32_bf16 v[72:75], v[176:179], v[132:135], v[72:75]
    ds_read_b64_tr_b16 v[206:207], v7 offset:43008
    s_add_u32 m0, s39, 25600
    v_mfma_f32_16x16x32_bf16 v[96:99], v[176:179], v[136:139], v[96:99]
    buffer_load_dwordx4 v10, s[8:11], s49 offen lds
    v_mfma_f32_16x16x32_bf16 v[120:123], v[176:179], v[140:143], v[120:123]
    v_mfma_f32_16x16x32_bf16 v[52:55], v[180:183], v[128:131], v[52:55]
    s_add_u32 m0, s39, 26624
    v_mfma_f32_16x16x32_bf16 v[76:79], v[180:183], v[132:135], v[76:79]
    v_mfma_f32_16x16x32_bf16 v[100:103], v[180:183], v[136:139], v[100:103]
    buffer_load_dwordx4 v11, s[8:11], s49 offen lds
    v_mfma_f32_16x16x32_bf16 v[124:127], v[180:183], v[140:143], v[124:127]
    s_waitcnt lgkmcnt(0)
    v_mfma_f32_16x16x32_bf16 v[32:35], v[184:187], v[144:147], v[32:35]
    v_mfma_f32_16x16x32_bf16 v[56:59], v[184:187], v[148:151], v[56:59]
    s_waitcnt vmcnt(11)
    s_barrier
    v_mfma_f32_16x16x32_bf16 v[80:83], v[184:187], v[152:155], v[80:83]
    ds_read_b128 v[128:131], v1 offset:0
    s_mul_i32 s48, s63, 81920
    v_mfma_f32_16x16x32_bf16 v[104:107], v[184:187], v[156:159], v[104:107]
    ds_read_b64_tr_b16 v[160:161], v2 offset:0
    s_add_u32 s48, s48, s30
    v_mfma_f32_16x16x32_bf16 v[36:39], v[188:191], v[144:147], v[36:39]
    ds_read_b64_tr_b16 v[162:163], v2 offset:6144
    v_mfma_f32_16x16x32_bf16 v[60:63], v[188:191], v[148:151], v[60:63]
    ds_read_b128 v[132:135], v1 offset:1024
    s_add_u32 m0, s79, 24576
    v_mfma_f32_16x16x32_bf16 v[84:87], v[188:191], v[152:155], v[84:87]
    ds_read_b128 v[136:139], v1 offset:2048
    v_mfma_f32_16x16x32_bf16 v[108:111], v[188:191], v[156:159], v[108:111]
    ds_read_b128 v[140:143], v1 offset:3072
    buffer_load_dwordx4 v8, s[4:7], s48 offen sc1 lds
    v_mfma_f32_16x16x32_bf16 v[40:43], v[192:195], v[144:147], v[40:43]
    ds_read_b64_tr_b16 v[164:165], v3 offset:0
    buffer_load_dwordx4 v8, s[4:7], s48 offen offset:1024 sc1 lds
    v_mfma_f32_16x16x32_bf16 v[64:67], v[192:195], v[148:151], v[64:67]
    ds_read_b64_tr_b16 v[166:167], v3 offset:6144
    v_mfma_f32_16x16x32_bf16 v[88:91], v[192:195], v[152:155], v[88:91]
    ds_read_b64_tr_b16 v[168:169], v4 offset:0
    s_mul_i32 s49, s63, 36864
    v_mfma_f32_16x16x32_bf16 v[112:115], v[192:195], v[156:159], v[112:115]
    ds_read_b64_tr_b16 v[170:171], v4 offset:6144
    v_mfma_f32_16x16x32_bf16 v[44:47], v[196:199], v[144:147], v[44:47]
    ds_read_b64_tr_b16 v[172:173], v5 offset:0
    s_add_u32 s49, s49, s31
    v_mfma_f32_16x16x32_bf16 v[68:71], v[196:199], v[148:151], v[68:71]
    ds_read_b64_tr_b16 v[174:175], v5 offset:6144
    s_add_u32 m0, s39, 36864
    v_mfma_f32_16x16x32_bf16 v[92:95], v[196:199], v[152:155], v[92:95]
    ds_read_b64_tr_b16 v[176:177], v6 offset:0
    v_mfma_f32_16x16x32_bf16 v[116:119], v[196:199], v[156:159], v[116:119]
    ds_read_b64_tr_b16 v[178:179], v6 offset:6144
    buffer_load_dwordx4 v9, s[8:11], s49 offen lds
    v_mfma_f32_16x16x32_bf16 v[48:51], v[200:203], v[144:147], v[48:51]
    ds_read_b64_tr_b16 v[180:181], v7 offset:0
    v_mfma_f32_16x16x32_bf16 v[72:75], v[200:203], v[148:151], v[72:75]
    ds_read_b64_tr_b16 v[182:183], v7 offset:6144
    s_add_u32 m0, s39, 37888
    v_mfma_f32_16x16x32_bf16 v[96:99], v[200:203], v[152:155], v[96:99]
    buffer_load_dwordx4 v10, s[8:11], s49 offen lds
    v_mfma_f32_16x16x32_bf16 v[120:123], v[200:203], v[156:159], v[120:123]
    v_mfma_f32_16x16x32_bf16 v[52:55], v[204:207], v[144:147], v[52:55]
    s_add_u32 m0, s39, 38912
    v_mfma_f32_16x16x32_bf16 v[76:79], v[204:207], v[148:151], v[76:79]
    v_mfma_f32_16x16x32_bf16 v[100:103], v[204:207], v[152:155], v[100:103]
    buffer_load_dwordx4 v11, s[8:11], s49 offen lds
    v_mfma_f32_16x16x32_bf16 v[124:127], v[204:207], v[156:159], v[124:127]
    s_waitcnt lgkmcnt(0)
    s_cmp_lg_u32 s24, 0
    s_cbranch_scc1 L_g2_pk1_end
    s_mov_b32 s45, 0
    s_waitcnt vmcnt(10)
    s_branch L_g2_pk1_chk
L_g2_pk1_ld:
    buffer_load_dword v24, v23, s[20:23], 0 offen sc1
    s_waitcnt vmcnt(0)
L_g2_pk1_chk:
    v_cmp_eq_u32 vcc, s66, v24
    s_nop 3
    s_lshr_b32 s47, vcc_lo, 4
    s_and_b32 s46, vcc_lo, s47
    s_and_b32 s46, s46, 15
    s_andn2_b32 s46, s46, s35
    s_cmp_lg_u32 s46, 0
    s_cbranch_scc1 L_g2_pk1_got
    s_sleep 2
    s_add_u32 s45, s45, 1
    s_cmp_lt_u32 s45, 400000
    s_cbranch_scc1 L_g2_pk1_ld
    s_andn2_b32 s46, 15, s35
L_g2_pk1_got:
    s_ff1_i32_b32 s46, s46
    v_mov_b32 v25, s46
    ds_write_b32 v26, v25
    s_waitcnt lgkmcnt(0)
L_g2_pk1_end:
    s_waitcnt lgkmcnt(0)
    v_mfma_f32_16x16x32_bf16 v[32:35], v[160:163], v[128:131], v[32:35]
    v_mfma_f32_16x16x32_bf16 v[56:59], v[160:163], v[132:135], v[56:59]
    s_waitcnt vmcnt(11)
    s_barrier
    ds_read_b32 v25, v26
    s_waitcnt lgkmcnt(0)
    v_readfirstlane_b32 s37, v25
    s_nop 3
    s_lshl_b32 s46, 1, s37
    s_or_b32 s35, s35, s46
    s_mul_i32 s32, s37, 655360
    s_add_u32 s32, s32, s29
    s_mul_i32 s33, s37, 294912
    v_mfma_f32_16x16x32_bf16 v[80:83], v[160:163], v[136:139], v[80:83]
    ds_read_b128 v[144:147], v1 offset:8192
    s_mul_i32 s48, s56, 81920
    v_mfma_f32_16x16x32_bf16 v[104:107], v[160:163], v[140:143], v[104:107]
    ds_read_b64_tr_b16 v[184:185], v2 offset:12288
    s_add_u32 s48, s48, s32
    v_mfma_f32_16x16x32_bf16 v[36:39], v[164:167], v[128:131], v[36:39]
    ds_read_b64_tr_b16 v[186:187], v2 offset:18432
    v_mfma_f32_16x16x32_bf16 v[60:63], v[164:167], v[132:135], v[60:63]
    ds_read_b128 v[148:151], v1 offset:9216
    s_add_u32 m0, s79, 0
    v_mfma_f32_16x16x32_bf16 v[84:87], v[164:167], v[136:139], v[84:87]
    ds_read_b128 v[152:155], v1 offset:10240
    v_mfma_f32_16x16x32_bf16 v[108:111], v[164:167], v[140:143], v[108:111]
    ds_read_b128 v[156:159], v1 offset:11264
    buffer_load_dwordx4 v8, s[4:7], s48 offen sc1 lds
    v_mfma_f32_16x16x32_bf16 v[40:43], v[168:171], v[128:131], v[40:43]
    ds_read_b64_tr_b16 v[188:189], v3 offset:12288
    buffer_load_dwordx4 v8, s[4:7], s48 offen offset:1024 sc1 lds
    v_mfma_f32_16x16x32_bf16 v[64:67], v[168:171], v[132:135], v[64:67]
    ds_read_b64_tr_b16 v[190:191], v3 offset:18432
    v_mfma_f32_16x16x32_bf16 v[88:91], v[168:171], v[136:139], v[88:91]
    ds_read_b64_tr_b16 v[192:193], v4 offset:12288
    s_mul_i32 s49, s56, 36864
    v_mfma_f32_16x16x32_bf16 v[112:115], v[168:171], v[140:143], v[112:115]
    ds_read_b64_tr_b16 v[194:195], v4 offset:18432
    v_mfma_f32_16x16x32_bf16 v[44:47], v[172:175], v[128:131], v[44:47]
    ds_read_b64_tr_b16 v[196:197], v5 offset:12288
    s_add_u32 s49, s49, s33
    v_mfma_f32_16x16x32_bf16 v[68:71], v[172:175], v[132:135], v[68:71]
    ds_read_b64_tr_b16 v[198:199], v5 offset:18432
    s_add_u32 m0, s39, 0
    v_mfma_f32_16x16x32_bf16 v[92:95], v[172:175], v[136:139], v[92:95]
    ds_read_b64_tr_b16 v[200:201], v6 offset:12288
    v_mfma_f32_16x16x32_bf16 v[116:119], v[172:175], v[140:143], v[116:119]
    ds_read_b64_tr_b16 v[202:203], v6 offset:18432
    buffer_load_dwordx4 v9, s[8:11], s49 offen lds
    v_mfma_f32_16x16x32_bf16 v[48:51], v[176:179], v[128:131], v[48:51]
    ds_read_b64_tr_b16 v[204:205], v7 offset:12288
    v_mfma_f32_16x16x32_bf16 v[72:75], v[176:179], v[132:135], v[72:75]
    ds_read_b64_tr_b16 v[206:207], v7 offset:18432
    s_add_u32 m0, s39, 1024
    v_mfma_f32_16x16x32_bf16 v[96:99], v[176:179], v[136:139], v[96:99]
    buffer_load_dwordx4 v10, s[8:11], s49 offen lds
    v_mfma_f32_16x16x32_bf16 v[120:123], v[176:179], v[140:143], v[120:123]
    v_mfma_f32_16x16x32_bf16 v[52:55], v[180:183], v[128:131], v[52:55]
    s_add_u32 m0, s39, 2048
    v_mfma_f32_16x16x32_bf16 v[76:79], v[180:183], v[132:135], v[76:79]
    v_mfma_f32_16x16x32_bf16 v[100:103], v[180:183], v[136:139], v[100:103]
    buffer_load_dwordx4 v11, s[8:11], s49 offen lds
    v_mfma_f32_16x16x32_bf16 v[124:127], v[180:183], v[140:143], v[124:127]
    s_waitcnt lgkmcnt(0)
    v_mfma_f32_16x16x32_bf16 v[32:35], v[184:187], v[144:147], v[32:35]
    v_mfma_f32_16x16x32_bf16 v[56:59], v[184:187], v[148:151], v[56:59]
    s_waitcnt vmcnt(10)
    s_barrier
    v_mfma_f32_16x16x32_bf16 v[80:83], v[184:187], v[152:155], v[80:83]
    ds_read_b128 v[128:131], v1 offset:16384
    s_mul_i32 s48, s57, 81920
    v_mfma_f32_16x16x32_bf16 v[104:107], v[184:187], v[156:159], v[104:107]
    ds_read_b64_tr_b16 v[160:161], v2 offset:24576
    s_add_u32 s48, s48, s32
    v_mfma_f32_16x16x32_bf16 v[36:39], v[188:191], v[144:147], v[36:39]
    ds_read_b64_tr_b16 v[162:163], v2 offset:30720
    v_mfma_f32_16x16x32_bf16 v[60:63], v[188:191], v[148:151], v[60:63]
    ds_read_b128 v[132:135], v1 offset:17408
    s_add_u32 m0, s79, 8192
    v_mfma_f32_16x16x32_bf16 v[84:87], v[188:191], v[152:155], v[84:87]
    ds_read_b128 v[136:139], v1 offset:18432
    v_mfma_f32_16x16x32_bf16 v[108:111], v[188:191], v[156:159], v[108:111]
    ds_read_b128 v[140:143], v1 offset:19456
    buffer_load_dwordx4 v8, s[4:7], s48 offen sc1 lds
    v_mfma_f32_16x16x32_bf16 v[40:43], v[192:195], v[144:147], v[40:43]
    ds_read_b64_tr_b16 v[164:165], v3 offset:24576
    buffer_load_dwordx4 v8, s[4:7], s48 offen offset:1024 sc1 lds
    v_mfma_f32_16x16x32_bf16 v[64:67], v[192:195], v[148:151], v[64:67]
    ds_read_b64_tr_b16 v[166:167], v3 offset:30720
    v_mfma_f32_16x16x32_bf16 v[88:91], v[192:195], v[152:155], v[88:91]
    ds_read_b64_tr_b16 v[168:169], v4 offset:24576
    s_mul_i32 s49, s57, 36864
    v_mfma_f32_16x16x32_bf16 v[112:115], v[192:195], v[156:159], v[112:115]
    ds_read_b64_tr_b16 v[170:171], v4 offset:30720
    v_mfma_f32_16x16x32_bf16 v[44:47], v[196:199], v[144:147], v[44:47]
    ds_read_b64_tr_b16 v[172:173], v5 offset:24576
    s_add_u32 s49, s49, s33
    v_mfma_f32_16x16x32_bf16 v[68:71], v[196:199], v[148:151], v[68:71]
    ds_read_b64_tr_b16 v[174:175], v5 offset:30720
    s_add_u32 m0, s39, 12288
    v_mfma_f32_16x16x32_bf16 v[92:95], v[196:199], v[152:155], v[92:95]
    ds_read_b64_tr_b16 v[176:177], v6 offset:24576
    v_mfma_f32_16x16x32_bf16 v[116:119], v[196:199], v[156:159], v[116:119]
    ds_read_b64_tr_b16 v[178:179], v6 offset:30720
    buffer_load_dwordx4 v9, s[8:11], s49 offen lds
    v_mfma_f32_16x16x32_bf16 v[48:51], v[200:203], v[144:147], v[48:51]
    ds_read_b64_tr_b16 v[180:181], v7 offset:24576
    v_mfma_f32_16x16x32_bf16 v[72:75], v[200:203], v[148:151], v[72:75]
    ds_read_b64_tr_b16 v[182:183], v7 offset:30720
    s_add_u32 m0, s39, 13312
    v_mfma_f32_16x16x32_bf16 v[96:99], v[200:203], v[152:155], v[96:99]
    buffer_load_dwordx4 v10, s[8:11], s49 offen lds
    v_mfma_f32_16x16x32_bf16 v[120:123], v[200:203], v[156:159], v[120:123]
    v_mfma_f32_16x16x32_bf16 v[52:55], v[204:207], v[144:147], v[52:55]
    s_add_u32 m0, s39, 14336
    v_mfma_f32_16x16x32_bf16 v[76:79], v[204:207], v[148:151], v[76:79]
    v_mfma_f32_16x16x32_bf16 v[100:103], v[204:207], v[152:155], v[100:103]
    buffer_load_dwordx4 v11, s[8:11], s49 offen lds
    v_mfma_f32_16x16x32_bf16 v[124:127], v[204:207], v[156:159], v[124:127]
    s_waitcnt lgkmcnt(0)
    v_mfma_f32_16x16x32_bf16 v[32:35], v[160:163], v[128:131], v[32:35]
    v_mfma_f32_16x16x32_bf16 v[56:59], v[160:163], v[132:135], v[56:59]
    s_waitcnt vmcnt(10)
    s_barrier
    v_mfma_f32_16x16x32_bf16 v[80:83], v[160:163], v[136:139], v[80:83]
    ds_read_b128 v[144:147], v1 offset:24576
    s_mul_i32 s48, s58, 81920
    v_mfma_f32_16x16x32_bf16 v[104:107], v[160:163], v[140:143], v[104:107]
    ds_read_b64_tr_b16 v[184:185], v2 offset:36864
    s_add_u32 s48, s48, s32
    v_mfma_f32_16x16x32_bf16 v[36:39], v[164:167], v[128:131], v[36:39]
    ds_read_b64_tr_b16 v[186:187], v2 offset:43008
    v_mfma_f32_16x16x32_bf16 v[60:63], v[164:167], v[132:135], v[60:63]
    ds_read_b128 v[148:151], v1 offset:25600
    s_add_u32 m0, s79, 16384
    v_mfma_f32_16x16x32_bf16 v[84:87], v[164:167], v[136:139], v[84:87]
    ds_read_b128 v[152:155], v1 offset:26624
    v_mfma_f32_16x16x32_bf16 v[108:111], v[164:167], v[140:143], v[108:111]
    ds_read_b128 v[156:159], v1 offset:27648
    buffer_load_dwordx4 v8, s[4:7], s48 offen sc1 lds
    v_mfma_f32_16x16x32_bf16 v[40:43], v[168:171], v[128:131], v[40:43]
    ds_read_b64_tr_b16 v[188:189], v3 offset:36864
    buffer_load_dwordx4 v8, s[4:7], s48 offen offset:1024 sc1 lds
    v_mfma_f32_16x16x32_bf16 v[64:67], v[168:171], v[132:135], v[64:67]
    ds_read_b64_tr_b16 v[190:191], v3 offset:43008
    v_mfma_f32_16x16x32_bf16 v[88:91], v[168:171], v[136:139], v[88:91]
    ds_read_b64_tr_b16 v[192:193], v4 offset:36864
    s_mul_i32 s49, s58, 36864
    v_mfma_f32_16x16x32_bf16 v[112:115], v[168:171], v[140:143], v[112:115]
    ds_read_b64_tr_b16 v[194:195], v4 offset:43008
    v_mfma_f32_16x16x32_bf16 v[44:47], v[172:175], v[128:131], v[44:47]
    ds_read_b64_tr_b16 v[196:197], v5 offset:36864
    s_add_u32 s49, s49, s33
    v_mfma_f32_16x16x32_bf16 v[68:71], v[172:175], v[132:135], v[68:71]
    ds_read_b64_tr_b16 v[198:199], v5 offset:43008
    s_add_u32 m0, s39, 24576
    v_mfma_f32_16x16x32_bf16 v[92:95], v[172:175], v[136:139], v[92:95]
    ds_read_b64_tr_b16 v[200:201], v6 offset:36864
    v_mfma_f32_16x16x32_bf16 v[116:119], v[172:175], v[140:143], v[116:119]
    ds_read_b64_tr_b16 v[202:203], v6 offset:43008
    buffer_load_dwordx4 v9, s[8:11], s49 offen lds
    v_mfma_f32_16x16x32_bf16 v[48:51], v[176:179], v[128:131], v[48:51]
    ds_read_b64_tr_b16 v[204:205], v7 offset:36864
    v_mfma_f32_16x16x32_bf16 v[72:75], v[176:179], v[132:135], v[72:75]
    ds_read_b64_tr_b16 v[206:207], v7 offset:43008
    s_add_u32 m0, s39, 25600
    v_mfma_f32_16x16x32_bf16 v[96:99], v[176:179], v[136:139], v[96:99]
    buffer_load_dwordx4 v10, s[8:11], s49 offen lds
    v_mfma_f32_16x16x32_bf16 v[120:123], v[176:179], v[140:143], v[120:123]
    v_mfma_f32_16x16x32_bf16 v[52:55], v[180:183], v[128:131], v[52:55]
    s_add_u32 m0, s39, 26624
    v_mfma_f32_16x16x32_bf16 v[76:79], v[180:183], v[132:135], v[76:79]
    v_mfma_f32_16x16x32_bf16 v[100:103], v[180:183], v[136:139], v[100:103]
    buffer_load_dwordx4 v11, s[8:11], s49 offen lds
    v_mfma_f32_16x16x32_bf16 v[124:127], v[180:183], v[140:143], v[124:127]
    s_waitcnt lgkmcnt(0)
    v_mfma_f32_16x16x32_bf16 v[32:35], v[184:187], v[144:147], v[32:35]
    v_mfma_f32_16x16x32_bf16 v[56:59], v[184:187], v[148:151], v[56:59]
    s_waitcnt vmcnt(10)
    s_barrier
    v_mfma_f32_16x16x32_bf16 v[80:83], v[184:187], v[152:155], v[80:83]
    ds_read_b128 v[128:131], v1 offset:0
    s_mul_i32 s48, s59, 81920
    v_mfma_f32_16x16x32_bf16 v[104:107], v[184:187], v[156:159], v[104:107]
    ds_read_b64_tr_b16 v[160:161], v2 offset:0
    s_add_u32 s48, s48, s32
    v_mfma_f32_16x16x32_bf16 v[36:39], v[188:191], v[144:147], v[36:39]
    ds_read_b64_tr_b16 v[162:163], v2 offset:6144
    v_mfma_f32_16x16x32_bf16 v[60:63], v[188:191], v[148:151], v[60:63]
    ds_read_b128 v[132:135], v1 offset:1024
    s_add_u32 m0, s79, 24576
    v_mfma_f32_16x16x32_bf16 v[84:87], v[188:191], v[152:155], v[84:87]
    ds_read_b128 v[136:139], v1 offset:2048
    v_mfma_f32_16x16x32_bf16 v[108:111], v[188:191], v[156:159], v[108:111]
    ds_read_b128 v[140:143], v1 offset:3072
    buffer_load_dwordx4 v8, s[4:7], s48 offen sc1 lds
    v_mfma_f32_16x16x32_bf16 v[40:43], v[192:195], v[144:147], v[40:43]
    ds_read_b64_tr_b16 v[164:165], v3 offset:0
    buffer_load_dwordx4 v8, s[4:7], s48 offen offset:1024 sc1 lds
    v_mfma_f32_16x16x32_bf16 v[64:67], v[192:195], v[148:151], v[64:67]
    ds_read_b64_tr_b16 v[166:167], v3 offset:6144
    v_mfma_f32_16x16x32_bf16 v[88:91], v[192:195], v[152:155], v[88:91]
    ds_read_b64_tr_b16 v[168:169], v4 offset:0
    s_mul_i32 s49, s59, 36864
    v_mfma_f32_16x16x32_bf16 v[112:115], v[192:195], v[156:159], v[112:115]
    ds_read_b64_tr_b16 v[170:171], v4 offset:6144
    v_mfma_f32_16x16x32_bf16 v[44:47], v[196:199], v[144:147], v[44:47]
    ds_read_b64_tr_b16 v[172:173], v5 offset:0
    s_add_u32 s49, s49, s33
    v_mfma_f32_16x16x32_bf16 v[68:71], v[196:199], v[148:151], v[68:71]
    ds_read_b64_tr_b16 v[174:175], v5 offset:6144
    s_add_u32 m0, s39, 36864
    v_mfma_f32_16x16x32_bf16 v[92:95], v[196:199], v[152:155], v[92:95]
    ds_read_b64_tr_b16 v[176:177], v6 offset:0
    v_mfma_f32_16x16x32_bf16 v[116:119], v[196:199], v[156:159], v[116:119]
    ds_read_b64_tr_b16 v[178:179], v6 offset:6144
    buffer_load_dwordx4 v9, s[8:11], s49 offen lds
    v_mfma_f32_16x16x32_bf16 v[48:51], v[200:203], v[144:147], v[48:51]
    ds_read_b64_tr_b16 v[180:181], v7 offset:0
    v_mfma_f32_16x16x32_bf16 v[72:75], v[200:203], v[148:151], v[72:75]
    ds_read_b64_tr_b16 v[182:183], v7 offset:6144
    s_add_u32 m0, s39, 37888
    v_mfma_f32_16x16x32_bf16 v[96:99], v[200:203], v[152:155], v[96:99]
    buffer_load_dwordx4 v10, s[8:11], s49 offen lds
    v_mfma_f32_16x16x32_bf16 v[120:123], v[200:203], v[156:159], v[120:123]
    v_mfma_f32_16x16x32_bf16 v[52:55], v[204:207], v[144:147], v[52:55]
    s_add_u32 m0, s39, 38912
    v_mfma_f32_16x16x32_bf16 v[76:79], v[204:207], v[148:151], v[76:79]
    v_mfma_f32_16x16x32_bf16 v[100:103], v[204:207], v[152:155], v[100:103]
    buffer_load_dwordx4 v11, s[8:11], s49 offen lds
    v_mfma_f32_16x16x32_bf16 v[124:127], v[204:207], v[156:159], v[124:127]
    s_waitcnt lgkmcnt(0)
    s_mov_b32 s30, s32
    s_mov_b32 s31, s33
    s_add_u32 s50, s50, 1
    s_cmp_lt_u32 s50, 3
    s_cbranch_scc1 L_g2_seg
    s_waitcnt lgkmcnt(0)
    v_mfma_f32_16x16x32_bf16 v[32:35], v[160:163], v[128:131], v[32:35]
    v_mfma_f32_16x16x32_bf16 v[56:59], v[160:163], v[132:135], v[56:59]
    s_waitcnt vmcnt(10)
    s_barrier
    v_mfma_f32_16x16x32_bf16 v[80:83], v[160:163], v[136:139], v[80:83]
    ds_read_b128 v[144:147], v1 offset:8192
    s_mul_i32 s48, s60, 81920
    v_mfma_f32_16x16x32_bf16 v[104:107], v[160:163], v[140:143], v[104:107]
    ds_read_b64_tr_b16 v[184:185], v2 offset:12288
    s_add_u32 s48, s48, s30
    v_mfma_f32_16x16x32_bf16 v[36:39], v[164:167], v[128:131], v[36:39]
    ds_read_b64_tr_b16 v[186:187], v2 offset:18432
    v_mfma_f32_16x16x32_bf16 v[60:63], v[164:167], v[132:135], v[60:63]
    ds_read_b128 v[148:151], v1 offset:9216
    s_add_u32 m0, s79, 0
    v_mfma_f32_16x16x32_bf16 v[84:87], v[164:167], v[136:139], v[84:87]
    ds_read_b128 v[152:155], v1 offset:10240
    v_mfma_f32_16x16x32_bf16 v[108:111], v[164:167], v[140:143], v[108:111]
    ds_read_b128 v[156:159], v1 offset:11264
    buffer_load_dwordx4 v8, s[4:7], s48 offen sc1 lds
    v_mfma_f32_16x16x32_bf16 v[40:43], v[168:171], v[128:131], v[40:43]
    ds_read_b64_tr_b16 v[188:189], v3 offset:12288
    buffer_load_dwordx4 v8, s[4:7], s48 offen offset:1024 sc1 lds
    v_mfma_f32_16x16x32_bf16 v[64:67], v[168:171], v[132:135], v[64:67]
    ds_read_b64_tr_b16 v[190:191], v3 offset:18432
    v_mfma_f32_16x16x32_bf16 v[88:91], v[168:171], v[136:139], v[88:91]
    ds_read_b64_tr_b16 v[192:193], v4 offset:12288
    s_mul_i32 s49, s60, 36864
    v_mfma_f32_16x16x32_bf16 v[112:115], v[168:171], v[140:143], v[112:115]
    ds_read_b64_tr_b16 v[194:195], v4 offset:18432
    v_mfma_f32_16x16x32_bf16 v[44:47], v[172:175], v[128:131], v[44:47]
    ds_read_b64_tr_b16 v[196:197], v5 offset:12288
    s_add_u32 s49, s49, s31
    v_mfma_f32_16x16x32_bf16 v[68:71], v[172:175], v[132:135], v[68:71]
    ds_read_b64_tr_b16 v[198:199], v5 offset:18432
    s_add_u32 m0, s39, 0
    v_mfma_f32_16x16x32_bf16 v[92:95], v[172:175], v[136:139], v[92:95]
    ds_read_b64_tr_b16 v[200:201], v6 offset:12288
    v_mfma_f32_16x16x32_bf16 v[116:119], v[172:175], v[140:143], v[116:119]
    ds_read_b64_tr_b16 v[202:203], v6 offset:18432
    buffer_load_dwordx4 v9, s[8:11], s49 offen lds
    v_mfma_f32_16x16x32_bf16 v[48:51], v[176:179], v[128:131], v[48:51]
    ds_read_b64_tr_b16 v[204:205], v7 offset:12288
    v_mfma_f32_16x16x32_bf16 v[72:75], v[176:179], v[132:135], v[72:75]
    ds_read_b64_tr_b16 v[206:207], v7 offset:18432
    s_add_u32 m0, s39, 1024
    v_mfma_f32_16x16x32_bf16 v[96:99], v[176:179], v[136:139], v[96:99]
    buffer_load_dwordx4 v10, s[8:11], s49 offen lds
    v_mfma_f32_16x16x32_bf16 v[120:123], v[176:179], v[140:143], v[120:123]
    v_mfma_f32_16x16x32_bf16 v[52:55], v[180:183], v[128:131], v[52:55]
    s_add_u32 m0, s39, 2048
    v_mfma_f32_16x16x32_bf16 v[76:79], v[180:183], v[132:135], v[76:79]
    v_mfma_f32_16x16x32_bf16 v[100:103], v[180:183], v[136:139], v[100:103]
    buffer_load_dwordx4 v11, s[8:11], s49 offen lds
    v_mfma_f32_16x16x32_bf16 v[124:127], v[180:183], v[140:143], v[124:127]
    s_waitcnt lgkmcnt(0)
    v_mfma_f32_16x16x32_bf16 v[32:35], v[184:187], v[144:147], v[32:35]
    v_mfma_f32_16x16x32_bf16 v[56:59], v[184:187], v[148:151], v[56:59]
    s_waitcnt vmcnt(10)
    s_barrier
    v_mfma_f32_16x16x32_bf16 v[80:83], v[184:187], v[152:155], v[80:83]
    ds_read_b128 v[128:131], v1 offset:16384
    s_mul_i32 s48, s61, 81920
    v_mfma_f32_16x16x32_bf16 v[104:107], v[184:187], v[156:159], v[104:107]
    ds_read_b64_tr_b16 v[160:161], v2 offset:24576
    s_add_u32 s48, s48, s30
    v_mfma_f32_16x16x32_bf16 v[36:39], v[188:191], v[144:147], v[36:39]
    ds_read_b64_tr_b16 v[162:163], v2 offset:30720
    v_mfma_f32_16x16x32_bf16 v[60:63], v[188:191], v[148:151], v[60:63]
    ds_read_b128 v[132:135], v1 offset:17408
    s_add_u32 m0, s79, 8192
    v_mfma_f32_16x16x32_bf16 v[84:87], v[188:191], v[152:155], v[84:87]
    ds_read_b128 v[136:139], v1 offset:18432
    v_mfma_f32_16x16x32_bf16 v[108:111], v[188:191], v[156:159], v[108:111]
    ds_read_b128 v[140:143], v1 offset:19456
    buffer_load_dwordx4 v8, s[4:7], s48 offen sc1 lds
    v_mfma_f32_16x16x32_bf16 v[40:43], v[192:195], v[144:147], v[40:43]
    ds_read_b64_tr_b16 v[164:165], v3 offset:24576
    buffer_load_dwordx4 v8, s[4:7], s48 offen offset:1024 sc1 lds
    v_mfma_f32_16x16x32_bf16 v[64:67], v[192:195], v[148:151], v[64:67]
    ds_read_b64_tr_b16 v[166:167], v3 offset:30720
    v_mfma_f32_16x16x32_bf16 v[88:91], v[192:195], v[152:155], v[88:91]
    ds_read_b64_tr_b16 v[168:169], v4 offset:24576
    s_mul_i32 s49, s61, 36864
    v_mfma_f32_16x16x32_bf16 v[112:115], v[192:195], v[156:159], v[112:115]
    ds_read_b64_tr_b16 v[170:171], v4 offset:30720
    v_mfma_f32_16x16x32_bf16 v[44:47], v[196:199], v[144:147], v[44:47]
    ds_read_b64_tr_b16 v[172:173], v5 offset:24576
    s_add_u32 s49, s49, s31
    v_mfma_f32_16x16x32_bf16 v[68:71], v[196:199], v[148:151], v[68:71]
    ds_read_b64_tr_b16 v[174:175], v5 offset:30720
    s_add_u32 m0, s39, 12288
    v_mfma_f32_16x16x32_bf16 v[92:95], v[196:199], v[152:155], v[92:95]
    ds_read_b64_tr_b16 v[176:177], v6 offset:24576
    v_mfma_f32_16x16x32_bf16 v[116:119], v[196:199], v[156:159], v[116:119]
    ds_read_b64_tr_b16 v[178:179], v6 offset:30720
    buffer_load_dwordx4 v9, s[8:11], s49 offen lds
    v_mfma_f32_16x16x32_bf16 v[48:51], v[200:203], v[144:147], v[48:51]
    ds_read_b64_tr_b16 v[180:181], v7 offset:24576
    v_mfma_f32_16x16x32_bf16 v[72:75], v[200:203], v[148:151], v[72:75]
    ds_read_b64_tr_b16 v[182:183], v7 offset:30720
    s_add_u32 m0, s39, 13312
    v_mfma_f32_16x16x32_bf16 v[96:99], v[200:203], v[152:155], v[96:99]
    buffer_load_dwordx4 v10, s[8:11], s49 offen lds
    v_mfma_f32_16x16x32_bf16 v[120:123], v[200:203], v[156:159], v[120:123]
    v_mfma_f32_16x16x32_bf16 v[52:55], v[204:207], v[144:147], v[52:55]
    s_add_u32 m0, s39, 14336
    v_mfma_f32_16x16x32_bf16 v[76:79], v[204:207], v[148:151], v[76:79]
    v_mfma_f32_16x16x32_bf16 v[100:103], v[204:207], v[152:155], v[100:103]
    buffer_load_dwordx4 v11, s[8:11], s49 offen lds
    v_mfma_f32_16x16x32_bf16 v[124:127], v[204:207], v[156:159], v[124:127]
    s_waitcnt lgkmcnt(0)
    v_mfma_f32_16x16x32_bf16 v[32:35], v[160:163], v[128:131], v[32:35]
    v_mfma_f32_16x16x32_bf16 v[56:59], v[160:163], v[132:135], v[56:59]
    s_waitcnt vmcnt(10)
    s_barrier
    v_mfma_f32_16x16x32_bf16 v[80:83], v[160:163], v[136:139], v[80:83]
    ds_read_b128 v[144:147], v1 offset:24576
    s_mul_i32 s48, s62, 81920
    v_mfma_f32_16x16x32_bf16 v[104:107], v[160:163], v[140:143], v[104:107]
    ds_read_b64_tr_b16 v[184:185], v2 offset:36864
    s_add_u32 s48, s48, s30
    v_mfma_f32_16x16x32_bf16 v[36:39], v[164:167], v[128:131], v[36:39]
    ds_read_b64_tr_b16 v[186:187], v2 offset:43008
    v_mfma_f32_16x16x32_bf16 v[60:63], v[164:167], v[132:135], v[60:63]
    ds_read_b128 v[148:151], v1 offset:25600
    s_add_u32 m0, s79, 16384
    v_mfma_f32_16x16x32_bf16 v[84:87], v[164:167], v[136:139], v[84:87]
    ds_read_b128 v[152:155], v1 offset:26624
    v_mfma_f32_16x16x32_bf16 v[108:111], v[164:167], v[140:143], v[108:111]
    ds_read_b128 v[156:159], v1 offset:27648
    buffer_load_dwordx4 v8, s[4:7], s48 offen sc1 lds
    v_mfma_f32_16x16x32_bf16 v[40:43], v[168:171], v[128:131], v[40:43]
    ds_read_b64_tr_b16 v[188:189], v3 offset:36864
    buffer_load_dwordx4 v8, s[4:7], s48 offen offset:1024 sc1 lds
    v_mfma_f32_16x16x32_bf16 v[64:67], v[168:171], v[132:135], v[64:67]
    ds_read_b64_tr_b16 v[190:191], v3 offset:43008
    v_mfma_f32_16x16x32_bf16 v[88:91], v[168:171], v[136:139], v[88:91]
    ds_read_b64_tr_b16 v[192:193], v4 offset:36864
    s_mul_i32 s49, s62, 36864
    v_mfma_f32_16x16x32_bf16 v[112:115], v[168:171], v[140:143], v[112:115]
    ds_read_b64_tr_b16 v[194:195], v4 offset:43008
    v_mfma_f32_16x16x32_bf16 v[44:47], v[172:175], v[128:131], v[44:47]
    ds_read_b64_tr_b16 v[196:197], v5 offset:36864
    s_add_u32 s49, s49, s31
    v_mfma_f32_16x16x32_bf16 v[68:71], v[172:175], v[132:135], v[68:71]
    ds_read_b64_tr_b16 v[198:199], v5 offset:43008
    s_add_u32 m0, s39, 24576
    v_mfma_f32_16x16x32_bf16 v[92:95], v[172:175], v[136:139], v[92:95]
    ds_read_b64_tr_b16 v[200:201], v6 offset:36864
    v_mfma_f32_16x16x32_bf16 v[116:119], v[172:175], v[140:143], v[116:119]
    ds_read_b64_tr_b16 v[202:203], v6 offset:43008
    buffer_load_dwordx4 v9, s[8:11], s49 offen lds
    v_mfma_f32_16x16x32_bf16 v[48:51], v[176:179], v[128:131], v[48:51]
    ds_read_b64_tr_b16 v[204:205], v7 offset:36864
    v_mfma_f32_16x16x32_bf16 v[72:75], v[176:179], v[132:135], v[72:75]
    ds_read_b64_tr_b16 v[206:207], v7 offset:43008
    s_add_u32 m0, s39, 25600
    v_mfma_f32_16x16x32_bf16 v[96:99], v[176:179], v[136:139], v[96:99]
    buffer_load_dwordx4 v10, s[8:11], s49 offen lds
    v_mfma_f32_16x16x32_bf16 v[120:123], v[176:179], v[140:143], v[120:123]
    v_mfma_f32_16x16x32_bf16 v[52:55], v[180:183], v[128:131], v[52:55]
    s_add_u32 m0, s39, 26624
    v_mfma_f32_16x16x32_bf16 v[76:79], v[180:183], v[132:135], v[76:79]
    v_mfma_f32_16x16x32_bf16 v[100:103], v[180:183], v[136:139], v[100:103]
    buffer_load_dwordx4 v11, s[8:11], s49 offen lds
    v_mfma_f32_16x16x32_bf16 v[124:127], v[180:183], v[140:143], v[124:127]
    s_waitcnt lgkmcnt(0)
    v_mfma_f32_16x16x32_bf16 v[32:35], v[184:187], v[144:147], v[32:35]
    v_mfma_f32_16x16x32_bf16 v[56:59], v[184:187], v[148:151], v[56:59]
    s_waitcnt vmcnt(10)
    s_barrier
    v_mfma_f32_16x16x32_bf16 v[80:83], v[184:187], v[152:155], v[80:83]
    ds_read_b128 v[128:131], v1 offset:0
    s_mul_i32 s48, s63, 81920
    v_mfma_f32_16x16x32_bf16 v[104:107], v[184:187], v[156:159], v[104:107]
    ds_read_b64_tr_b16 v[160:161], v2 offset:0
    s_add_u32 s48, s48, s30
    v_mfma_f32_16x16x32_bf16 v[36:39], v[188:191], v[144:147], v[36:39]
    ds_read_b64_tr_b16 v[162:163], v2 offset:6144
    v_mfma_f32_16x16x32_bf16 v[60:63], v[188:191], v[148:151], v[60:63]
    ds_read_b128 v[132:135], v1 offset:1024
    s_add_u32 m0, s79, 24576
    v_mfma_f32_16x16x32_bf16 v[84:87], v[188:191], v[152:155], v[84:87]
    ds_read_b128 v[136:139], v1 offset:2048
    v_mfma_f32_16x16x32_bf16 v[108:111], v[188:191], v[156:159], v[108:111]
    ds_read_b128 v[140:143], v1 offset:3072
    buffer_load_dwordx4 v8, s[4:7], s48 offen sc1 lds
    v_mfma_f32_16x16x32_bf16 v[40:43], v[192:195], v[144:147], v[40:43]
    ds_read_b64_tr_b16 v[164:165], v3 offset:0
    buffer_load_dwordx4 v8, s[4:7], s48 offen offset:1024 sc1 lds
    v_mfma_f32_16x16x32_bf16 v[64:67], v[192:195], v[148:151], v[64:67]
    ds_read_b64_tr_b16 v[166:167], v3 offset:6144
    v_mfma_f32_16x16x32_bf16 v[88:91], v[192:195], v[152:155], v[88:91]
    ds_read_b64_tr_b16 v[168:169], v4 offset:0
    s_mul_i32 s49, s63, 36864
    v_mfma_f32_16x16x32_bf16 v[112:115], v[192:195], v[156:159], v[112:115]
    ds_read_b64_tr_b16 v[170:171], v4 offset:6144
    v_mfma_f32_16x16x32_bf16 v[44:47], v[196:199], v[144:147], v[44:47]
    ds_read_b64_tr_b16 v[172:173], v5 offset:0
    s_add_u32 s49, s49, s31
    v_mfma_f32_16x16x32_bf16 v[68:71], v[196:199], v[148:151], v[68:71]
    ds_read_b64_tr_b16 v[174:175], v5 offset:6144
    s_add_u32 m0, s39, 36864
    v_mfma_f32_16x16x32_bf16 v[92:95], v[196:199], v[152:155], v[92:95]
    ds_read_b64_tr_b16 v[176:177], v6 offset:0
    v_mfma_f32_16x16x32_bf16 v[116:119], v[196:199], v[156:159], v[116:119]
    ds_read_b64_tr_b16 v[178:179], v6 offset:6144
    buffer_load_dwordx4 v9, s[8:11], s49 offen lds
    v_mfma_f32_16x16x32_bf16 v[48:51], v[200:203], v[144:147], v[48:51]
    ds_read_b64_tr_b16 v[180:181], v7 offset:0
    v_mfma_f32_16x16x32_bf16 v[72:75], v[200:203], v[148:151], v[72:75]
    ds_read_b64_tr_b16 v[182:183], v7 offset:6144
    s_add_u32 m0, s39, 37888
    v_mfma_f32_16x16x32_bf16 v[96:99], v[200:203], v[152:155], v[96:99]
    buffer_load_dwordx4 v10, s[8:11], s49 offen lds
    v_mfma_f32_16x16x32_bf16 v[120:123], v[200:203], v[156:159], v[120:123]
    v_mfma_f32_16x16x32_bf16 v[52:55], v[204:207], v[144:147], v[52:55]
    s_add_u32 m0, s39, 38912
    v_mfma_f32_16x16x32_bf16 v[76:79], v[204:207], v[148:151], v[76:79]
    v_mfma_f32_16x16x32_bf16 v[100:103], v[204:207], v[152:155], v[100:103]
    buffer_load_dwordx4 v11, s[8:11], s49 offen lds
    v_mfma_f32_16x16x32_bf16 v[124:127], v[204:207], v[156:159], v[124:127]
    s_waitcnt lgkmcnt(0)
    v_mfma_f32_16x16x32_bf16 v[32:35], v[160:163], v[128:131], v[32:35]
    v_mfma_f32_16x16x32_bf16 v[56:59], v[160:163], v[132:135], v[56:59]
    s_waitcnt vmcnt(10)
    s_barrier
    v_mfma_f32_16x16x32_bf16 v[80:83], v[160:163], v[136:139], v[80:83]
    ds_read_b128 v[144:147], v1 offset:8192
    v_mfma_f32_16x16x32_bf16 v[104:107], v[160:163], v[140:143], v[104:107]
    ds_read_b64_tr_b16 v[184:185], v2 offset:12288
    v_mfma_f32_16x16x32_bf16 v[36:39], v[164:167], v[128:131], v[36:39]
    ds_read_b64_tr_b16 v[186:187], v2 offset:18432
    v_mfma_f32_16x16x32_bf16 v[60:63], v[164:167], v[132:135], v[60:63]
    ds_read_b128 v[148:151], v1 offset:9216
    v_mfma_f32_16x16x32_bf16 v[84:87], v[164:167], v[136:139], v[84:87]
    ds_read_b128 v[152:155], v1 offset:10240
    v_mfma_f32_16x16x32_bf16 v[108:111], v[164:167], v[140:143], v[108:111]
    ds_read_b128 v[156:159], v1 offset:11264
    v_mfma_f32_16x16x32_bf16 v[40:43], v[168:171], v[128:131], v[40:43]
    ds_read_b64_tr_b16 v[188:189], v3 offset:12288
    v_mfma_f32_16x16x32_bf16 v[64:67], v[168:171], v[132:135], v[64:67]
    ds_read_b64_tr_b16 v[190:191], v3 offset:18432
    v_mfma_f32_16x16x32_bf16 v[88:91], v[168:171], v[136:139], v[88:91]
    ds_read_b64_tr_b16 v[192:193], v4 offset:12288
    v_mfma_f32_16x16x32_bf16 v[112:115], v[168:171], v[140:143], v[112:115]
    ds_read_b64_tr_b16 v[194:195], v4 offset:18432
    v_mfma_f32_16x16x32_bf16 v[44:47], v[172:175], v[128:131], v[44:47]
    ds_read_b64_tr_b16 v[196:197], v5 offset:12288
    v_mfma_f32_16x16x32_bf16 v[68:71], v[172:175], v[132:135], v[68:71]
    ds_read_b64_tr_b16 v[198:199], v5 offset:18432
    v_mfma_f32_16x16x32_bf16 v[92:95], v[172:175], v[136:139], v[92:95]
    ds_read_b64_tr_b16 v[200:201], v6 offset:12288
    v_mfma_f32_16x16x32_bf16 v[116:119], v[172:175], v[140:143], v[116:119]
    ds_read_b64_tr_b16 v[202:203], v6 offset:18432
    v_mfma_f32_16x16x32_bf16 v[48:51], v[176:179], v[128:131], v[48:51]
    ds_read_b64_tr_b16 v[204:205], v7 offset:12288
    v_mfma_f32_16x16x32_bf16 v[72:75], v[176:179], v[132:135], v[72:75]
    ds_read_b64_tr_b16 v[206:207], v7 offset:18432
    v_mfma_f32_16x16x32_bf16 v[96:99], v[176:179], v[136:139], v[96:99]
    v_mfma_f32_16x16x32_bf16 v[120:123], v[176:179], v[140:143], v[120:123]
    v_mfma_f32_16x16x32_bf16 v[52:55], v[180:183], v[128:131], v[52:55]
    v_mfma_f32_16x16x32_bf16 v[76:79], v[180:183], v[132:135], v[76:79]
    v_mfma_f32_16x16x32_bf16 v[100:103], v[180:183], v[136:139], v[100:103]
    v_mfma_f32_16x16x32_bf16 v[124:127], v[180:183], v[140:143], v[124:127]
    s_waitcnt lgkmcnt(0)
    v_mfma_f32_16x16x32_bf16 v[32:35], v[184:187], v[144:147], v[32:35]
    v_mfma_f32_16x16x32_bf16 v[56:59], v[184:187], v[148:151], v[56:59]
    s_waitcnt vmcnt(5)
    s_barrier
    v_mfma_f32_16x16x32_bf16 v[80:83], v[184:187], v[152:155], v[80:83]
    ds_read_b128 v[128:131], v1 offset:16384
    v_mfma_f32_16x16x32_bf16 v[104:107], v[184:187], v[156:159], v[104:107]
    ds_read_b64_tr_b16 v[160:161], v2 offset:24576
    v_mfma_f32_16x16x32_bf16 v[36:39], v[188:191], v[144:147], v[36:39]
    ds_read_b64_tr_b16 v[162:163], v2 offset:30720
    v_mfma_f32_16x16x32_bf16 v[60:63], v[188:191], v[148:151], v[60:63]
    ds_read_b128 v[132:135], v1 offset:17408
    v_mfma_f32_16x16x32_bf16 v[84:87], v[188:191], v[152:155], v[84:87]
    ds_read_b128 v[136:139], v1 offset:18432
    v_mfma_f32_16x16x32_bf16 v[108:111], v[188:191], v[156:159], v[108:111]
    ds_read_b128 v[140:143], v1 offset:19456
    v_mfma_f32_16x16x32_bf16 v[40:43], v[192:195], v[144:147], v[40:43]
    ds_read_b64_tr_b16 v[164:165], v3 offset:24576
    v_mfma_f32_16x16x32_bf16 v[64:67], v[192:195], v[148:151], v[64:67]
    ds_read_b64_tr_b16 v[166:167], v3 offset:30720
    v_mfma_f32_16x16x32_bf16 v[88:91], v[192:195], v[152:155], v[88:91]
    ds_read_b64_tr_b16 v[168:169], v4 offset:24576
    v_mfma_f32_16x16x32_bf16 v[112:115], v[192:195], v[156:159], v[112:115]
    ds_read_b64_tr_b16 v[170:171], v4 offset:30720
    v_mfma_f32_16x16x32_bf16 v[44:47], v[196:199], v[144:147], v[44:47]
    ds_read_b64_tr_b16 v[172:173], v5 offset:24576
    v_mfma_f32_16x16x32_bf16 v[68:71], v[196:199], v[148:151], v[68:71]
    ds_read_b64_tr_b16 v[174:175], v5 offset:30720
    v_mfma_f32_16x16x32_bf16 v[92:95], v[196:199], v[152:155], v[92:95]
    ds_read_b64_tr_b16 v[176:177], v6 offset:24576
    v_mfma_f32_16x16x32_bf16 v[116:119], v[196:199], v[156:159], v[116:119]
    ds_read_b64_tr_b16 v[178:179], v6 offset:30720
    v_mfma_f32_16x16x32_bf16 v[48:51], v[200:203], v[144:147], v[48:51]
    ds_read_b64_tr_b16 v[180:181], v7 offset:24576
    v_mfma_f32_16x16x32_bf16 v[72:75], v[200:203], v[148:151], v[72:75]
    ds_read_b64_tr_b16 v[182:183], v7 offset:30720
    v_mfma_f32_16x16x32_bf16 v[96:99], v[200:203], v[152:155], v[96:99]
    v_mfma_f32_16x16x32_bf16 v[120:123], v[200:203], v[156:159], v[120:123]
    v_mfma_f32_16x16x32_bf16 v[52:55], v[204:207], v[144:147], v[52:55]
    v_mfma_f32_16x16x32_bf16 v[76:79], v[204:207], v[148:151], v[76:79]
    v_mfma_f32_16x16x32_bf16 v[100:103], v[204:207], v[152:155], v[100:103]
    v_mfma_f32_16x16x32_bf16 v[124:127], v[204:207], v[156:159], v[124:127]
    s_waitcnt lgkmcnt(0)
    v_mfma_f32_16x16x32_bf16 v[32:35], v[160:163], v[128:131], v[32:35]
    v_mfma_f32_16x16x32_bf16 v[56:59], v[160:163], v[132:135], v[56:59]
    s_waitcnt vmcnt(0)
    s_barrier
    v_mfma_f32_16x16x32_bf16 v[80:83], v[160:163], v[136:139], v[80:83]
    ds_read_b128 v[144:147], v1 offset:24576
    v_mfma_f32_16x16x32_bf16 v[104:107], v[160:163], v[140:143], v[104:107]
    ds_read_b64_tr_b16 v[184:185], v2 offset:36864
    v_mfma_f32_16x16x32_bf16 v[36:39], v[164:167], v[128:131], v[36:39]
    ds_read_b64_tr_b16 v[186:187], v2 offset:43008
    v_mfma_f32_16x16x32_bf16 v[60:63], v[164:167], v[132:135], v[60:63]
    ds_read_b128 v[148:151], v1 offset:25600
    v_mfma_f32_16x16x32_bf16 v[84:87], v[164:167], v[136:139], v[84:87]
    ds_read_b128 v[152:155], v1 offset:26624
    v_mfma_f32_16x16x32_bf16 v[108:111], v[164:167], v[140:143], v[108:111]
    ds_read_b128 v[156:159], v1 offset:27648
    v_mfma_f32_16x16x32_bf16 v[40:43], v[168:171], v[128:131], v[40:43]
    ds_read_b64_tr_b16 v[188:189], v3 offset:36864
    v_mfma_f32_16x16x32_bf16 v[64:67], v[168:171], v[132:135], v[64:67]
    ds_read_b64_tr_b16 v[190:191], v3 offset:43008
    v_mfma_f32_16x16x32_bf16 v[88:91], v[168:171], v[136:139], v[88:91]
    ds_read_b64_tr_b16 v[192:193], v4 offset:36864
    v_mfma_f32_16x16x32_bf16 v[112:115], v[168:171], v[140:143], v[112:115]
    ds_read_b64_tr_b16 v[194:195], v4 offset:43008
    v_mfma_f32_16x16x32_bf16 v[44:47], v[172:175], v[128:131], v[44:47]
    ds_read_b64_tr_b16 v[196:197], v5 offset:36864
    v_mfma_f32_16x16x32_bf16 v[68:71], v[172:175], v[132:135], v[68:71]
    ds_read_b64_tr_b16 v[198:199], v5 offset:43008
    v_mfma_f32_16x16x32_bf16 v[92:95], v[172:175], v[136:139], v[92:95]
    ds_read_b64_tr_b16 v[200:201], v6 offset:36864
    v_mfma_f32_16x16x32_bf16 v[116:119], v[172:175], v[140:143], v[116:119]
    ds_read_b64_tr_b16 v[202:203], v6 offset:43008
    v_mfma_f32_16x16x32_bf16 v[48:51], v[176:179], v[128:131], v[48:51]
    ds_read_b64_tr_b16 v[204:205], v7 offset:36864
    v_mfma_f32_16x16x32_bf16 v[72:75], v[176:179], v[132:135], v[72:75]
    ds_read_b64_tr_b16 v[206:207], v7 offset:43008
    v_mfma_f32_16x16x32_bf16 v[96:99], v[176:179], v[136:139], v[96:99]
    v_mfma_f32_16x16x32_bf16 v[120:123], v[176:179], v[140:143], v[120:123]
    v_mfma_f32_16x16x32_bf16 v[52:55], v[180:183], v[128:131], v[52:55]
    v_mfma_f32_16x16x32_bf16 v[76:79], v[180:183], v[132:135], v[76:79]
    v_mfma_f32_16x16x32_bf16 v[100:103], v[180:183], v[136:139], v[100:103]
    v_mfma_f32_16x16x32_bf16 v[124:127], v[180:183], v[140:143], v[124:127]
    s_waitcnt lgkmcnt(0)
    v_mfma_f32_16x16x32_bf16 v[32:35], v[184:187], v[144:147], v[32:35]
    v_mfma_f32_16x16x32_bf16 v[56:59], v[184:187], v[148:151], v[56:59]
    v_mfma_f32_16x16x32_bf16 v[80:83], v[184:187], v[152:155], v[80:83]
    v_mfma_f32_16x16x32_bf16 v[104:107], v[184:187], v[156:159], v[104:107]
    v_mfma_f32_16x16x32_bf16 v[36:39], v[188:191], v[144:147], v[36:39]
    v_mfma_f32_16x16x32_bf16 v[60:63], v[188:191], v[148:151], v[60:63]
    v_mfma_f32_16x16x32_bf16 v[84:87], v[188:191], v[152:155], v[84:87]
    v_mfma_f32_16x16x32_bf16 v[108:111], v[188:191], v[156:159], v[108:111]
    v_mfma_f32_16x16x32_bf16 v[40:43], v[192:195], v[144:147], v[40:43]
    v_mfma_f32_16x16x32_bf16 v[64:67], v[192:195], v[148:151], v[64:67]
    v_mfma_f32_16x16x32_bf16 v[88:91], v[192:195], v[152:155], v[88:91]
    v_mfma_f32_16x16x32_bf16 v[112:115], v[192:195], v[156:159], v[112:115]
    v_mfma_f32_16x16x32_bf16 v[44:47], v[196:199], v[144:147], v[44:47]
    v_mfma_f32_16x16x32_bf16 v[68:71], v[196:199], v[148:151], v[68:71]
    v_mfma_f32_16x16x32_bf16 v[92:95], v[196:199], v[152:155], v[92:95]
    v_mfma_f32_16x16x32_bf16 v[116:119], v[196:199], v[156:159], v[116:119]
    v_mfma_f32_16x16x32_bf16 v[48:51], v[200:203], v[144:147], v[48:51]
    v_mfma_f32_16x16x32_bf16 v[72:75], v[200:203], v[148:151], v[72:75]
    v_mfma_f32_16x16x32_bf16 v[96:99], v[200:203], v[152:155], v[96:99]
    v_mfma_f32_16x16x32_bf16 v[120:123], v[200:203], v[156:159], v[120:123]
    v_mfma_f32_16x16x32_bf16 v[52:55], v[204:207], v[144:147], v[52:55]
    v_mfma_f32_16x16x32_bf16 v[76:79], v[204:207], v[148:151], v[76:79]
    v_mfma_f32_16x16x32_bf16 v[100:103], v[204:207], v[152:155], v[100:103]
    v_mfma_f32_16x16x32_bf16 v[124:127], v[204:207], v[156:159], v[124:127]
    s_waitcnt lgkmcnt(0)
    s_mul_i32 s40, s25, 30
    s_add_u32 s40, s40, s36
    s_mul_i32 s42, s24, 3072
    v_lshlrev_b32 v12, 4, v0
    s_cmp_eq_u32 s26, 0
    s_cbranch_scc1 L_g2_skip0
    v_cvt_pk_bf16_f32 v128, v32, v33
    v_cvt_pk_bf16_f32 v129, v34, v35
    v_cvt_pk_bf16_f32 v130, v36, v37
    v_cvt_pk_bf16_f32 v131, v38, v39
    v_cvt_pk_bf16_f32 v132, v40, v41
    v_cvt_pk_bf16_f32 v133, v42, v43
    v_cvt_pk_bf16_f32 v134, v44, v45
    v_cvt_pk_bf16_f32 v135, v46, v47
    v_cvt_pk_bf16_f32 v136, v48, v49
    v_cvt_pk_bf16_f32 v137, v50, v51
    v_cvt_pk_bf16_f32 v138, v52, v53
    v_cvt_pk_bf16_f32 v139, v54, v55
    s_lshl_b32 s43, s40, 2
    s_add_u32 s43, s43, 0
    s_lshl_b32 s43, s43, 2
    s_add_u32 s43, s43, s26
    s_mul_i32 s43, s43, 12288
    s_add_u32 s43, s43, s42
    buffer_store_dwordx4 v[128:131], v12, s[12:15], s43 offen offset:0 sc1
    buffer_store_dwordx4 v[132:135], v12, s[12:15], s43 offen offset:1024 sc1
    buffer_store_dwordx4 v[136:139], v12, s[12:15], s43 offen offset:2048 sc1
L_g2_skip0:
    s_cmp_eq_u32 s26, 1
    s_cbranch_scc1 L_g2_skip1
    v_cvt_pk_bf16_f32 v140, v56, v57
    v_cvt_pk_bf16_f32 v141, v58, v59
    v_cvt_pk_bf16_f32 v142, v60, v61
    v_cvt_pk_bf16_f32 v143, v62, v63
    v_cvt_pk_bf16_f32 v144, v64, v65
    v_cvt_pk_bf16_f32 v145, v66, v67
    v_cvt_pk_bf16_f32 v146, v68, v69
    v_cvt_pk_bf16_f32 v147, v70, v71
    v_cvt_pk_bf16_f32 v148, v72, v73
    v_cvt_pk_bf16_f32 v149, v74, v75
    v_cvt_pk_bf16_f32 v150, v76, v77
    v_cvt_pk_bf16_f32 v151, v78, v79
    s_lshl_b32 s43, s40, 2
    s_add_u32 s43, s43, 1
    s_lshl_b32 s43, s43, 2
    s_add_u32 s43, s43, s26
    s_mul_i32 s43, s43, 12288
    s_add_u32 s43, s43, s42
    buffer_store_dwordx4 v[140:143], v12, s[12:15], s43 offen offset:0 sc1
    buffer_store_dwordx4 v[144:147], v12, s[12:15], s43 offen offset:1024 sc1
    buffer_store_dwordx4 v[148:151], v12, s[12:15], s43 offen offset:2048 sc1
L_g2_skip1:
    s_cmp_eq_u32 s26, 2
    s_cbranch_scc1 L_g2_skip2
    v_cvt_pk_bf16_f32 v152, v80, v81
    v_cvt_pk_bf16_f32 v153, v82, v83
    v_cvt_pk_bf16_f32 v154, v84, v85
    v_cvt_pk_bf16_f32 v155, v86, v87
    v_cvt_pk_bf16_f32 v156, v88, v89
    v_cvt_pk_bf16_f32 v157, v90, v91
    v_cvt_pk_bf16_f32 v158, v92, v93
    v_cvt_pk_bf16_f32 v159, v94, v95
    v_cvt_pk_bf16_f32 v160, v96, v97
    v_cvt_pk_bf16_f32 v161, v98, v99
    v_cvt_pk_bf16_f32 v162, v100, v101
    v_cvt_pk_bf16_f32 v163, v102, v103
    s_lshl_b32 s43, s40, 2
    s_add_u32 s43, s43, 2
    s_lshl_b32 s43, s43, 2
    s_add_u32 s43, s43, s26
    s_mul_i32 s43, s43, 12288
    s_add_u32 s43, s43, s42
    buffer_store_dwordx4 v[152:155], v12, s[12:15], s43 offen offset:0 sc1
    buffer_store_dwordx4 v[156:159], v12, s[12:15], s43 offen offset:1024 sc1
    buffer_store_dwordx4 v[160:163], v12, s[12:15], s43 offen offset:2048 sc1
L_g2_skip2:
    s_cmp_eq_u32 s26, 3
    s_cbranch_scc1 L_g2_skip3
    v_cvt_pk_bf16_f32 v164, v104, v105
    v_cvt_pk_bf16_f32 v165, v106, v107
    v_cvt_pk_bf16_f32 v166, v108, v109
    v_cvt_pk_bf16_f32 v167, v110, v111
    v_cvt_pk_bf16_f32 v168, v112, v113
    v_cvt_pk_bf16_f32 v169, v114, v115
    v_cvt_pk_bf16_f32 v170, v116, v117
    v_cvt_pk_bf16_f32 v171, v118, v119
    v_cvt_pk_bf16_f32 v172, v120, v121
    v_cvt_pk_bf16_f32 v173, v122, v123
    v_cvt_pk_bf16_f32 v174, v124, v125
    v_cvt_pk_bf16_f32 v175, v126, v127
    s_lshl_b32 s43, s40, 2
    s_add_u32 s43, s43, 3
    s_lshl_b32 s43, s43, 2
    s_add_u32 s43, s43, s26
    s_mul_i32 s43, s43, 12288
    s_add_u32 s43, s43, s42
    buffer_store_dwordx4 v[164:167], v12, s[12:15], s43 offen offset:0 sc1
    buffer_store_dwordx4 v[168:171], v12, s[12:15], s43 offen offset:1024 sc1
    buffer_store_dwordx4 v[172:175], v12, s[12:15], s43 offen offset:2048 sc1
L_g2_skip3:
    s_cmp_lg_u32 s26, 0
    s_cbranch_scc1 L_g2_mv0
    v_mov_b32 v208, v32
    v_mov_b32 v209, v33
    v_mov_b32 v210, v34
    v_mov_b32 v211, v35
    v_mov_b32 v212, v36
    v_mov_b32 v213, v37
    v_mov_b32 v214, v38
    v_mov_b32 v215, v39
    v_mov_b32 v216, v40
    v_mov_b32 v217, v41
    v_mov_b32 v218, v42
    v_mov_b32 v219, v43
    v_mov_b32 v220, v44
    v_mov_b32 v221, v45
    v_mov_b32 v222, v46
    v_mov_b32 v223, v47
    v_mov_b32 v224, v48
    v_mov_b32 v225, v49
    v_mov_b32 v226, v50
    v_mov_b32 v227, v51
    v_mov_b32 v228, v52
    v_mov_b32 v229, v53
    v_mov_b32 v230, v54
    v_mov_b32 v231, v55
L_g2_mv0:
    s_cmp_lg_u32 s26, 1
    s_cbranch_scc1 L_g2_mv1
    v_mov_b32 v208, v56
    v_mov_b32 v209, v57
    v_mov_b32 v210, v58
    v_mov_b32 v211, v59
    v_mov_b32 v212, v60
    v_mov_b32 v213, v61
    v_mov_b32 v214, v62
    v_mov_b32 v215, v63
    v_mov_b32 v216, v64
    v_mov_b32 v217, v65
    v_mov_b32 v218, v66
    v_mov_b32 v219, v67
    v_mov_b32 v220, v68
    v_mov_b32 v221, v69
    v_mov_b32 v222, v70
    v_mov_b32 v223, v71
    v_mov_b32 v224, v72
    v_mov_b32 v225, v73
    v_mov_b32 v226, v74
    v_mov_b32 v227, v75
    v_mov_b32 v228, v76
    v_mov_b32 v229, v77
    v_mov_b32 v230, v78
    v_mov_b32 v231, v79
L_g2_mv1:
    s_cmp_lg_u32 s26, 2
    s_cbranch_scc1 L_g2_mv2
    v_mov_b32 v208, v80
    v_mov_b32 v209, v81
    v_mov_b32 v210, v82
    v_mov_b32 v211, v83
    v_mov_b32 v212, v84
    v_mov_b32 v213, v85
    v_mov_b32 v214, v86
    v_mov_b32 v215, v87
    v_mov_b32 v216, v88
    v_mov_b32 v217, v89
    v_mov_b32 v218, v90
    v_mov_b32 v219, v91
    v_mov_b32 v220, v92
    v_mov_b32 v221, v93
    v_mov_b32 v222, v94
    v_mov_b32 v223, v95
    v_mov_b32 v224, v96
    v_mov_b32 v225, v97
    v_mov_b32 v226, v98
    v_mov_b32 v227, v99
    v_mov_b32 v228, v100
    v_mov_b32 v229, v101
    v_mov_b32 v230, v102
    v_mov_b32 v231, v103
L_g2_mv2:
    s_cmp_lg_u32 s26, 3
    s_cbranch_scc1 L_g2_mv3
    v_mov_b32 v208, v104
    v_mov_b32 v209, v105
    v_mov_b32 v210, v106
    v_mov_b32 v211, v107
    v_mov_b32 v212, v108
    v_mov_b32 v213, v109
    v_mov_b32 v214, v110
    v_mov_b32 v215, v111
    v_mov_b32 v216, v112
    v_mov_b32 v217, v113
    v_mov_b32 v218, v114
    v_mov_b32 v219, v115
    v_mov_b32 v220, v116
    v_mov_b32 v221, v117
    v_mov_b32 v222, v118
    v_mov_b32 v223, v119
    v_mov_b32 v224, v120
    v_mov_b32 v225, v121
    v_mov_b32 v226, v122
    v_mov_b32 v227, v123
    v_mov_b32 v228, v124
    v_mov_b32 v229, v125
    v_mov_b32 v230, v126
    v_mov_b32 v231, v127
L_g2_mv3:
    s_waitcnt vmcnt(0)
    s_barrier
    s_cmp_lg_u32 s24, 0
    s_cbranch_scc1 L_g2_xw
    s_lshl_b32 s44, s40, 2
    s_add_u32 s44, s44, 256
    v_and_b32 v15, 3, v0
    v_add_u32 v15, s44, v15
    v_lshlrev_b32 v15, 7, v15
    s_add_u32 s44, s44, s26
    s_lshl_b32 s44, s44, 7
    v_mov_b32 v13, s44
    v_mov_b32 v14, s66
    v_cmp_eq_u32 vcc, 0, v0
    s_nop 3
    s_and_saveexec_b64 s[74:75], vcc
    buffer_store_dword v14, v13, s[20:23], 0 offen sc1
    s_mov_b64 exec, s[74:75]
    s_mov_b32 s45, 0
L_g2_xpoll:
    buffer_load_dword v16, v15, s[20:23], 0 offen sc1
    s_waitcnt vmcnt(0)
    v_cmp_ne_u32 vcc, s66, v16
    s_nop 4
    s_cbranch_vccz L_g2_xw
    s_sleep 2
    s_add_u32 s45, s45, 1
    s_cmp_lt_u32 s45, 400000
    s_cbranch_scc1 L_g2_xpoll
L_g2_xw:
    s_barrier
    s_add_u32 s44, s26, 1
    s_and_b32 s44, s44, 3
    s_lshl_b32 s43, s40, 2
    s_add_u32 s43, s43, s26
    s_lshl_b32 s43, s43, 2
    s_add_u32 s43, s43, s44
    s_mul_i32 s43, s43, 12288
    s_add_u32 s43, s43, s42
    buffer_load_dwordx4 v[128:131], v12, s[12:15], s43 offen offset:0 sc1
    buffer_load_dwordx4 v[132:135], v12, s[12:15], s43 offen offset:1024 sc1
    buffer_load_dwordx4 v[136:139], v12, s[12:15], s43 offen offset:2048 sc1
    s_add_u32 s44, s26, 2
    s_and_b32 s44, s44, 3
    s_lshl_b32 s43, s40, 2
    s_add_u32 s43, s43, s26
    s_lshl_b32 s43, s43, 2
    s_add_u32 s43, s43, s44
    s_mul_i32 s43, s43, 12288
    s_add_u32 s43, s43, s42
    buffer_load_dwordx4 v[140:143], v12, s[12:15], s43 offen offset:0 sc1
    buffer_load_dwordx4 v[144:147], v12, s[12:15], s43 offen offset:1024 sc1
    buffer_load_dwordx4 v[148:151], v12, s[12:15], s43 offen offset:2048 sc1
    s_add_u32 s44, s26, 3
    s_and_b32 s44, s44, 3
    s_lshl_b32 s43, s40, 2
    s_add_u32 s43, s43, s26
    s_lshl_b32 s43, s43, 2
    s_add_u32 s43, s43, s44
    s_mul_i32 s43, s43, 12288
    s_add_u32 s43, s43, s42
    buffer_load_dwordx4 v[152:155], v12, s[12:15], s43 offen offset:0 sc1
    buffer_load_dwordx4 v[156:159], v12, s[12:15], s43 offen offset:1024 sc1
    buffer_load_dwordx4 v[160:163], v12, s[12:15], s43 offen offset:2048 sc1
    s_lshl_b32 s43, s27, 3
    s_lshr_b32 s44, s24, 1
    s_lshl_b32 s44, s44, 2
    s_add_u32 s43, s43, s44
    s_add_u32 s43, s43, s26
    s_mul_i32 s43, s43, 36864
    s_mul_i32 s44, s25, 1152
    s_add_u32 s43, s43, s44
    s_mul_i32 s44, s28, 384
    s_add_u32 s43, s43, s44
    s_and_b32 s44, s24, 1
    s_mul_i32 s44, s44, 192
    s_add_u32 s43, s43, s44
    v_and_b32 v13, 15, v0
    v_mul_u32_u24 v13, 2304, v13
    v_lshrrev_b32 v14, 4, v0
    v_lshlrev_b32 v14, 4, v14
    v_add_u32 v13, v13, v14
    s_mov_b32 s45, 0xffff0000
    s_waitcnt vmcnt(6)
    v_lshlrev_b32 v15, 16, v128
    v_and_b32 v16, s45, v128
    v_add_f32 v208, v208, v15
    v_add_f32 v209, v209, v16
    v_lshlrev_b32 v15, 16, v129
    v_and_b32 v16, s45, v129
    v_add_f32 v210, v210, v15
    v_add_f32 v211, v211, v16
    v_lshlrev_b32 v15, 16, v130
    v_and_b32 v16, s45, v130
    v_add_f32 v212, v212, v15
    v_add_f32 v213, v213, v16
    v_lshlrev_b32 v15, 16, v131
    v_and_b32 v16, s45, v131
    v_add_f32 v214, v214, v15
    v_add_f32 v215, v215, v16
    v_lshlrev_b32 v15, 16, v132
    v_and_b32 v16, s45, v132
    v_add_f32 v216, v216, v15
    v_add_f32 v217, v217, v16
    v_lshlrev_b32 v15, 16, v133
    v_and_b32 v16, s45, v133
    v_add_f32 v218, v218, v15
    v_add_f32 v219, v219, v16
    v_lshlrev_b32 v15, 16, v134
    v_and_b32 v16, s45, v134
    v_add_f32 v220, v220, v15
    v_add_f32 v221, v221, v16
    v_lshlrev_b32 v15, 16, v135
    v_and_b32 v16, s45, v135
    v_add_f32 v222, v222, v15
    v_add_f32 v223, v223, v16
    v_lshlrev_b32 v15, 16, v136
    v_and_b32 v16, s45, v136
    v_add_f32 v224, v224, v15
    v_add_f32 v225, v225, v16
    v_lshlrev_b32 v15, 16, v137
    v_and_b32 v16, s45, v137
    v_add_f32 v226, v226, v15
    v_add_f32 v227, v227, v16
    v_lshlrev_b32 v15, 16, v138
    v_and_b32 v16, s45, v138
    v_add_f32 v228, v228, v15
    v_add_f32 v229, v229, v16
    v_lshlrev_b32 v15, 16, v139
    v_and_b32 v16, s45, v139
    v_add_f32 v230, v230, v15
    v_add_f32 v231, v231, v16
    s_waitcnt vmcnt(3)
    v_lshlrev_b32 v15, 16, v140
    v_and_b32 v16, s45, v140
    v_add_f32 v208, v208, v15
    v_add_f32 v209, v209, v16
    v_lshlrev_b32 v15, 16, v141
    v_and_b32 v16, s45, v141
    v_add_f32 v210, v210, v15
    v_add_f32 v211, v211, v16
    v_lshlrev_b32 v15, 16, v142
    v_and_b32 v16, s45, v142
    v_add_f32 v212, v212, v15
    v_add_f32 v213, v213, v16
    v_lshlrev_b32 v15, 16, v143
    v_and_b32 v16, s45, v143
    v_add_f32 v214, v214, v15
    v_add_f32 v215, v215, v16
    v_lshlrev_b32 v15, 16, v144
    v_and_b32 v16, s45, v144
    v_add_f32 v216, v216, v15
    v_add_f32 v217, v217, v16
    v_lshlrev_b32 v15, 16, v145
    v_and_b32 v16, s45, v145
    v_add_f32 v218, v218, v15
    v_add_f32 v219, v219, v16
    v_lshlrev_b32 v15, 16, v146
    v_and_b32 v16, s45, v146
    v_add_f32 v220, v220, v15
    v_add_f32 v221, v221, v16
    v_lshlrev_b32 v15, 16, v147
    v_and_b32 v16, s45, v147
    v_add_f32 v222, v222, v15
    v_add_f32 v223, v223, v16
    v_lshlrev_b32 v15, 16, v148
    v_and_b32 v16, s45, v148
    v_add_f32 v224, v224, v15
    v_add_f32 v225, v225, v16
    v_lshlrev_b32 v15, 16, v149
    v_and_b32 v16, s45, v149
    v_add_f32 v226, v226, v15
    v_add_f32 v227, v227, v16
    v_lshlrev_b32 v15, 16, v150
    v_and_b32 v16, s45, v150
    v_add_f32 v228, v228, v15
    v_add_f32 v229, v229, v16
    v_lshlrev_b32 v15, 16, v151
    v_and_b32 v16, s45, v151
    v_add_f32 v230, v230, v15
    v_add_f32 v231, v231, v16
    s_waitcnt vmcnt(0)
    v_lshlrev_b32 v15, 16, v152
    v_and_b32 v16, s45, v152
    v_add_f32 v208, v208, v15
    v_add_f32 v209, v209, v16
    v_lshlrev_b32 v15, 16, v153
    v_and_b32 v16, s45, v153
    v_add_f32 v210, v210, v15
    v_add_f32 v211, v211, v16
    v_lshlrev_b32 v15, 16, v154
    v_and_b32 v16, s45, v154
    v_add_f32 v212, v212, v15
    v_add_f32 v213, v213, v16
    v_lshlrev_b32 v15, 16, v155
    v_and_b32 v16, s45, v155
    v_add_f32 v214, v214, v15
    v_add_f32 v215, v215, v16
    v_lshlrev_b32 v15, 16, v156
    v_and_b32 v16, s45, v156
    v_add_f32 v216, v216, v15
    v_add_f32 v217, v217, v16
    v_lshlrev_b32 v15, 16, v157
    v_and_b32 v16, s45, v157
    v_add_f32 v218, v218, v15
    v_add_f32 v219, v219, v16
    v_lshlrev_b32 v15, 16, v158
    v_and_b32 v16, s45, v158
    v_add_f32 v220, v220, v15
    v_add_f32 v221, v221, v16
    v_lshlrev_b32 v15, 16, v159
    v_and_b32 v16, s45, v159
    v_add_f32 v222, v222, v15
    v_add_f32 v223, v223, v16
    v_lshlrev_b32 v15, 16, v160
    v_and_b32 v16, s45, v160
    v_add_f32 v224, v224, v15
    v_add_f32 v225, v225, v16
    v_lshlrev_b32 v15, 16, v161
    v_and_b32 v16, s45, v161
    v_add_f32 v226, v226, v15
    v_add_f32 v227, v227, v16
    v_lshlrev_b32 v15, 16, v162
    v_and_b32 v16, s45, v162
    v_add_f32 v228, v228, v15
    v_add_f32 v229, v229, v16
    v_lshlrev_b32 v15, 16, v163
    v_and_b32 v16, s45, v163
    v_add_f32 v230, v230, v15
    v_add_f32 v231, v231, v16
    v_cvt_pk_bf16_f32 v208, v208, v209
    v_cvt_pk_bf16_f32 v209, v210, v211
    v_cvt_pk_bf16_f32 v212, v212, v213
    v_cvt_pk_bf16_f32 v213, v214, v215
    v_cvt_pk_bf16_f32 v216, v216, v217
    v_cvt_pk_bf16_f32 v217, v218, v219
    v_cvt_pk_bf16_f32 v220, v220, v221
    v_cvt_pk_bf16_f32 v221, v222, v223
    v_cvt_pk_bf16_f32 v224, v224, v225
    v_cvt_pk_bf16_f32 v225, v226, v227
    v_cvt_pk_bf16_f32 v228, v228, v229
    v_cvt_pk_bf16_f32 v229, v230, v231
    v_permlane32_swap_b32 v208, v212
    v_permlane32_swap_b32 v209, v213
    v_permlane32_swap_b32 v216, v220
    v_permlane32_swap_b32 v217, v221
    v_permlane32_swap_b32 v224, v228
    v_permlane32_swap_b32 v225, v229
    v_permlane16_swap_b32 v208, v212
    v_permlane16_swap_b32 v209, v213
    v_permlane16_swap_b32 v216, v220
    v_permlane16_swap_b32 v217, v221
    v_permlane16_swap_b32 v224, v228
    v_permlane16_swap_b32 v225, v229
    v_mov_b32 v210, v212
    v_mov_b32 v211, v213
    v_mov_b32 v218, v220
    v_mov_b32 v219, v221
    v_mov_b32 v226, v228
    v_mov_b32 v227, v229
    buffer_store_dwordx4 v[208:211], v13, s[16:19], s43 offen offset:0
    buffer_store_dwordx4 v[216:219], v13, s[16:19], s43 offen offset:64
    buffer_store_dwordx4 v[224:227], v13, s[16:19], s43 offen offset:128
L_g2_done:
L_k1_done:
    s_endpgm
L_rescale:
    s_nop 7
    s_nop 7
    v_max3_f32 v24, v64, v65, v66
    v_max3_f32 v25, v67, v68, v69
    v_max3_f32 v24, v24, v70, v71
    v_max_f32 v24, v24, v25
    v_mov_b32 v25, v24
    s_nop 1
    v_permlane32_swap_b32 v24, v25
    v_max_f32 v24, v24, v25
    v_mov_b32 v25, v24
    s_nop 1
    v_permlane16_swap_b32 v24, v25
    v_max_f32 v24, v24, v25
    v_add_f32 v24, 0x40e00000, v24
    v_max_f32 v24, 0, v24
    v_sub_f32 v25, 0, v24
    v_exp_f32 v25, v25
    v_sub_f32 v124, v124, v24
    v_sub_f32 v125, v125, v24
    v_sub_f32 v126, v126, v24
    v_sub_f32 v127, v127, v24
    v_sub_f32 v64, v64, v24
    v_sub_f32 v65, v65, v24
    v_sub_f32 v66, v66, v24
    v_sub_f32 v67, v67, v24
    v_sub_f32 v68, v68, v24
    v_sub_f32 v69, v69, v24
    v_sub_f32 v70, v70, v24
    v_sub_f32 v71, v71, v24
    v_mul_f32 v144, v144, v25
    v_mul_f32 v145, v145, v25
    v_mul_f32 v146, v146, v25
    v_mul_f32 v147, v147, v25
    v_accvgpr_read_b32 v200, a0
    v_accvgpr_read_b32 v201, a1
    v_accvgpr_read_b32 v202, a2
    v_accvgpr_read_b32 v203, a3
    v_mul_f32 v200, v200, v25
    v_mul_f32 v201, v201, v25
    v_mul_f32 v202, v202, v25
    v_mul_f32 v203, v203, v25
    v_accvgpr_write_b32 a0, v200
    v_accvgpr_write_b32 a1, v201
    v_accvgpr_write_b32 a2, v202
    v_accvgpr_write_b32 a3, v203
    v_accvgpr_read_b32 v200, a20
    v_accvgpr_read_b32 v201, a21
    v_accvgpr_read_b32 v202, a22
    v_accvgpr_read_b32 v203, a23
    v_mul_f32 v200, v200, v25
    v_mul_f32 v201, v201, v25
    v_mul_f32 v202, v202, v25
    v_mul_f32 v203, v203, v25
    v_accvgpr_write_b32 a20, v200
    v_accvgpr_write_b32 a21, v201
    v_accvgpr_write_b32 a22, v202
    v_accvgpr_write_b32 a23, v203
    v_accvgpr_read_b32 v200, a40
    v_accvgpr_read_b32 v201, a41
    v_accvgpr_read_b32 v202, a42
    v_accvgpr_read_b32 v203, a43
    v_mul_f32 v200, v200, v25
    v_mul_f32 v201, v201, v25
    v_mul_f32 v202, v202, v25
    v_mul_f32 v203, v203, v25
    v_accvgpr_write_b32 a40, v200
    v_accvgpr_write_b32 a41, v201
    v_accvgpr_write_b32 a42, v202
    v_accvgpr_write_b32 a43, v203
    v_accvgpr_read_b32 v200, a60
    v_accvgpr_read_b32 v201, a61
    v_accvgpr_read_b32 v202, a62
    v_accvgpr_read_b32 v203, a63
    v_mul_f32 v200, v200, v25
    v_mul_f32 v201, v201, v25
    v_mul_f32 v202, v202, v25
    v_mul_f32 v203, v203, v25
    v_accvgpr_write_b32 a60, v200
    v_accvgpr_write_b32 a61, v201
    v_accvgpr_write_b32 a62, v202
    v_accvgpr_write_b32 a63, v203
    v_accvgpr_read_b32 v200, a80
    v_accvgpr_read_b32 v201, a81
    v_accvgpr_read_b32 v202, a82
    v_accvgpr_read_b32 v203, a83
    v_mul_f32 v200, v200, v25
    v_mul_f32 v201, v201, v25
    v_mul_f32 v202, v202, v25
    v_mul_f32 v203, v203, v25
    v_accvgpr_write_b32 a80, v200
    v_accvgpr_write_b32 a81, v201
    v_accvgpr_write_b32 a82, v202
    v_accvgpr_write_b32 a83, v203
    v_accvgpr_read_b32 v200, a100
    v_accvgpr_read_b32 v201, a101
    v_accvgpr_read_b32 v202, a102
    v_accvgpr_read_b32 v203, a103
    v_mul_f32 v200, v200, v25
    v_mul_f32 v201, v201, v25
    v_mul_f32 v202, v202, v25
    v_mul_f32 v203, v203, v25
    v_accvgpr_write_b32 a100, v200
    v_accvgpr_write_b32 a101, v201
    v_accvgpr_write_b32 a102, v202
    v_accvgpr_write_b32 a103, v203
    v_accvgpr_read_b32 v200, a120
    v_accvgpr_read_b32 v201, a121
    v_accvgpr_read_b32 v202, a122
    v_accvgpr_read_b32 v203, a123
    v_mul_f32 v200, v200, v25
    v_mul_f32 v201, v201, v25
    v_mul_f32 v202, v202, v25
    v_mul_f32 v203, v203, v25
    v_accvgpr_write_b32 a120, v200
    v_accvgpr_write_b32 a121, v201
    v_accvgpr_write_b32 a122, v202
    v_accvgpr_write_b32 a123, v203
    v_accvgpr_read_b32 v200, a140
    v_accvgpr_read_b32 v201, a141
    v_accvgpr_read_b32 v202, a142
    v_accvgpr_read_b32 v203, a143
    v_mul_f32 v200, v200, v25
    v_mul_f32 v201, v201, v25
    v_mul_f32 v202, v202, v25
    v_mul_f32 v203, v203, v25
    v_accvgpr_write_b32 a140, v200
    v_accvgpr_write_b32 a141, v201
    v_accvgpr_write_b32 a142, v202
    v_accvgpr_write_b32 a143, v203
    v_exp_f32 v200, v64
    v_exp_f32 v201, v65
    v_exp_f32 v202, v66
    v_exp_f32 v203, v67
    v_exp_f32 v204, v68
    v_cvt_pk_bf16_f32 v104, v200, v201
    v_exp_f32 v205, v69
    v_cvt_pk_bf16_f32 v105, v202, v203
    v_exp_f32 v206, v70
    v_exp_f32 v207, v71
    v_cvt_pk_bf16_f32 v106, v204, v205
    v_cvt_pk_bf16_f32 v107, v206, v207
    v_or3_b32 v23, v104, v105, v106
    v_or_b32 v23, v23, v107
    v_max3_f32 v24, v72, v73, v74
    v_max3_f32 v25, v75, v76, v77
    v_max3_f32 v24, v24, v78, v79
    v_max_f32 v24, v24, v25
    v_mov_b32 v25, v24
    s_nop 1
    v_permlane32_swap_b32 v24, v25
    v_max_f32 v24, v24, v25
    v_mov_b32 v25, v24
    s_nop 1
    v_permlane16_swap_b32 v24, v25
    v_max_f32 v24, v24, v25
    v_add_f32 v24, 0x40e00000, v24
    v_max_f32 v24, 0, v24
    v_sub_f32 v25, 0, v24
    v_exp_f32 v25, v25
    v_sub_f32 v128, v128, v24
    v_sub_f32 v129, v129, v24
    v_sub_f32 v130, v130, v24
    v_sub_f32 v131, v131, v24
    v_sub_f32 v72, v72, v24
    v_sub_f32 v73, v73, v24
    v_sub_f32 v74, v74, v24
    v_sub_f32 v75, v75, v24
    v_sub_f32 v76, v76, v24
    v_sub_f32 v77, v77, v24
    v_sub_f32 v78, v78, v24
    v_sub_f32 v79, v79, v24
    v_mul_f32 v148, v148, v25
    v_mul_f32 v149, v149, v25
    v_mul_f32 v150, v150, v25
    v_mul_f32 v151, v151, v25
    v_accvgpr_read_b32 v200, a4
    v_accvgpr_read_b32 v201, a5
    v_accvgpr_read_b32 v202, a6
    v_accvgpr_read_b32 v203, a7
    v_mul_f32 v200, v200, v25
    v_mul_f32 v201, v201, v25
    v_mul_f32 v202, v202, v25
    v_mul_f32 v203, v203, v25
    v_accvgpr_write_b32 a4, v200
    v_accvgpr_write_b32 a5, v201
    v_accvgpr_write_b32 a6, v202
    v_accvgpr_write_b32 a7, v203
    v_accvgpr_read_b32 v200, a24
    v_accvgpr_read_b32 v201, a25
    v_accvgpr_read_b32 v202, a26
    v_accvgpr_read_b32 v203, a27
    v_mul_f32 v200, v200, v25
    v_mul_f32 v201, v201, v25
    v_mul_f32 v202, v202, v25
    v_mul_f32 v203, v203, v25
    v_accvgpr_write_b32 a24, v200
    v_accvgpr_write_b32 a25, v201
    v_accvgpr_write_b32 a26, v202
    v_accvgpr_write_b32 a27, v203
    v_accvgpr_read_b32 v200, a44
    v_accvgpr_read_b32 v201, a45
    v_accvgpr_read_b32 v202, a46
    v_accvgpr_read_b32 v203, a47
    v_mul_f32 v200, v200, v25
    v_mul_f32 v201, v201, v25
    v_mul_f32 v202, v202, v25
    v_mul_f32 v203, v203, v25
    v_accvgpr_write_b32 a44, v200
    v_accvgpr_write_b32 a45, v201
    v_accvgpr_write_b32 a46, v202
    v_accvgpr_write_b32 a47, v203
    v_accvgpr_read_b32 v200, a64
    v_accvgpr_read_b32 v201, a65
    v_accvgpr_read_b32 v202, a66
    v_accvgpr_read_b32 v203, a67
    v_mul_f32 v200, v200, v25
    v_mul_f32 v201, v201, v25
    v_mul_f32 v202, v202, v25
    v_mul_f32 v203, v203, v25
    v_accvgpr_write_b32 a64, v200
    v_accvgpr_write_b32 a65, v201
    v_accvgpr_write_b32 a66, v202
    v_accvgpr_write_b32 a67, v203
    v_accvgpr_read_b32 v200, a84
    v_accvgpr_read_b32 v201, a85
    v_accvgpr_read_b32 v202, a86
    v_accvgpr_read_b32 v203, a87
    v_mul_f32 v200, v200, v25
    v_mul_f32 v201, v201, v25
    v_mul_f32 v202, v202, v25
    v_mul_f32 v203, v203, v25
    v_accvgpr_write_b32 a84, v200
    v_accvgpr_write_b32 a85, v201
    v_accvgpr_write_b32 a86, v202
    v_accvgpr_write_b32 a87, v203
    v_accvgpr_read_b32 v200, a104
    v_accvgpr_read_b32 v201, a105
    v_accvgpr_read_b32 v202, a106
    v_accvgpr_read_b32 v203, a107
    v_mul_f32 v200, v200, v25
    v_mul_f32 v201, v201, v25
    v_mul_f32 v202, v202, v25
    v_mul_f32 v203, v203, v25
    v_accvgpr_write_b32 a104, v200
    v_accvgpr_write_b32 a105, v201
    v_accvgpr_write_b32 a106, v202
    v_accvgpr_write_b32 a107, v203
    v_accvgpr_read_b32 v200, a124
    v_accvgpr_read_b32 v201, a125
    v_accvgpr_read_b32 v202, a126
    v_accvgpr_read_b32 v203, a127
    v_mul_f32 v200, v200, v25
    v_mul_f32 v201, v201, v25
    v_mul_f32 v202, v202, v25
    v_mul_f32 v203, v203, v25
    v_accvgpr_write_b32 a124, v200
    v_accvgpr_write_b32 a125, v201
    v_accvgpr_write_b32 a126, v202
    v_accvgpr_write_b32 a127, v203
    v_accvgpr_read_b32 v200, a144
    v_accvgpr_read_b32 v201, a145
    v_accvgpr_read_b32 v202, a146
    v_accvgpr_read_b32 v203, a147
    v_mul_f32 v200, v200, v25
    v_mul_f32 v201, v201, v25
    v_mul_f32 v202, v202, v25
    v_mul_f32 v203, v203, v25
    v_accvgpr_write_b32 a144, v200
    v_accvgpr_write_b32 a145, v201
    v_accvgpr_write_b32 a146, v202
    v_accvgpr_write_b32 a147, v203
    v_exp_f32 v208, v72
    v_exp_f32 v209, v73
    v_exp_f32 v210, v74
    v_exp_f32 v211, v75
    v_exp_f32 v212, v76
    v_cvt_pk_bf16_f32 v108, v208, v209
    v_exp_f32 v213, v77
    v_cvt_pk_bf16_f32 v109, v210, v211
    v_exp_f32 v214, v78
    v_exp_f32 v215, v79
    v_cvt_pk_bf16_f32 v110, v212, v213
    v_cvt_pk_bf16_f32 v111, v214, v215
    v_or3_b32 v23, v108, v109, v110
    v_or_b32 v23, v23, v111
    v_max3_f32 v24, v80, v81, v82
    v_max3_f32 v25, v83, v84, v85
    v_max3_f32 v24, v24, v86, v87
    v_max_f32 v24, v24, v25
    v_mov_b32 v25, v24
    s_nop 1
    v_permlane32_swap_b32 v24, v25
    v_max_f32 v24, v24, v25
    v_mov_b32 v25, v24
    s_nop 1
    v_permlane16_swap_b32 v24, v25
    v_max_f32 v24, v24, v25
    v_add_f32 v24, 0x40e00000, v24
    v_max_f32 v24, 0, v24
    v_sub_f32 v25, 0, v24
    v_exp_f32 v25, v25
    v_sub_f32 v132, v132, v24
    v_sub_f32 v133, v133, v24
    v_sub_f32 v134, v134, v24
    v_sub_f32 v135, v135, v24
    v_sub_f32 v80, v80, v24
    v_sub_f32 v81, v81, v24
    v_sub_f32 v82, v82, v24
    v_sub_f32 v83, v83, v24
    v_sub_f32 v84, v84, v24
    v_sub_f32 v85, v85, v24
    v_sub_f32 v86, v86, v24
    v_sub_f32 v87, v87, v24
    v_mul_f32 v152, v152, v25
    v_mul_f32 v153, v153, v25
    v_mul_f32 v154, v154, v25
    v_mul_f32 v155, v155, v25
    v_accvgpr_read_b32 v200, a8
    v_accvgpr_read_b32 v201, a9
    v_accvgpr_read_b32 v202, a10
    v_accvgpr_read_b32 v203, a11
    v_mul_f32 v200, v200, v25
    v_mul_f32 v201, v201, v25
    v_mul_f32 v202, v202, v25
    v_mul_f32 v203, v203, v25
    v_accvgpr_write_b32 a8, v200
    v_accvgpr_write_b32 a9, v201
    v_accvgpr_write_b32 a10, v202
    v_accvgpr_write_b32 a11, v203
    v_accvgpr_read_b32 v200, a28
    v_accvgpr_read_b32 v201, a29
    v_accvgpr_read_b32 v202, a30
    v_accvgpr_read_b32 v203, a31
    v_mul_f32 v200, v200, v25
    v_mul_f32 v201, v201, v25
    v_mul_f32 v202, v202, v25
    v_mul_f32 v203, v203, v25
    v_accvgpr_write_b32 a28, v200
    v_accvgpr_write_b32 a29, v201
    v_accvgpr_write_b32 a30, v202
    v_accvgpr_write_b32 a31, v203
    v_accvgpr_read_b32 v200, a48
    v_accvgpr_read_b32 v201, a49
    v_accvgpr_read_b32 v202, a50
    v_accvgpr_read_b32 v203, a51
    v_mul_f32 v200, v200, v25
    v_mul_f32 v201, v201, v25
    v_mul_f32 v202, v202, v25
    v_mul_f32 v203, v203, v25
    v_accvgpr_write_b32 a48, v200
    v_accvgpr_write_b32 a49, v201
    v_accvgpr_write_b32 a50, v202
    v_accvgpr_write_b32 a51, v203
    v_accvgpr_read_b32 v200, a68
    v_accvgpr_read_b32 v201, a69
    v_accvgpr_read_b32 v202, a70
    v_accvgpr_read_b32 v203, a71
    v_mul_f32 v200, v200, v25
    v_mul_f32 v201, v201, v25
    v_mul_f32 v202, v202, v25
    v_mul_f32 v203, v203, v25
    v_accvgpr_write_b32 a68, v200
    v_accvgpr_write_b32 a69, v201
    v_accvgpr_write_b32 a70, v202
    v_accvgpr_write_b32 a71, v203
    v_accvgpr_read_b32 v200, a88
    v_accvgpr_read_b32 v201, a89
    v_accvgpr_read_b32 v202, a90
    v_accvgpr_read_b32 v203, a91
    v_mul_f32 v200, v200, v25
    v_mul_f32 v201, v201, v25
    v_mul_f32 v202, v202, v25
    v_mul_f32 v203, v203, v25
    v_accvgpr_write_b32 a88, v200
    v_accvgpr_write_b32 a89, v201
    v_accvgpr_write_b32 a90, v202
    v_accvgpr_write_b32 a91, v203
    v_accvgpr_read_b32 v200, a108
    v_accvgpr_read_b32 v201, a109
    v_accvgpr_read_b32 v202, a110
    v_accvgpr_read_b32 v203, a111
    v_mul_f32 v200, v200, v25
    v_mul_f32 v201, v201, v25
    v_mul_f32 v202, v202, v25
    v_mul_f32 v203, v203, v25
    v_accvgpr_write_b32 a108, v200
    v_accvgpr_write_b32 a109, v201
    v_accvgpr_write_b32 a110, v202
    v_accvgpr_write_b32 a111, v203
    v_accvgpr_read_b32 v200, a128
    v_accvgpr_read_b32 v201, a129
    v_accvgpr_read_b32 v202, a130
    v_accvgpr_read_b32 v203, a131
    v_mul_f32 v200, v200, v25
    v_mul_f32 v201, v201, v25
    v_mul_f32 v202, v202, v25
    v_mul_f32 v203, v203, v25
    v_accvgpr_write_b32 a128, v200
    v_accvgpr_write_b32 a129, v201
    v_accvgpr_write_b32 a130, v202
    v_accvgpr_write_b32 a131, v203
    v_accvgpr_read_b32 v200, a148
    v_accvgpr_read_b32 v201, a149
    v_accvgpr_read_b32 v202, a150
    v_accvgpr_read_b32 v203, a151
    v_mul_f32 v200, v200, v25
    v_mul_f32 v201, v201, v25
    v_mul_f32 v202, v202, v25
    v_mul_f32 v203, v203, v25
    v_accvgpr_write_b32 a148, v200
    v_accvgpr_write_b32 a149, v201
    v_accvgpr_write_b32 a150, v202
    v_accvgpr_write_b32 a151, v203
    v_exp_f32 v200, v80
    v_exp_f32 v201, v81
    v_exp_f32 v202, v82
    v_exp_f32 v203, v83
    v_exp_f32 v204, v84
    v_cvt_pk_bf16_f32 v112, v200, v201
    v_exp_f32 v205, v85
    v_cvt_pk_bf16_f32 v113, v202, v203
    v_exp_f32 v206, v86
    v_exp_f32 v207, v87
    v_cvt_pk_bf16_f32 v114, v204, v205
    v_cvt_pk_bf16_f32 v115, v206, v207
    v_or3_b32 v23, v112, v113, v114
    v_or_b32 v23, v23, v115
    v_max3_f32 v24, v88, v89, v90
    v_max3_f32 v25, v91, v92, v93
    v_max3_f32 v24, v24, v94, v95
    v_max_f32 v24, v24, v25
    v_mov_b32 v25, v24
    s_nop 1
    v_permlane32_swap_b32 v24, v25
    v_max_f32 v24, v24, v25
    v_mov_b32 v25, v24
    s_nop 1
    v_permlane16_swap_b32 v24, v25
    v_max_f32 v24, v24, v25
    v_add_f32 v24, 0x40e00000, v24
    v_max_f32 v24, 0, v24
    v_sub_f32 v25, 0, v24
    v_exp_f32 v25, v25
    v_sub_f32 v136, v136, v24
    v_sub_f32 v137, v137, v24
    v_sub_f32 v138, v138, v24
    v_sub_f32 v139, v139, v24
    v_sub_f32 v88, v88, v24
    v_sub_f32 v89, v89, v24
    v_sub_f32 v90, v90, v24
    v_sub_f32 v91, v91, v24
    v_sub_f32 v92, v92, v24
    v_sub_f32 v93, v93, v24
    v_sub_f32 v94, v94, v24
    v_sub_f32 v95, v95, v24
    v_mul_f32 v156, v156, v25
    v_mul_f32 v157, v157, v25
    v_mul_f32 v158, v158, v25
    v_mul_f32 v159, v159, v25
    v_accvgpr_read_b32 v200, a12
    v_accvgpr_read_b32 v201, a13
    v_accvgpr_read_b32 v202, a14
    v_accvgpr_read_b32 v203, a15
    v_mul_f32 v200, v200, v25
    v_mul_f32 v201, v201, v25
    v_mul_f32 v202, v202, v25
    v_mul_f32 v203, v203, v25
    v_accvgpr_write_b32 a12, v200
    v_accvgpr_write_b32 a13, v201
    v_accvgpr_write_b32 a14, v202
    v_accvgpr_write_b32 a15, v203
    v_accvgpr_read_b32 v200, a32
    v_accvgpr_read_b32 v201, a33
    v_accvgpr_read_b32 v202, a34
    v_accvgpr_read_b32 v203, a35
    v_mul_f32 v200, v200, v25
    v_mul_f32 v201, v201, v25
    v_mul_f32 v202, v202, v25
    v_mul_f32 v203, v203, v25
    v_accvgpr_write_b32 a32, v200
    v_accvgpr_write_b32 a33, v201
    v_accvgpr_write_b32 a34, v202
    v_accvgpr_write_b32 a35, v203
    v_accvgpr_read_b32 v200, a52
    v_accvgpr_read_b32 v201, a53
    v_accvgpr_read_b32 v202, a54
    v_accvgpr_read_b32 v203, a55
    v_mul_f32 v200, v200, v25
    v_mul_f32 v201, v201, v25
    v_mul_f32 v202, v202, v25
    v_mul_f32 v203, v203, v25
    v_accvgpr_write_b32 a52, v200
    v_accvgpr_write_b32 a53, v201
    v_accvgpr_write_b32 a54, v202
    v_accvgpr_write_b32 a55, v203
    v_accvgpr_read_b32 v200, a72
    v_accvgpr_read_b32 v201, a73
    v_accvgpr_read_b32 v202, a74
    v_accvgpr_read_b32 v203, a75
    v_mul_f32 v200, v200, v25
    v_mul_f32 v201, v201, v25
    v_mul_f32 v202, v202, v25
    v_mul_f32 v203, v203, v25
    v_accvgpr_write_b32 a72, v200
    v_accvgpr_write_b32 a73, v201
    v_accvgpr_write_b32 a74, v202
    v_accvgpr_write_b32 a75, v203
    v_accvgpr_read_b32 v200, a92
    v_accvgpr_read_b32 v201, a93
    v_accvgpr_read_b32 v202, a94
    v_accvgpr_read_b32 v203, a95
    v_mul_f32 v200, v200, v25
    v_mul_f32 v201, v201, v25
    v_mul_f32 v202, v202, v25
    v_mul_f32 v203, v203, v25
    v_accvgpr_write_b32 a92, v200
    v_accvgpr_write_b32 a93, v201
    v_accvgpr_write_b32 a94, v202
    v_accvgpr_write_b32 a95, v203
    v_accvgpr_read_b32 v200, a112
    v_accvgpr_read_b32 v201, a113
    v_accvgpr_read_b32 v202, a114
    v_accvgpr_read_b32 v203, a115
    v_mul_f32 v200, v200, v25
    v_mul_f32 v201, v201, v25
    v_mul_f32 v202, v202, v25
    v_mul_f32 v203, v203, v25
    v_accvgpr_write_b32 a112, v200
    v_accvgpr_write_b32 a113, v201
    v_accvgpr_write_b32 a114, v202
    v_accvgpr_write_b32 a115, v203
    v_accvgpr_read_b32 v200, a132
    v_accvgpr_read_b32 v201, a133
    v_accvgpr_read_b32 v202, a134
    v_accvgpr_read_b32 v203, a135
    v_mul_f32 v200, v200, v25
    v_mul_f32 v201, v201, v25
    v_mul_f32 v202, v202, v25
    v_mul_f32 v203, v203, v25
    v_accvgpr_write_b32 a132, v200
    v_accvgpr_write_b32 a133, v201
    v_accvgpr_write_b32 a134, v202
    v_accvgpr_write_b32 a135, v203
    v_accvgpr_read_b32 v200, a152
    v_accvgpr_read_b32 v201, a153
    v_accvgpr_read_b32 v202, a154
    v_accvgpr_read_b32 v203, a155
    v_mul_f32 v200, v200, v25
    v_mul_f32 v201, v201, v25
    v_mul_f32 v202, v202, v25
    v_mul_f32 v203, v203, v25
    v_accvgpr_write_b32 a152, v200
    v_accvgpr_write_b32 a153, v201
    v_accvgpr_write_b32 a154, v202
    v_accvgpr_write_b32 a155, v203
    v_exp_f32 v208, v88
    v_exp_f32 v209, v89
    v_exp_f32 v210, v90
    v_exp_f32 v211, v91
    v_exp_f32 v212, v92
    v_cvt_pk_bf16_f32 v116, v208, v209
    v_exp_f32 v213, v93
    v_cvt_pk_bf16_f32 v117, v210, v211
    v_exp_f32 v214, v94
    v_exp_f32 v215, v95
    v_cvt_pk_bf16_f32 v118, v212, v213
    v_cvt_pk_bf16_f32 v119, v214, v215
    v_or3_b32 v23, v116, v117, v118
    v_or_b32 v23, v23, v119
    v_max3_f32 v24, v96, v97, v98
    v_max3_f32 v25, v99, v100, v101
    v_max3_f32 v24, v24, v102, v103
    v_max_f32 v24, v24, v25
    v_mov_b32 v25, v24
    s_nop 1
    v_permlane32_swap_b32 v24, v25
    v_max_f32 v24, v24, v25
    v_mov_b32 v25, v24
    s_nop 1
    v_permlane16_swap_b32 v24, v25
    v_max_f32 v24, v24, v25
    v_add_f32 v24, 0x40e00000, v24
    v_max_f32 v24, 0, v24
    v_sub_f32 v25, 0, v24
    v_exp_f32 v25, v25
    v_sub_f32 v140, v140, v24
    v_sub_f32 v141, v141, v24
    v_sub_f32 v142, v142, v24
    v_sub_f32 v143, v143, v24
    v_sub_f32 v96, v96, v24
    v_sub_f32 v97, v97, v24
    v_sub_f32 v98, v98, v24
    v_sub_f32 v99, v99, v24
    v_sub_f32 v100, v100, v24
    v_sub_f32 v101, v101, v24
    v_sub_f32 v102, v102, v24
    v_sub_f32 v103, v103, v24
    v_mul_f32 v160, v160, v25
    v_mul_f32 v161, v161, v25
    v_mul_f32 v162, v162, v25
    v_mul_f32 v163, v163, v25
    v_accvgpr_read_b32 v200, a16
    v_accvgpr_read_b32 v201, a17
    v_accvgpr_read_b32 v202, a18
    v_accvgpr_read_b32 v203, a19
    v_mul_f32 v200, v200, v25
    v_mul_f32 v201, v201, v25
    v_mul_f32 v202, v202, v25
    v_mul_f32 v203, v203, v25
    v_accvgpr_write_b32 a16, v200
    v_accvgpr_write_b32 a17, v201
    v_accvgpr_write_b32 a18, v202
    v_accvgpr_write_b32 a19, v203
    v_accvgpr_read_b32 v200, a36
    v_accvgpr_read_b32 v201, a37
    v_accvgpr_read_b32 v202, a38
    v_accvgpr_read_b32 v203, a39
    v_mul_f32 v200, v200, v25
    v_mul_f32 v201, v201, v25
    v_mul_f32 v202, v202, v25
    v_mul_f32 v203, v203, v25
    v_accvgpr_write_b32 a36, v200
    v_accvgpr_write_b32 a37, v201
    v_accvgpr_write_b32 a38, v202
    v_accvgpr_write_b32 a39, v203
    v_accvgpr_read_b32 v200, a56
    v_accvgpr_read_b32 v201, a57
    v_accvgpr_read_b32 v202, a58
    v_accvgpr_read_b32 v203, a59
    v_mul_f32 v200, v200, v25
    v_mul_f32 v201, v201, v25
    v_mul_f32 v202, v202, v25
    v_mul_f32 v203, v203, v25
    v_accvgpr_write_b32 a56, v200
    v_accvgpr_write_b32 a57, v201
    v_accvgpr_write_b32 a58, v202
    v_accvgpr_write_b32 a59, v203
    v_accvgpr_read_b32 v200, a76
    v_accvgpr_read_b32 v201, a77
    v_accvgpr_read_b32 v202, a78
    v_accvgpr_read_b32 v203, a79
    v_mul_f32 v200, v200, v25
    v_mul_f32 v201, v201, v25
    v_mul_f32 v202, v202, v25
    v_mul_f32 v203, v203, v25
    v_accvgpr_write_b32 a76, v200
    v_accvgpr_write_b32 a77, v201
    v_accvgpr_write_b32 a78, v202
    v_accvgpr_write_b32 a79, v203
    v_accvgpr_read_b32 v200, a96
    v_accvgpr_read_b32 v201, a97
    v_accvgpr_read_b32 v202, a98
    v_accvgpr_read_b32 v203, a99
    v_mul_f32 v200, v200, v25
    v_mul_f32 v201, v201, v25
    v_mul_f32 v202, v202, v25
    v_mul_f32 v203, v203, v25
    v_accvgpr_write_b32 a96, v200
    v_accvgpr_write_b32 a97, v201
    v_accvgpr_write_b32 a98, v202
    v_accvgpr_write_b32 a99, v203
    v_accvgpr_read_b32 v200, a116
    v_accvgpr_read_b32 v201, a117
    v_accvgpr_read_b32 v202, a118
    v_accvgpr_read_b32 v203, a119
    v_mul_f32 v200, v200, v25
    v_mul_f32 v201, v201, v25
    v_mul_f32 v202, v202, v25
    v_mul_f32 v203, v203, v25
    v_accvgpr_write_b32 a116, v200
    v_accvgpr_write_b32 a117, v201
    v_accvgpr_write_b32 a118, v202
    v_accvgpr_write_b32 a119, v203
    v_accvgpr_read_b32 v200, a136
    v_accvgpr_read_b32 v201, a137
    v_accvgpr_read_b32 v202, a138
    v_accvgpr_read_b32 v203, a139
    v_mul_f32 v200, v200, v25
    v_mul_f32 v201, v201, v25
    v_mul_f32 v202, v202, v25
    v_mul_f32 v203, v203, v25
    v_accvgpr_write_b32 a136, v200
    v_accvgpr_write_b32 a137, v201
    v_accvgpr_write_b32 a138, v202
    v_accvgpr_write_b32 a139, v203
    v_accvgpr_read_b32 v200, a156
    v_accvgpr_read_b32 v201, a157
    v_accvgpr_read_b32 v202, a158
    v_accvgpr_read_b32 v203, a159
    v_mul_f32 v200, v200, v25
    v_mul_f32 v201, v201, v25
    v_mul_f32 v202, v202, v25
    v_mul_f32 v203, v203, v25
    v_accvgpr_write_b32 a156, v200
    v_accvgpr_write_b32 a157, v201
    v_accvgpr_write_b32 a158, v202
    v_accvgpr_write_b32 a159, v203
    v_exp_f32 v200, v96
    v_exp_f32 v201, v97
    v_exp_f32 v202, v98
    v_exp_f32 v203, v99
    v_exp_f32 v204, v100
    v_cvt_pk_bf16_f32 v120, v200, v201
    v_exp_f32 v205, v101
    v_cvt_pk_bf16_f32 v121, v202, v203
    v_exp_f32 v206, v102
    v_exp_f32 v207, v103
    v_cvt_pk_bf16_f32 v122, v204, v205
    v_cvt_pk_bf16_f32 v123, v206, v207
    v_or3_b32 v23, v120, v121, v122
    v_or_b32 v23, v23, v123
    s_nop 7
    s_setpc_b64 s[58:59]
.section .rodata,"a"
.p2align 6
.amdhsa_kernel attn_kernel
  .amdhsa_next_free_vgpr 512
  .amdhsa_next_free_sgpr 100
  .amdhsa_accum_offset 256
  .amdhsa_group_segment_fixed_size 0
  .amdhsa_kernarg_size 104
  .amdhsa_user_sgpr_count 2
  .amdhsa_user_sgpr_kernarg_segment_ptr 1
  .amdhsa_system_sgpr_workgroup_id_x 1
.end_amdhsa_kernel
```
